```python
import torch

def _softmax(x, axis=-1):
    return torch.softmax(x, dim=axis)
def _gelu(x):
    return torch.nn.functional.gelu(x, approximate="tanh")
def _silu(x):
    return torch.nn.functional.silu(x)
def _sigmoid(x):
    return torch.sigmoid(x)
def _layernorm(x, axis=-1, eps=1e-5):
    m = x.mean(dim=axis, keepdim=True)
    v = x.var(dim=axis, keepdim=True, unbiased=False)
    return (x - m) / torch.sqrt(v + eps)
def _scatter_add(tgt, idx, src, axis=0):
    return tgt.clone().index_add_(axis, idx, src)
def _segment_sum(src, seg, n):
    out = torch.zeros((n,) + src.shape[1:], dtype=src.dtype)
    return out.index_add_(0, seg, src)
def _pad(x, pw):
    flat = tuple(v for pair in reversed(pw) for v in pair)
    return torch.nn.functional.pad(x, flat)

kernel_name = 'parallel_sum__ssm_conv_h3__dense_activation_gelu__prompt'

def setup_inputs():

    _w = (lambda a: (lambda t: t.to(torch.bfloat16) if t.is_floating_point() else t)(torch.as_tensor(a)))
    def _A_setup():
        B, S, D = 1, 2048, 640
        ks = 4
        return {
            "q": _w((lambda *s: torch.randn(*s, dtype=torch.bfloat16) * 0.05)(B, S, D)),
            "k": _w((lambda *s: torch.randn(*s, dtype=torch.bfloat16) * 0.2)(B, S, D)),
            "v": _w((lambda *s: torch.randn(*s, dtype=torch.bfloat16) * 0.2)(B, S, D)),
            "shift_k": _w((lambda *s: torch.randn(*s, dtype=torch.bfloat16) * 0.2)(D, ks) * 0.5),
            "ssm_k": _w((lambda *s: torch.randn(*s, dtype=torch.bfloat16) * 0.8)(D, S) * (1.0 / S ** 0.5)),
            "ssm_D": _w((lambda *s: torch.randn(*s, dtype=torch.bfloat16) * 0.2)(D)),
        }
    _A_in = _A_setup()

    def _B_setup():
        B, S, D, F = 1, 2048, 640, 1728
        return {
            "x": _w((lambda *s: torch.randn(*s, dtype=torch.bfloat16) * 0.05)(B, S, D)),
            "w1": _w((lambda *s: torch.randn(*s, dtype=torch.bfloat16) * 0.4)(D, F) * (D ** -0.5)),
            "b1": _w((lambda *s: torch.randn(*s, dtype=torch.bfloat16) * 12.8)(F) * 0.01),
            "w2": _w((lambda *s: torch.randn(*s, dtype=torch.bfloat16) * 0.2)(F, D) * (F ** -0.5)),
            "b2": _w((lambda *s: torch.randn(*s, dtype=torch.bfloat16) * 1.6)(D) * 0.01),
        }
    _B_in = _B_setup()

    return {
        "A_q": _A_in["q"],
        "A_k": _A_in["k"],
        "A_v": _A_in["v"],
        "A_shift_k": _A_in["shift_k"],
        "A_ssm_k": _A_in["ssm_k"],
        "A_ssm_D": _A_in["ssm_D"],
        "B_x": _B_in["x"],
        "B_w1": _B_in["w1"],
        "B_b1": _B_in["b1"],
        "B_w2": _B_in["w2"],
        "B_b2": _B_in["b2"],
    }

def reference(A_q, A_k, A_v, A_shift_k, A_ssm_k, A_ssm_D, B_x, B_w1, B_b1, B_w2, B_b2):
    def _A_ref(q, k, v, shift_k, ssm_k, ssm_D):
        B, S, D = q.shape
        ks = shift_k.shape[-1]
        k_pad = _pad(k, ((0, 0), (ks - 1, 0), (0, 0)))
        k_shift = torch.zeros_like(k)
        for t in range(ks):
            k_shift = k_shift + k_pad[:, t:t + S, :] * shift_k[:, ks - 1 - t][None, None, :]
        kv = k_shift * v
        L = 2 * S
        kv_pad = _pad(kv, ((0, 0), (0, S), (0, 0)))
        kf_pad = _pad(ssm_k, ((0, 0), (0, S)))
        kv_f = (lambda x, axes=(-2,-1): torch.fft.rfft2(x.float(), dim=axes))(kv_pad[:, None, :, :], axes=(1, 2))
        kf_f = (lambda x, axes=(-2,-1): torch.fft.rfft2(x.float(), dim=axes))(kf_pad[:, None, :], axes=(1, 2))
        kf_f = (lambda x, *d: x.permute(*d))(kf_f, 1, 2, 0)
        y_f = kv_f * kf_f[None, :, :, :]
        y = (lambda x, s, axes=(-2,-1): torch.fft.irfft2(x, s=s, dim=axes).to(torch.bfloat16))(y_f, (1, L), axes=(1, 2))[:, 0, :S, :]
        y = y + kv * ssm_D[None, None, :]
        return q * y

    def _B_ref(x, w1, b1, w2, b2):
        h = torch.einsum("bsd,df->bsf", x, w1) + b1
        h = _gelu(h)
        return torch.einsum("bsf,fd->bsd", h, w2) + b2

    x = A_q
    xn = _layernorm(x, axis=-1)
    return x + _A_ref(xn, A_k, A_v, A_shift_k, A_ssm_k, A_ssm_D) + _B_ref(xn, B_w1, B_b1, B_w2, B_b2)
```

```asm
; @launch grid=(256,1,1) block=(256,1,1) lds=161792
.amdgcn_target "amdgcn-amd-amdhsa--gfx950"
.text
.globl parallel_sum__ssm_conv_h3__dense_activation_gelu__prompt_kernel
.p2align 8
.type parallel_sum__ssm_conv_h3__dense_activation_gelu__prompt_kernel,@function
parallel_sum__ssm_conv_h3__dense_activation_gelu__prompt_kernel:
    s_cmp_ge_u32 s2, 256
    s_cbranch_scc1 L_end
    s_load_dwordx4 s[36:39], s[0:1], 0
    s_load_dwordx4 s[44:47], s[0:1], 16
    s_load_dwordx4 s[64:67], s[0:1], 88
    s_load_dwordx4 s[48:51], s[0:1], 56
    s_load_dwordx4 s[56:59], s[0:1], 32
    s_load_dwordx4 s[52:55], s[0:1], 72
    s_load_dwordx2 s[60:61], s[0:1], 104
    s_getpc_b64 s[6:7]
L_pc:
    s_lshr_b32 s82, s2, 3
    v_and_b32 v6, 15, v0
    v_lshlrev_b32 v6, 5, v6
    v_add_u32 v6, s82, v6
    v_lshlrev_b32 v6, 7, v6
    v_min_u32 v6, L_last-L_pc, v6
    v_mov_b32 v7, s7
    v_add_co_u32 v6, vcc, s6, v6
    s_nop 1
    v_addc_co_u32 v7, vcc, 0, v7, vcc
    v_lshrrev_b32 v8, 4, v0
    v_cmp_eq_u32 vcc, 4, v8
    s_nop 1
    s_and_b64 exec, exec, vcc
    s_cbranch_execz L_nopf
    global_load_dword v253, v[6:7], off
L_nopf:
    s_mov_b64 exec, -1
    v_lshrrev_b32 v2, 6, v0
    v_and_b32 v1, 63, v0
    v_mov_b32 v255, 0
    v_readfirstlane_b32 s5, v2
    s_and_b32 s3, s2, 7
    s_lshr_b32 s4, s2, 3
    s_lshr_b32 s68, s3, 1
    s_and_b32 s69, s3, 1
    s_lshr_b32 s70, s4, 3
    s_and_b32 s71, s4, 7
    s_lshl2_add_u32 s72, s68, s70
    s_lshl3_add_u32 s73, s69, s71
    s_lshl2_add_u32 s81, s3, s70
    s_lshl_b32 s74, s68, 9
    s_lshl4_add_u32 s74, s70, s74
    s_mov_b32 s30, 2621440
    s_mov_b32 s31, 0x20000
    s_mov_b32 s34, 2211840
    s_mov_b32 s35, 0x20000
    s_mov_b64 s[42:43], s[30:31]
    s_mov_b32 s62, 17825792
    s_mov_b32 s63, 0x20000
    v_lshrrev_b32 v2, 5, v0
    v_mul_u32_u24 v2, 81920, v2
    v_and_b32 v3, 31, v0
    v_lshl_add_u32 v2, v3, 3, v2
    s_add_u32 s89, s74, s73
    s_mul_i32 s89, s89, 1280
    v_lshrrev_b32 v6, 3, v1
    v_lshrrev_b32 v7, 5, v1
    v_lshlrev_b32 v7, 1, v7
    v_and_b32 v8, 7, v1
    v_xor_b32 v8, v8, v7
    v_mul_u32_u24 v6, 1280, v6
    v_lshl_add_u32 v4, v8, 4, v6
    v_xor_b32 v5, 64, v4
    v_lshlrev_b32 v252, 4, v1
    v_and_b32 v3, 15, v1
    v_lshlrev_b32 v3, 3, v3
    s_cmp_eq_u32 s71, 7
    s_cbranch_scc1 L_roleS
    s_mul_i32 s84, s81, 7
    s_add_u32 s84, s84, s71
    s_and_b32 s76, s84, 31
    s_lshr_b32 s77, s84, 5
    s_mul_i32 s78, s76, 81920
    s_lshl_b32 s79, s77, 7
    s_add_u32 s78, s78, s79
    s_sub_u32 s80, s78, 10240
    s_cmp_eq_u32 s76, 0
    s_cselect_b32 s80, 2621440, s80
    s_mul_i32 s79, s5, 20480
    s_add_u32 s78, s78, s79
    s_add_u32 s79, s78, 10240
    s_lshl2_add_u32 s16, s77, s5
    s_lshl_b32 s16, s16, 7
    v_add_u32 v6, s16, v3
    s_lshl_b32 s16, s5, 11
    s_waitcnt lgkmcnt(0)
    s_mov_b64 s[40:41], s[38:39]
    s_mov_b64 s[14:15], s[46:47]
    s_mov_b64 s[46:47], s[30:31]
    s_add_u32 m0, s16, 132096
    s_nop 0
    buffer_load_dwordx4 v5, s[40:43], s78 offen nt lds
    s_add_u32 m0, s16, 133120
    global_load_dwordx2 v[198:199], v6, s[14:15]
    buffer_load_dwordx4 v4, s[40:43], s79 offen nt lds
    s_add_u32 m0, s16, 140288
    s_nop 0
    buffer_load_dwordx4 v4, s[44:47], s78 offen nt lds
    s_add_u32 m0, s16, 141312
    s_nop 0
    buffer_load_dwordx4 v5, s[44:47], s79 offen nt lds
    s_mov_b32 m0, 131072
    s_nop 0
    buffer_load_dwordx4 v4, s[40:43], s80 offen nt lds
    s_mov_b64 s[38:39], s[30:31]
    buffer_load_dwordx2 v[128:129], v2, s[36:39], s89 offen offset:0
    buffer_load_dwordx2 v[130:131], v2, s[36:39], s89 offen offset:256
    buffer_load_dwordx2 v[132:133], v2, s[36:39], s89 offen offset:512
    buffer_load_dwordx2 v[134:135], v2, s[36:39], s89 offen offset:768
    buffer_load_dwordx2 v[136:137], v2, s[36:39], s89 offen offset:1024
    s_mov_b64 s[24:25], s[50:51]
    s_mov_b64 s[50:51], s[34:35]
    s_mul_i32 s6, s69, 7
    s_add_u32 s6, s6, s71
    s_lshl_b32 s75, s6, 2
    s_min_u32 s75, s75, 50
    v_lshrrev_b32 v6, 3, v1
    v_mul_u32_u24 v6, 81920, v6
    v_lshrrev_b32 v7, 4, v1
    v_and_b32 v8, 7, v1
    v_xor_b32 v8, v8, v7
    v_lshl_add_u32 v32, v8, 4, v6
    v_xor_b32 v6, 64, v32
    v_add_u32 v33, 256, v6
    v_add_u32 v34, 512, v32
    v_add_u32 v35, 768, v6
    v_mul_u32_u24 v6, 3456, v7
    v_lshlrev_b32 v7, 2, v7
    v_and_b32 v8, 15, v1
    v_xor_b32 v8, v8, v7
    v_lshl_add_u32 v36, v8, 4, v6
    v_xor_b32 v8, 2, v8
    v_lshl_add_u32 v6, v8, 4, v6
    v_add_u32 v37, 12800, v36
    v_add_u32 v38, 25600, v6
    v_add_u32 v39, 38400, v6
    s_lshl2_add_u32 s6, s5, s74
    s_mul_i32 s8, s6, 1280
    s_mul_i32 s9, s5, 55296
    s_lshl_b32 s6, s75, 6
    s_add_u32 s9, s9, s6
    s_lshl_b32 s81, s5, 12
    s_mul_i32 s6, s70, 5
    s_lshr_b32 s6, s6, 1
    s_mul_i32 s85, s71, 3
    s_add_u32 s85, s85, s6
    s_mul_i32 s6, s68, 5
    s_lshr_b32 s6, s6, 1
    s_add_u32 s85, s85, s6
    s_add_u32 s85, s85, s69
    s_mul_i32 s6, s85, 26
    s_lshr_b32 s6, s6, 8
    s_mul_i32 s6, s6, 10
    s_sub_u32 s85, s85, s6
    s_lshl_b32 s6, s85, 7
    s_add_u32 s8, s8, s6
    s_mul_i32 s6, s85, 221184
    s_add_u32 s9, s9, s6
    v_and_b32 v6, 3, v1
    v_lshlrev_b32 v6, 2, v6
    v_bfe_u32 v7, v1, 2, 2
    v_add_u32 v6, v6, v7
    v_bfe_u32 v7, v1, 4, 1
    v_lshl_add_u32 v7, s5, 1, v7
    v_lshrrev_b32 v8, 5, v1
    v_add_u32 v9, 1032, v6
    v_sub_u32 v9, v9, v8
    v_bfe_u32 v14, v9, 2, 2
    v_lshlrev_b32 v14, 1, v14
    v_xor_b32 v14, v14, v7
    v_lshlrev_b32 v14, 4, v14
    v_lshl_add_u32 v192, v9, 7, v14
    v_add_u32 v9, 1030, v6
    v_sub_u32 v9, v9, v8
    v_bfe_u32 v14, v9, 2, 2
    v_lshlrev_b32 v14, 1, v14
    v_xor_b32 v14, v14, v7
    v_lshlrev_b32 v14, 4, v14
    v_lshl_add_u32 v193, v9, 7, v14
    v_add_u32 v9, 1096, v6
    v_bfe_u32 v14, v6, 2, 2
    v_lshlrev_b32 v14, 1, v14
    v_xor_b32 v14, v14, v7
    v_lshlrev_b32 v14, 4, v14
    v_lshl_add_u32 v194, v9, 7, v14
    v_bfe_u32 v6, v1, 3, 1
    v_bfe_u32 v7, v1, 4, 1
    v_bfe_u32 v9, v1, 1, 2
    v_cmp_eq_u32 vcc, v6, v7
    v_lshlrev_b32 v195, 4, v8
    v_and_b32 v196, 1, v1
    v_cndmask_b32 v9, 7, v9, vcc
    v_lshlrev_b32 v196, 4, v196
    v_mov_b32 v6, 0xffff
    v_lshlrev_b32 v6, v196, v6
    v_sub_u32 v8, 1, v8
    v_mul_u32_u24 v8, 0x3f80, v8
    v_lshl_or_b32 v8, v8, 16, v8
    v_cmp_eq_u32 vcc, 0, v9
    v_and_b32 v14, 15, v1
    s_nop 0
    v_cndmask_b32 v212, 0, v6, vcc
    v_cmp_eq_u32 vcc, 1, v9
    v_and_b32 v200, v8, v212
    s_nop 0
    v_cndmask_b32 v213, 0, v6, vcc
    v_cmp_eq_u32 vcc, 2, v9
    v_and_b32 v201, v8, v213
    s_nop 0
    v_cndmask_b32 v214, 0, v6, vcc
    v_cmp_eq_u32 vcc, 3, v9
    v_and_b32 v202, v8, v214
    s_nop 0
    v_cndmask_b32 v215, 0, v6, vcc
    v_and_b32 v203, v8, v215
    s_lshl_b32 s6, s5, 11
    s_add_u32 s6, s6, 149504
    v_lshlrev_b32 v14, 6, v14
    v_lshrrev_b32 v7, 4, v1
    v_lshl_add_u32 v14, v7, 4, v14
    v_add_u32 v224, s6, v14
    v_add_u32 v225, s6, v252
    v_lshrrev_b32 v14, 2, v1
    v_lshlrev_b32 v14, 12, v14
    v_and_b32 v7, 3, v1
    v_lshl_add_u32 v197, v7, 4, v14
    s_mov_b64 s[28:29], s[54:55]
    s_mov_b64 s[54:55], s[34:35]
    s_mov_b64 s[18:19], s[58:59]
    s_mov_b64 s[58:59], s[30:31]
    s_mov_b64 s[32:33], s[66:67]
    s_mov_b64 s[66:67], s[30:31]
    s_lshr_b32 s90, s5, 1
    s_and_b32 s91, s5, 1
    v_and_b32 v6, 15, v1
    v_lshrrev_b32 v7, 1, v6
    v_lshrrev_b32 v8, 4, v1
    v_xor_b32 v7, v7, v8
    s_lshl_b32 s6, s91, 13
    v_lshlrev_b32 v6, 7, v6
    v_add_u32 v6, s6, v6
    v_lshl_add_u32 v20, v7, 4, v6
    v_xor_b32 v21, 64, v20
    v_add_u32 v22, 0x10000, v20
    v_add_u32 v23, 0x10000, v21
    v_bfe_u32 v6, v1, 2, 2
    v_lshl_add_u32 v7, v8, 3, v6
    v_lshlrev_b32 v7, 8, v7
    v_and_b32 v9, 3, v1
    v_lshl_add_u32 v7, v9, 3, v7
    v_add_u32 v7, 16384, v7
    v_and_b32 v8, 1, v8
    v_lshl_add_u32 v6, v6, 1, v8
    s_lshl_b32 s6, s5, 1
    v_xor_b32 v6, s6, v6
    v_lshl_add_u32 v24, v6, 5, v7
    v_xor_b32 v25, 32, v24
    v_xor_b32 v26, 64, v24
    v_xor_b32 v27, 96, v24
    v_add_u32 v28, 0x10000, v24
    v_add_u32 v29, 0x10000, v25
    v_add_u32 v30, 0x10000, v26
    v_add_u32 v31, 0x10000, v27
    v_mov_b32 v40, 0x3f803f80
    v_mov_b32 v41, 0x3f803f80
    v_mov_b32 v42, 0x3f803f80
    v_mov_b32 v43, 0x3f803f80
    s_lshl1_add_u32 s86, s84, s90
    s_mul_i32 s34, s84, 1639
    s_lshr_b32 s34, s34, 16
    s_lshl_b32 s34, s34, 7
    s_add_u32 s34, s34, 7168
    s_mov_b32 s30, 17825792
    s_mul_i32 s88, s90, 4352
    s_add_u32 s87, s88, 131072
    s_add_u32 s88, s88, 65536
    s_lshr_b32 s22, s84, 2
    s_and_b32 s23, s84, 3
    v_add_u32 v6, 0, v0
    v_mul_u32_u24 v7, 3277, v6
    v_lshrrev_b32 v7, 16, v7
    v_mul_u32_u24 v8, 20, v7
    v_sub_u32 v8, v6, v8
    v_mul_u32_u24 v7, 1280, v7
    v_lshl_add_u32 v60, v8, 4, v7
    v_add_u32 v6, 256, v0
    v_mul_u32_u24 v7, 3277, v6
    v_lshrrev_b32 v7, 16, v7
    v_mul_u32_u24 v8, 20, v7
    v_sub_u32 v8, v6, v8
    v_mul_u32_u24 v7, 1280, v7
    v_lshl_add_u32 v61, v8, 4, v7
    v_add_u32 v6, 512, v0
    v_mul_u32_u24 v7, 3277, v6
    v_lshrrev_b32 v7, 16, v7
    v_mul_u32_u24 v8, 20, v7
    v_sub_u32 v8, v6, v8
    v_mul_u32_u24 v7, 1280, v7
    v_lshl_add_u32 v62, v8, 4, v7
    s_cmp_ge_u32 s5, 2
    s_cselect_b32 s78, 1073741824, 0
    v_add_u32 v62, s78, v62
    s_mul_i32 s26, s22, 40960
    s_mul_i32 s78, s23, 320
    s_add_u32 s26, s26, s78
    v_lshrrev_b32 v7, 2, v1
    v_mul_u32_u24 v7, 320, v7
    v_and_b32 v6, 3, v1
    v_lshl_add_u32 v7, v6, 3, v7
    s_lshl_b32 s78, s5, 5
    s_add_u32 s78, s78, 149504
    v_add_u32 v63, s78, v7
    s_mul_i32 s78, s23, 108
    s_add_u32 s78, s78, s22
    s_mul_i32 s78, s78, 5120
    s_lshl_b32 s79, s5, 10
    s_add_u32 s78, s78, s79
    s_add_u32 s78, s78, 7340032
    s_cmp_ge_u32 s22, 54
    s_cselect_b32 s96, 17825792, s78
    s_movk_i32 s78, 4096
    s_cmp_eq_u32 s5, 0
    s_cselect_b32 s78, s78, 275456
    s_add_u32 s97, s96, s78
    s_mov_b32 s78, 17825792
    s_cmp_ge_u32 s5, 2
    s_cselect_b32 s78, s78, 279552
    s_add_u32 s98, s96, s78
    s_lshl_b32 s22, s5, 10
    s_lshl_b32 s23, s23, 7
    s_add_u32 s23, s23, 6144
    v_mov_b32 v6, 148992
    ds_write2_b32 v6, v255, v255 offset1:1
    s_mov_b32 s10, s72
    s_bfe_u32 s11, s4, 0x10002
    s_and_b32 s12, s4, 3
    s_lshl_b32 s6, s69, 2
    s_add_u32 s12, s12, s6
    s_mul_i32 s101, s5, 13
    s_cmp_lg_u32 s5, 0
    s_addc_u32 s101, s101, 0
    s_bfe_u32 s6, s4, 0x20002
    s_lshl_b32 s6, s6, 2
    s_sub_u32 s68, 16, s6
    s_sub_u32 s6, s6, 2
    s_max_i32 s31, s6, 0
    s_mul_i32 s74, s12, 54
    s_add_u32 s74, s74, s101
    s_mul_i32 s74, s74, 5120
    s_add_u32 s74, s74, 7340032
    s_mul_i32 s100, s31, 5120
    s_add_u32 s100, s100, s74
    s_mov_b32 s27, s100
    s_and_b32 s6, s5, 1
    s_lshl_b32 s79, s6, 11
    s_add_u32 s99, s79, s87
    s_add_u32 s99, s99, 32
    s_lshl_b32 s95, s86, 12
    s_add_u32 s35, s95, s79
    s_add_u32 s95, s35, 1048576
    s_lshl_b32 s78, s86, 1
    v_mov_b32 v55, s78
    v_lshl_add_u32 v56, v1, 2, s88
    v_and_b32 v57, 7, v1
    v_lshl_add_u32 v57, v57, 2, s87
    s_mul_i32 s78, s6, 4160
    s_add_u32 s78, s78, s87
    v_mov_b32 v58, s78
    v_lshrrev_b32 v59, 2, v1
    v_lshlrev_b32 v59, 6, v59
    v_and_b32 v6, 3, v1
    v_lshl_add_u32 v59, v6, 3, v59
    s_add_u32 s79, s79, s88
    s_add_u32 s79, s79, 256
    v_add_u32 v59, s79, v59
    s_add_u32 s78, s5, s75
    s_lshl_b32 s78, s78, 6
    v_and_b32 v6, 15, v1
    v_lshl_add_u32 v18, v6, 1, s78
    v_xor_b32 v19, 64, v18
    s_lshl_b32 s78, s5, 7
    s_add_u32 s78, s78, 148480
    v_lshl_add_u32 v16, v6, 2, s78
    v_xor_b32 v17, 128, v16
    s_lshl1_add_u32 s79, s72, s91
    s_lshl_b32 s94, s79, 10
    s_add_u32 s94, s94, 32768
    s_mul_i32 s84, s5, 3072
    s_add_u32 s84, s84, 149504
    v_mov_b32 v7, 2048
    v_add3_u32 v52, s84, v252, v7
    v_lshl_add_u32 v53, v6, 4, s84
    v_cmp_gt_u32 vcc, 16, v1
    v_add_u32 v54, 2048, v53
    s_mul_i32 s78, s79, 54
    v_cndmask_b32 v54, v54, v53, vcc
    s_add_u32 s78, s78, s75
    s_add_u32 s92, s78, s5
    s_lshl_b32 s92, s92, 12
    s_add_u32 s92, s92, 10485760
    s_xor_b32 s93, s92, 4096
    s_lshl4_add_u32 s78, s90, s73
    s_cmp_eq_u32 s78, 14
    s_cselect_b32 s92, 17825792, s92
    s_cselect_b32 s93, 17825792, s93
    s_lshl_b32 s78, s72, 7
    v_mov_b32 v241, s78
    v_mov_b32 v242, 0
    s_lshr_b32 s78, s86, 6
    s_lshl_b32 s78, s78, 7
    s_add_u32 s78, s78, 4096
    v_writelane_b32 v241, s78, 1
    s_lshr_b32 s78, s12, 1
    s_lshl_b32 s78, s78, 7
    s_add_u32 s78, s78, 6144
    v_writelane_b32 v241, s78, 2
    v_writelane_b32 v242, 16, 0
    v_writelane_b32 v242, 32, 1
    v_writelane_b32 v242, 56, 2
    v_bfe_u32 v2, v1, 2, 2
    v_lshrrev_b32 v6, 4, v1
    v_lshlrev_b32 v7, 1, v6
    v_sub_u32 v3, v2, v7
    v_lshlrev_b32 v3, 5, v3
    v_and_b32 v7, 3, v1
    v_sub_u32 v4, v7, v2
    v_lshl_add_u32 v2, v7, 3, v3
    s_add_u32 s6, s88, 224
    v_add_u32 v2, s6, v2
    v_add_u32 v3, 2048, v2
    v_lshlrev_b32 v4, 3, v4
    v_lshl_add_u32 v4, v6, 6, v4
    s_add_u32 s6, s87, 32
    v_add_u32 v4, s6, v4
    v_lshlrev_b32 v13, 3, v6
    v_lshrrev_b32 v6, 3, v1
    v_mul_u32_u24 v6, 81920, v6
    v_and_b32 v7, 7, v1
    v_lshl_add_u32 v5, v7, 4, v6
    v_lshrrev_b32 v6, 4, v1
    v_mul_u32_u24 v6, 81920, v6
    v_and_b32 v7, 15, v1
    v_lshl_add_u32 v6, v7, 4, v6
    v_cmp_gt_u32 vcc, 10, v7
    v_mov_b32 v7, 1073741824
    s_nop 0
    v_cndmask_b32 v12, v7, v6, vcc
    v_bfe_u32 v6, v1, 2, 2
    v_mul_u32_u24 v6, 1088, v6
    v_and_b32 v7, 3, v1
    v_lshl_add_u32 v6, v7, 8, v6
    s_mul_i32 s21, s5, 4608
    s_add_u32 s21, s21, 106496
    v_add3_u32 v13, v13, v6, s21
    s_lshr_b32 s7, s10, 2
    s_lshl_b32 s7, s7, 9
    s_and_b32 s6, s10, 3
    s_lshl_b32 s6, s6, 4
    s_add_u32 s7, s7, s6
    s_lshl_b32 s6, s11, 3
    s_add_u32 s7, s7, s6
    s_lshl_b32 s6, s5, 1
    s_add_u32 s7, s7, s6
    s_mul_i32 s7, s7, 1280
    s_mul_i32 s6, s12, 160
    s_add_u32 s7, s7, s6
    s_add_u32 s6, s5, 1
    s_and_b32 s6, s6, 3
    s_lshl_b32 s6, s6, 10
    v_add_u32 v8, s6, v252
    s_add_u32 s6, s5, 2
    s_and_b32 s6, s6, 3
    s_lshl_b32 s6, s6, 10
    v_add_u32 v9, s6, v252
    s_add_u32 s6, s5, 3
    s_and_b32 s6, s6, 3
    s_lshl_b32 s6, s6, 10
    v_add_u32 v10, s6, v252
    s_add_u32 s6, s5, 4
    s_and_b32 s6, s6, 3
    s_lshl_b32 s6, s6, 10
    v_add_u32 v11, s6, v252
    s_lshl_b32 s6, s10, 1
    s_add_u32 s6, s6, s11
    s_mul_i32 s6, s6, 54
    s_add_u32 s6, s6, s101
    s_lshl_b32 s6, s6, 12
    s_add_u32 s14, s6, 10485760
    s_lshl_b32 s20, s31, 12
    s_add_u32 s20, s20, s14
    s_cmp_ge_u32 s5, 2
    s_cselect_b32 s15, 17825792, s14
    s_cmp_eq_u32 s31, 0
    s_cselect_b32 s17, s15, s20
    s_getpc_b64 s[78:79]
Lpc_1:
    v_lshrrev_b32 v6, 4, v1
    v_lshl_add_u32 v6, s4, 2, v6
    v_lshlrev_b32 v6, 7, v6
    v_min_u32 v6, L_end-L_conv, v6
    v_add_u32 v6, L_conv-Lpc_1, v6
    v_ashrrev_i32 v7, 31, v6
    v_mov_b32 v247, s79
    v_add_co_u32 v246, vcc, s78, v6
    s_nop 1
    v_addc_co_u32 v247, vcc, v247, v7, vcc
    global_load_ushort v248, v18, s[24:25] offset:0
    global_load_ushort v249, v18, s[24:25] offset:32
    global_load_ushort v250, v19, s[24:25] offset:0
    global_load_ushort v251, v19, s[24:25] offset:32
    s_add_u32 m0, s81, 0
    s_nop 0
    buffer_load_dwordx4 v32, s[36:39], s8 offen offset:0 lds
    buffer_load_dwordx4 v33, s[36:39], s8 offen offset:1024 lds
    buffer_load_dwordx4 v34, s[36:39], s8 offen offset:2048 lds
    buffer_load_dwordx4 v35, s[36:39], s8 offen offset:3072 lds
    s_add_u32 m0, s81, 16384
    s_nop 0
    buffer_load_dwordx4 v36, s[48:51], s9 offen offset:0 lds
    buffer_load_dwordx4 v37, s[48:51], s9 offen offset:1024 lds
    buffer_load_dwordx4 v38, s[48:51], s9 offen offset:2048 lds
    buffer_load_dwordx4 v39, s[48:51], s9 offen offset:3072 lds
    s_add_u32 s8, s8, 128
    s_add_u32 s9, s9, 221184
    s_cmp_eq_u32 s85, 9
    s_cselect_b32 s83, 1280, 0
    s_cselect_b32 s82, 2211840, 0
    s_sub_u32 s8, s8, s83
    s_sub_u32 s9, s9, s82
    s_waitcnt vmcnt(21)
    v_lshrrev_b32 v6, v195, v198
    v_and_b32 v6, 0xffff, v6
    v_lshl_or_b32 v6, v6, 16, v6
    v_and_b32 v204, v6, v212
    v_and_b32 v205, v6, v213
    v_and_b32 v206, v6, v214
    v_and_b32 v207, v6, v215
    v_lshrrev_b32 v6, v195, v199
    v_and_b32 v6, 0xffff, v6
    v_lshl_or_b32 v6, v6, 16, v6
    v_and_b32 v208, v6, v212
    v_and_b32 v209, v6, v213
    v_and_b32 v210, v6, v214
    v_and_b32 v211, v6, v215
    s_waitcnt vmcnt(17) lgkmcnt(0)
    s_barrier
    ds_read_b128 v[148:151], v192 offset:0
    ds_read_b128 v[152:155], v193 offset:0
    ds_read_b128 v[156:159], v194 offset:0
    ds_read_b128 v[160:163], v192 offset:2048
    ds_read_b128 v[164:167], v193 offset:2048
    ds_read_b128 v[168:171], v194 offset:2048
    s_lshl2_add_u32 s16, s77, s5
    s_lshl_b32 s16, s16, 9
    s_add_u32 s16, s16, s76
    s_lshl_b32 s16, s16, 7
    s_add_u32 s16, s16, 1048576
    v_mov_b32 v138, 0
    v_mov_b32 v139, 0
    v_mov_b32 v140, 0x3f803f80
    s_waitcnt vmcnt(16)
    v_dot2c_f32_bf16 v138, v128, v140
    v_dot2c_f32_bf16 v138, v129, v140
    s_waitcnt vmcnt(15)
    v_dot2c_f32_bf16 v138, v130, v140
    v_dot2c_f32_bf16 v138, v131, v140
    s_waitcnt vmcnt(14)
    v_dot2c_f32_bf16 v138, v132, v140
    v_dot2c_f32_bf16 v138, v133, v140
    s_waitcnt vmcnt(13)
    v_dot2c_f32_bf16 v138, v134, v140
    v_dot2c_f32_bf16 v138, v135, v140
    s_waitcnt vmcnt(12)
    v_dot2c_f32_bf16 v138, v136, v140
    v_dot2c_f32_bf16 v138, v137, v140
    v_dot2c_f32_bf16 v139, v128, v128
    v_dot2c_f32_bf16 v139, v129, v129
    v_dot2c_f32_bf16 v139, v130, v130
    v_dot2c_f32_bf16 v139, v131, v131
    v_dot2c_f32_bf16 v139, v132, v132
    v_dot2c_f32_bf16 v139, v133, v133
    v_dot2c_f32_bf16 v139, v134, v134
    v_dot2c_f32_bf16 v139, v135, v135
    v_dot2c_f32_bf16 v139, v136, v136
    v_dot2c_f32_bf16 v139, v137, v137
    s_waitcnt lgkmcnt(5)
    v_mfma_f32_16x16x32_bf16 v[172:175], v[148:151], v[204:207], 0
    s_waitcnt lgkmcnt(3)
    v_mfma_f32_16x16x32_bf16 v[180:183], v[156:159], v[200:203], 0
    v_mfma_f32_16x16x32_bf16 v[172:175], v[152:155], v[208:211], v[172:175]
    s_waitcnt lgkmcnt(2)
    v_mfma_f32_16x16x32_bf16 v[176:179], v[160:163], v[204:207], 0
    s_waitcnt lgkmcnt(0)
    v_mfma_f32_16x16x32_bf16 v[184:187], v[168:171], v[200:203], 0
    v_mfma_f32_16x16x32_bf16 v[176:179], v[164:167], v[208:211], v[176:179]
    ds_read_b128 v[148:151], v192 offset:4096
    ds_read_b128 v[152:155], v193 offset:4096
    ds_read_b128 v[156:159], v194 offset:4096
    ds_read_b128 v[160:163], v192 offset:6144
    ds_read_b128 v[164:167], v193 offset:6144
    ds_read_b128 v[168:171], v194 offset:6144
    v_mul_f32 v172, v172, v180
    v_mul_f32 v173, v173, v181
    v_mul_f32 v174, v174, v182
    v_mul_f32 v175, v175, v183
    v_cvt_pk_bf16_f32 v216, v172, v173
    v_cvt_pk_bf16_f32 v217, v174, v175
    v_mul_f32 v176, v176, v184
    v_mul_f32 v177, v177, v185
    v_mul_f32 v178, v178, v186
    v_mul_f32 v179, v179, v187
    v_cvt_pk_bf16_f32 v218, v176, v177
    v_cvt_pk_bf16_f32 v219, v178, v179
    ds_write_b128 v224, v[216:219] offset:0
    ds_read_b128 v[216:219], v225 offset:0
    s_waitcnt lgkmcnt(7)
    v_mfma_f32_16x16x32_bf16 v[172:175], v[148:151], v[204:207], 0
    s_waitcnt lgkmcnt(5)
    v_mfma_f32_16x16x32_bf16 v[180:183], v[156:159], v[200:203], 0
    v_mfma_f32_16x16x32_bf16 v[172:175], v[152:155], v[208:211], v[172:175]
    s_waitcnt lgkmcnt(4)
    v_mfma_f32_16x16x32_bf16 v[176:179], v[160:163], v[204:207], 0
    s_waitcnt lgkmcnt(2)
    v_mfma_f32_16x16x32_bf16 v[184:187], v[168:171], v[200:203], 0
    v_mfma_f32_16x16x32_bf16 v[176:179], v[164:167], v[208:211], v[176:179]
    s_nop 2
    v_mul_f32 v172, v172, v180
    v_mul_f32 v173, v173, v181
    v_mul_f32 v174, v174, v182
    v_mul_f32 v175, v175, v183
    v_cvt_pk_bf16_f32 v220, v172, v173
    v_cvt_pk_bf16_f32 v221, v174, v175
    s_waitcnt lgkmcnt(0)
    buffer_store_dwordx4 v[216:219], v197, s[60:63], s16 offen offset:0 sc1
    v_mul_f32 v176, v176, v184
    v_mul_f32 v177, v177, v185
    v_mul_f32 v178, v178, v186
    v_mul_f32 v179, v179, v187
    v_cvt_pk_bf16_f32 v222, v176, v177
    v_cvt_pk_bf16_f32 v223, v178, v179
    ds_write_b128 v224, v[220:223] offset:1024
    ds_read_b128 v[220:223], v225 offset:1024
    s_waitcnt lgkmcnt(0)
    buffer_store_dwordx4 v[220:223], v197, s[60:63], s16 offen offset:64 sc1
    s_lshl_b32 s78, s72, 4
    s_add_u32 s78, s78, s73
    v_add_f32_dpp v138, v138, v138 quad_perm:[1,0,3,2] row_mask:0xf bank_mask:0xf
    v_add_f32_dpp v139, v139, v139 quad_perm:[1,0,3,2] row_mask:0xf bank_mask:0xf
    s_nop 0
    v_add_f32_dpp v138, v138, v138 quad_perm:[2,3,0,1] row_mask:0xf bank_mask:0xf
    v_add_f32_dpp v139, v139, v139 quad_perm:[2,3,0,1] row_mask:0xf bank_mask:0xf
    s_nop 0
    v_add_f32_dpp v138, v138, v138 row_half_mirror row_mask:0xf bank_mask:0xf
    v_add_f32_dpp v139, v139, v139 row_half_mirror row_mask:0xf bank_mask:0xf
    s_nop 0
    v_add_f32_dpp v138, v138, v138 row_mirror row_mask:0xf bank_mask:0xf
    v_add_f32_dpp v139, v139, v139 row_mirror row_mask:0xf bank_mask:0xf
    v_mov_b32 v140, v138
    v_mov_b32 v141, v139
    s_lshl_b32 s79, s78, 7
    s_add_u32 s79, s79, 32768
    v_permlane16_swap_b32 v138, v140
    v_permlane16_swap_b32 v139, v141
    v_add_f32 v138, v138, v140
    v_add_f32 v139, v139, v141
    v_mul_f32 v128, 0x3acccccd, v138
    v_mul_f32 v139, 0x3acccccd, v139
    v_fma_f32 v139, -v128, v128, v139
    v_cvt_pk_bf16_f32 v132, -v128, -v128
    v_max_f32 v139, 0, v139
    v_add_f32 v139, 0x3727c5ac, v139
    v_and_b32 v140, 0xffff0000, v132
    v_rsq_f32 v129, v139
    v_sub_f32 v140, -v128, v140
    v_lshrrev_b32 v141, 5, v0
    v_mul_f32 v146, v139, v129
    v_mul_f32 v144, 0xc0135761, v129
    v_cvt_pk_bf16_f32 v133, v140, v146
    v_mul_f32 v145, v129, v129
    v_and_b32 v140, 0xffff0000, v133
    v_mul_f32 v145, 0x3d372713, v145
    v_sub_f32 v140, v146, v140
    v_mul_f32 v145, v145, v144
    v_cvt_pk_bf16_f32 v134, v140, 0
    v_mov_b32 v135, 0
    v_mov_b32 v147, v129
    v_lshlrev_b32 v140, 4, v141
    v_lshlrev_b32 v141, 3, v141
    s_add_u32 s80, s79, 32768
    s_lshl_b32 s78, s78, 6
    s_add_u32 s78, s78, 98304
    s_mov_b32 exec_lo, 1
    s_mov_b32 exec_hi, 1
    buffer_store_dwordx4 v[132:135], v140, s[60:63], s79 offen sc1
    buffer_store_dwordx4 v[144:147], v140, s[60:63], s80 offen sc1
    buffer_store_dwordx2 v[128:129], v141, s[60:63], s78 offen sc1
    s_mov_b64 exec, -1
    s_add_u32 m0, s81, 32768
    s_nop 0
    buffer_load_dwordx4 v32, s[36:39], s8 offen offset:0 lds
    buffer_load_dwordx4 v33, s[36:39], s8 offen offset:1024 lds
    buffer_load_dwordx4 v34, s[36:39], s8 offen offset:2048 lds
    buffer_load_dwordx4 v35, s[36:39], s8 offen offset:3072 lds
    s_add_u32 m0, s81, 49152
    s_nop 0
    buffer_load_dwordx4 v36, s[48:51], s9 offen offset:0 lds
    buffer_load_dwordx4 v37, s[48:51], s9 offen offset:1024 lds
    buffer_load_dwordx4 v38, s[48:51], s9 offen offset:2048 lds
    buffer_load_dwordx4 v39, s[48:51], s9 offen offset:3072 lds
    s_add_u32 s8, s8, 128
    s_add_u32 s9, s9, 221184
    s_cmp_eq_u32 s85, 8
    s_cselect_b32 s83, 1280, 0
    s_cselect_b32 s82, 2211840, 0
    s_sub_u32 s8, s8, s83
    s_sub_u32 s9, s9, s82
    s_cmp_lg_u32 s5, 0
    s_cbranch_scc1 Lz_2
    global_load_dword v240, v255, s[32:33] sc1
Lz_2:
    s_lshl_b32 s76, s72, 7
    s_lshl_b32 s16, s77, 7
    s_add_u32 s16, s16, 4096
    s_waitcnt vmcnt(13)
    s_barrier
    ds_read_b64_tr_b16 v[144:145], v24 offset:0
    ds_read_b64_tr_b16 v[146:147], v24 offset:1024
    ds_read_b128 v[128:131], v20 offset:0
    ds_read_b64_tr_b16 v[148:149], v25 offset:0
    ds_read_b64_tr_b16 v[150:151], v25 offset:1024
    ds_read_b128 v[132:135], v20 offset:2048
    ds_read_b64_tr_b16 v[152:153], v26 offset:0
    ds_read_b64_tr_b16 v[154:155], v26 offset:1024
    ds_read_b128 v[136:139], v20 offset:4096
    ds_read_b64_tr_b16 v[156:157], v27 offset:0
    ds_read_b64_tr_b16 v[158:159], v27 offset:1024
    ds_read_b128 v[140:143], v20 offset:6144
    s_waitcnt lgkmcnt(9)
    v_mfma_f32_16x16x32_bf16 v[64:67], v[144:147], v[128:131], 0
    ds_read_b64_tr_b16 v[176:177], v24 offset:8192
    s_add_u32 m0, s81, 65536
    s_waitcnt lgkmcnt(8)
    v_mfma_f32_16x16x32_bf16 v[80:83], v[148:151], v[128:131], 0
    ds_read_b64_tr_b16 v[178:179], v24 offset:9216
    buffer_load_dwordx4 v32, s[36:39], s8 offen offset:0 lds
    s_waitcnt lgkmcnt(8)
    v_mfma_f32_16x16x32_bf16 v[68:71], v[144:147], v[132:135], 0
    ds_read_b128 v[160:163], v21 offset:0
    v_mfma_f32_16x16x32_bf16 v[84:87], v[148:151], v[132:135], 0
    ds_read_b64_tr_b16 v[180:181], v25 offset:8192
    buffer_load_dwordx4 v33, s[36:39], s8 offen offset:1024 lds
    s_waitcnt lgkmcnt(8)
    v_mfma_f32_16x16x32_bf16 v[96:99], v[152:155], v[128:131], 0
    ds_read_b64_tr_b16 v[182:183], v25 offset:9216
    v_mfma_f32_16x16x32_bf16 v[100:103], v[152:155], v[132:135], 0
    ds_read_b128 v[164:167], v21 offset:2048
    buffer_load_dwordx4 v34, s[36:39], s8 offen offset:2048 lds
    s_waitcnt lgkmcnt(9)
    v_mfma_f32_16x16x32_bf16 v[72:75], v[144:147], v[136:139], 0
    ds_read_b64_tr_b16 v[184:185], v26 offset:8192
    v_mfma_f32_16x16x32_bf16 v[88:91], v[148:151], v[136:139], 0
    ds_read_b64_tr_b16 v[186:187], v26 offset:9216
    buffer_load_dwordx4 v35, s[36:39], s8 offen offset:3072 lds
    v_mfma_f32_16x16x32_bf16 v[104:107], v[152:155], v[136:139], 0
    ds_read_b128 v[168:171], v21 offset:4096
    s_add_u32 m0, s81, 81920
    s_waitcnt lgkmcnt(10)
    v_mfma_f32_16x16x32_bf16 v[112:115], v[156:159], v[128:131], 0
    ds_read_b64_tr_b16 v[188:189], v27 offset:8192
    buffer_load_dwordx4 v36, s[48:51], s9 offen offset:0 lds
    v_mfma_f32_16x16x32_bf16 v[116:119], v[156:159], v[132:135], 0
    ds_read_b64_tr_b16 v[190:191], v27 offset:9216
    v_mfma_f32_16x16x32_bf16 v[120:123], v[156:159], v[136:139], 0
    ds_read_b128 v[172:175], v21 offset:6144
    buffer_load_dwordx4 v37, s[48:51], s9 offen offset:1024 lds
    s_waitcnt lgkmcnt(12)
    v_mfma_f32_16x16x32_bf16 v[76:79], v[144:147], v[140:143], 0
    v_mfma_f32_16x16x32_bf16 v[92:95], v[148:151], v[140:143], 0
    buffer_load_dwordx4 v38, s[48:51], s9 offen offset:2048 lds
    v_mfma_f32_16x16x32_bf16 v[108:111], v[152:155], v[140:143], 0
    v_mfma_f32_16x16x32_bf16 v[124:127], v[156:159], v[140:143], 0
    buffer_load_dwordx4 v39, s[48:51], s9 offen offset:3072 lds
    v_mfma_f32_16x16x32_bf16 v[44:47], v[40:43], v[144:147], 0
    v_mfma_f32_16x16x32_bf16 v[48:51], v[40:43], v[148:151], 0
    s_add_u32 s8, s8, 128
    s_add_u32 s9, s9, 221184
    s_cmp_eq_u32 s85, 7
    s_cselect_b32 s83, 1280, 0
    s_cselect_b32 s82, 2211840, 0
    s_sub_u32 s8, s8, s83
    s_sub_u32 s9, s9, s82
    s_waitcnt vmcnt(8) lgkmcnt(0)
    s_barrier
    v_mfma_f32_16x16x32_bf16 v[64:67], v[176:179], v[160:163], v[64:67]
    ds_read_b64_tr_b16 v[144:145], v24 offset:32768
    s_add_u32 m0, s81, 98304
    v_mfma_f32_16x16x32_bf16 v[80:83], v[180:183], v[160:163], v[80:83]
    ds_read_b64_tr_b16 v[146:147], v24 offset:33792
    buffer_load_dwordx4 v32, s[36:39], s8 offen offset:0 lds
    v_mfma_f32_16x16x32_bf16 v[68:71], v[176:179], v[164:167], v[68:71]
    ds_read_b128 v[128:131], v20 offset:32768
    v_mfma_f32_16x16x32_bf16 v[84:87], v[180:183], v[164:167], v[84:87]
    ds_read_b64_tr_b16 v[148:149], v25 offset:32768
    buffer_load_dwordx4 v33, s[36:39], s8 offen offset:1024 lds
    v_mfma_f32_16x16x32_bf16 v[96:99], v[184:187], v[160:163], v[96:99]
    ds_read_b64_tr_b16 v[150:151], v25 offset:33792
    v_mfma_f32_16x16x32_bf16 v[100:103], v[184:187], v[164:167], v[100:103]
    ds_read_b128 v[132:135], v20 offset:34816
    buffer_load_dwordx4 v34, s[36:39], s8 offen offset:2048 lds
    v_mfma_f32_16x16x32_bf16 v[72:75], v[176:179], v[168:171], v[72:75]
    ds_read_b64_tr_b16 v[152:153], v26 offset:32768
    v_mfma_f32_16x16x32_bf16 v[88:91], v[180:183], v[168:171], v[88:91]
    ds_read_b64_tr_b16 v[154:155], v26 offset:33792
    buffer_load_dwordx4 v35, s[36:39], s8 offen offset:3072 lds
    v_mfma_f32_16x16x32_bf16 v[104:107], v[184:187], v[168:171], v[104:107]
    ds_read_b128 v[136:139], v20 offset:36864
    s_add_u32 m0, s81, 114688
    v_mfma_f32_16x16x32_bf16 v[112:115], v[188:191], v[160:163], v[112:115]
    ds_read_b64_tr_b16 v[156:157], v27 offset:32768
    buffer_load_dwordx4 v36, s[48:51], s9 offen offset:0 lds
    v_mfma_f32_16x16x32_bf16 v[116:119], v[188:191], v[164:167], v[116:119]
    ds_read_b64_tr_b16 v[158:159], v27 offset:33792
    v_mfma_f32_16x16x32_bf16 v[120:123], v[188:191], v[168:171], v[120:123]
    ds_read_b128 v[140:143], v20 offset:38912
    buffer_load_dwordx4 v37, s[48:51], s9 offen offset:1024 lds
    v_mfma_f32_16x16x32_bf16 v[76:79], v[176:179], v[172:175], v[76:79]
    v_mfma_f32_16x16x32_bf16 v[92:95], v[180:183], v[172:175], v[92:95]
    buffer_load_dwordx4 v38, s[48:51], s9 offen offset:2048 lds
    v_mfma_f32_16x16x32_bf16 v[108:111], v[184:187], v[172:175], v[108:111]
    v_mfma_f32_16x16x32_bf16 v[124:127], v[188:191], v[172:175], v[124:127]
    buffer_load_dwordx4 v39, s[48:51], s9 offen offset:3072 lds
    v_mfma_f32_16x16x32_bf16 v[44:47], v[40:43], v[176:179], v[44:47]
    s_add_u32 s8, s8, 128
    s_add_u32 s9, s9, 221184
    s_cmp_eq_u32 s85, 6
    s_cselect_b32 s83, 1280, 0
    s_cselect_b32 s82, 2211840, 0
    s_sub_u32 s8, s8, s83
    s_sub_u32 s9, s9, s82
    s_add_u32 m0, s22, 149504
    v_mfma_f32_16x16x32_bf16 v[48:51], v[40:43], v[180:183], v[48:51]
    buffer_load_dwordx4 v60, s[52:55], s26 offen nt lds
    s_add_u32 m0, s22, 153600
    s_nop 0
    buffer_load_dwordx4 v61, s[52:55], s26 offen nt lds
    s_add_u32 m0, s22, 157696
    s_nop 0
    buffer_load_dwordx4 v62, s[52:55], s26 offen nt lds
    s_waitcnt lgkmcnt(0)
    v_mfma_f32_16x16x32_bf16 v[64:67], v[144:147], v[128:131], v[64:67]
    ds_read_b64_tr_b16 v[176:177], v24 offset:40960
    s_add_u32 m0, s81, 0
    v_mfma_f32_16x16x32_bf16 v[80:83], v[148:151], v[128:131], v[80:83]
    ds_read_b64_tr_b16 v[178:179], v24 offset:41984
    buffer_load_dwordx4 v32, s[36:39], s8 offen offset:0 lds
    v_mfma_f32_16x16x32_bf16 v[68:71], v[144:147], v[132:135], v[68:71]
    ds_read_b128 v[160:163], v21 offset:32768
    v_mfma_f32_16x16x32_bf16 v[84:87], v[148:151], v[132:135], v[84:87]
    ds_read_b64_tr_b16 v[180:181], v25 offset:40960
    v_mfma_f32_16x16x32_bf16 v[96:99], v[152:155], v[128:131], v[96:99]
    ds_read_b64_tr_b16 v[182:183], v25 offset:41984
    v_mfma_f32_16x16x32_bf16 v[100:103], v[152:155], v[132:135], v[100:103]
    ds_read_b128 v[164:167], v21 offset:34816
    buffer_load_dwordx4 v33, s[36:39], s8 offen offset:1024 lds
    v_mfma_f32_16x16x32_bf16 v[72:75], v[144:147], v[136:139], v[72:75]
    ds_read_b64_tr_b16 v[184:185], v26 offset:40960
    v_mfma_f32_16x16x32_bf16 v[88:91], v[148:151], v[136:139], v[88:91]
    ds_read_b64_tr_b16 v[186:187], v26 offset:41984
    v_mfma_f32_16x16x32_bf16 v[104:107], v[152:155], v[136:139], v[104:107]
    ds_read_b128 v[168:171], v21 offset:36864
    v_mfma_f32_16x16x32_bf16 v[112:115], v[156:159], v[128:131], v[112:115]
    ds_read_b64_tr_b16 v[188:189], v27 offset:40960
    buffer_load_dwordx4 v34, s[36:39], s8 offen offset:2048 lds
    v_mfma_f32_16x16x32_bf16 v[116:119], v[156:159], v[132:135], v[116:119]
    ds_read_b64_tr_b16 v[190:191], v27 offset:41984
    v_mfma_f32_16x16x32_bf16 v[120:123], v[156:159], v[136:139], v[120:123]
    ds_read_b128 v[172:175], v21 offset:38912
    v_mfma_f32_16x16x32_bf16 v[76:79], v[144:147], v[140:143], v[76:79]
    v_mfma_f32_16x16x32_bf16 v[92:95], v[148:151], v[140:143], v[92:95]
    buffer_load_dwordx4 v35, s[36:39], s8 offen offset:3072 lds
    v_mfma_f32_16x16x32_bf16 v[108:111], v[152:155], v[140:143], v[108:111]
    v_mfma_f32_16x16x32_bf16 v[124:127], v[156:159], v[140:143], v[124:127]
    v_mfma_f32_16x16x32_bf16 v[44:47], v[40:43], v[144:147], v[44:47]
    v_mfma_f32_16x16x32_bf16 v[48:51], v[40:43], v[148:151], v[48:51]
    s_waitcnt vmcnt(15) lgkmcnt(0)
    s_cmp_lg_u32 s5, 0
    s_cbranch_scc1 Lz_3
    s_waitcnt vmcnt(23)
    v_readfirstlane_b32 s83, v240
    s_mov_b32 s82, 0
    s_nop 0
    s_cmp_ge_u32 s83, 1
    s_cbranch_scc1 Lok_4
Lspin_5:
    global_load_dword v240, v255, s[32:33] sc1
    s_waitcnt vmcnt(0)
    v_readfirstlane_b32 s83, v240
    s_add_u32 s82, s82, 1
    s_cmp_ge_u32 s82, 200000
    s_waitcnt lgkmcnt(0)
    s_cbranch_scc1 Lok_4
    s_cmp_lt_u32 s83, 1
    s_cbranch_scc1 Lspin_5
Lok_4:
Lz_3:
    s_barrier
    s_cmp_lg_u32 s5, 0
    s_cbranch_scc1 Lsig_6
    v_mov_b32 v14, 1
    s_mov_b64 exec, 1
    buffer_atomic_add v14, v255, s[60:63], s16 offen sc1
    buffer_atomic_add v14, v255, s[60:63], s76 offen sc1
    s_mov_b64 exec, -1
Lsig_6:
    s_nop 0
    v_mfma_f32_16x16x32_bf16 v[64:67], v[176:179], v[160:163], v[64:67]
    ds_read_b64_tr_b16 v[144:145], v28 offset:0
    s_add_u32 m0, s81, 16384
    v_mfma_f32_16x16x32_bf16 v[80:83], v[180:183], v[160:163], v[80:83]
    ds_read_b64_tr_b16 v[146:147], v28 offset:1024
    buffer_load_dwordx4 v36, s[48:51], s9 offen offset:0 lds
    v_mfma_f32_16x16x32_bf16 v[68:71], v[176:179], v[164:167], v[68:71]
    ds_read_b128 v[128:131], v22 offset:0
    v_mfma_f32_16x16x32_bf16 v[84:87], v[180:183], v[164:167], v[84:87]
    ds_read_b64_tr_b16 v[148:149], v29 offset:0
    v_mfma_f32_16x16x32_bf16 v[96:99], v[184:187], v[160:163], v[96:99]
    ds_read_b64_tr_b16 v[150:151], v29 offset:1024
    v_mfma_f32_16x16x32_bf16 v[100:103], v[184:187], v[164:167], v[100:103]
    ds_read_b128 v[132:135], v22 offset:2048
    buffer_load_dwordx4 v37, s[48:51], s9 offen offset:1024 lds
    v_mfma_f32_16x16x32_bf16 v[72:75], v[176:179], v[168:171], v[72:75]
    ds_read_b64_tr_b16 v[152:153], v30 offset:0
    v_mfma_f32_16x16x32_bf16 v[88:91], v[180:183], v[168:171], v[88:91]
    ds_read_b64_tr_b16 v[154:155], v30 offset:1024
    v_mfma_f32_16x16x32_bf16 v[104:107], v[184:187], v[168:171], v[104:107]
    ds_read_b128 v[136:139], v22 offset:4096
    v_mfma_f32_16x16x32_bf16 v[112:115], v[188:191], v[160:163], v[112:115]
    ds_read_b64_tr_b16 v[156:157], v31 offset:0
    buffer_load_dwordx4 v38, s[48:51], s9 offen offset:2048 lds
    v_mfma_f32_16x16x32_bf16 v[116:119], v[188:191], v[164:167], v[116:119]
    ds_read_b64_tr_b16 v[158:159], v31 offset:1024
    v_mfma_f32_16x16x32_bf16 v[120:123], v[188:191], v[168:171], v[120:123]
    ds_read_b128 v[140:143], v22 offset:6144
    v_mfma_f32_16x16x32_bf16 v[76:79], v[176:179], v[172:175], v[76:79]
    v_mfma_f32_16x16x32_bf16 v[92:95], v[180:183], v[172:175], v[92:95]
    buffer_load_dwordx4 v39, s[48:51], s9 offen offset:3072 lds
    v_mfma_f32_16x16x32_bf16 v[108:111], v[184:187], v[172:175], v[108:111]
    v_mfma_f32_16x16x32_bf16 v[124:127], v[188:191], v[172:175], v[124:127]
    v_mfma_f32_16x16x32_bf16 v[44:47], v[40:43], v[176:179], v[44:47]
    v_mfma_f32_16x16x32_bf16 v[48:51], v[40:43], v[180:183], v[48:51]
    s_add_u32 s8, s8, 128
    s_add_u32 s9, s9, 221184
    s_cmp_eq_u32 s85, 5
    s_cselect_b32 s83, 1280, 0
    s_cselect_b32 s82, 2211840, 0
    s_sub_u32 s8, s8, s83
    s_sub_u32 s9, s9, s82
    s_waitcnt lgkmcnt(0)
    v_mfma_f32_16x16x32_bf16 v[64:67], v[144:147], v[128:131], v[64:67]
    ds_read_b64_tr_b16 v[176:177], v28 offset:8192
    s_add_u32 m0, s81, 32768
    v_mfma_f32_16x16x32_bf16 v[80:83], v[148:151], v[128:131], v[80:83]
    ds_read_b64_tr_b16 v[178:179], v28 offset:9216
    buffer_load_dwordx4 v32, s[36:39], s8 offen offset:0 lds
    v_mfma_f32_16x16x32_bf16 v[68:71], v[144:147], v[132:135], v[68:71]
    ds_read_b128 v[160:163], v23 offset:0
    v_mfma_f32_16x16x32_bf16 v[84:87], v[148:151], v[132:135], v[84:87]
    ds_read_b64_tr_b16 v[180:181], v29 offset:8192
    v_mfma_f32_16x16x32_bf16 v[96:99], v[152:155], v[128:131], v[96:99]
    ds_read_b64_tr_b16 v[182:183], v29 offset:9216
    v_mfma_f32_16x16x32_bf16 v[100:103], v[152:155], v[132:135], v[100:103]
    ds_read_b128 v[164:167], v23 offset:2048
    buffer_load_dwordx4 v33, s[36:39], s8 offen offset:1024 lds
    v_mfma_f32_16x16x32_bf16 v[72:75], v[144:147], v[136:139], v[72:75]
    ds_read_b64_tr_b16 v[184:185], v30 offset:8192
    v_mfma_f32_16x16x32_bf16 v[88:91], v[148:151], v[136:139], v[88:91]
    ds_read_b64_tr_b16 v[186:187], v30 offset:9216
    v_mfma_f32_16x16x32_bf16 v[104:107], v[152:155], v[136:139], v[104:107]
    ds_read_b128 v[168:171], v23 offset:4096
    v_mfma_f32_16x16x32_bf16 v[112:115], v[156:159], v[128:131], v[112:115]
    ds_read_b64_tr_b16 v[188:189], v31 offset:8192
    buffer_load_dwordx4 v34, s[36:39], s8 offen offset:2048 lds
    v_mfma_f32_16x16x32_bf16 v[116:119], v[156:159], v[132:135], v[116:119]
    ds_read_b64_tr_b16 v[190:191], v31 offset:9216
    v_mfma_f32_16x16x32_bf16 v[120:123], v[156:159], v[136:139], v[120:123]
    ds_read_b128 v[172:175], v23 offset:6144
    v_mfma_f32_16x16x32_bf16 v[76:79], v[144:147], v[140:143], v[76:79]
    v_mfma_f32_16x16x32_bf16 v[92:95], v[148:151], v[140:143], v[92:95]
    buffer_load_dwordx4 v35, s[36:39], s8 offen offset:3072 lds
    v_mfma_f32_16x16x32_bf16 v[108:111], v[152:155], v[140:143], v[108:111]
    v_mfma_f32_16x16x32_bf16 v[124:127], v[156:159], v[140:143], v[124:127]
    v_mfma_f32_16x16x32_bf16 v[44:47], v[40:43], v[144:147], v[44:47]
    v_mfma_f32_16x16x32_bf16 v[48:51], v[40:43], v[148:151], v[48:51]
    s_waitcnt vmcnt(15) lgkmcnt(0)
    s_waitcnt vmcnt(12)
    s_barrier
    v_mfma_f32_16x16x32_bf16 v[64:67], v[176:179], v[160:163], v[64:67]
    ds_read_b64_tr_b16 v[144:145], v28 offset:32768
    s_add_u32 m0, s81, 49152
    v_mfma_f32_16x16x32_bf16 v[80:83], v[180:183], v[160:163], v[80:83]
    ds_read_b64_tr_b16 v[146:147], v28 offset:33792
    buffer_load_dwordx4 v36, s[48:51], s9 offen offset:0 lds
    v_mfma_f32_16x16x32_bf16 v[68:71], v[176:179], v[164:167], v[68:71]
    ds_read_b128 v[128:131], v22 offset:32768
    v_mfma_f32_16x16x32_bf16 v[84:87], v[180:183], v[164:167], v[84:87]
    ds_read_b64_tr_b16 v[148:149], v29 offset:32768
    v_mfma_f32_16x16x32_bf16 v[96:99], v[184:187], v[160:163], v[96:99]
    ds_read_b64_tr_b16 v[150:151], v29 offset:33792
    v_mfma_f32_16x16x32_bf16 v[100:103], v[184:187], v[164:167], v[100:103]
    ds_read_b128 v[132:135], v22 offset:34816
    buffer_load_dwordx4 v37, s[48:51], s9 offen offset:1024 lds
    v_mfma_f32_16x16x32_bf16 v[72:75], v[176:179], v[168:171], v[72:75]
    ds_read_b64_tr_b16 v[152:153], v30 offset:32768
    v_mfma_f32_16x16x32_bf16 v[88:91], v[180:183], v[168:171], v[88:91]
    ds_read_b64_tr_b16 v[154:155], v30 offset:33792
    v_mfma_f32_16x16x32_bf16 v[104:107], v[184:187], v[168:171], v[104:107]
    ds_read_b128 v[136:139], v22 offset:36864
    v_mfma_f32_16x16x32_bf16 v[112:115], v[188:191], v[160:163], v[112:115]
    ds_read_b64_tr_b16 v[156:157], v31 offset:32768
    buffer_load_dwordx4 v38, s[48:51], s9 offen offset:2048 lds
    v_mfma_f32_16x16x32_bf16 v[116:119], v[188:191], v[164:167], v[116:119]
    ds_read_b64_tr_b16 v[158:159], v31 offset:33792
    v_mfma_f32_16x16x32_bf16 v[120:123], v[188:191], v[168:171], v[120:123]
    ds_read_b128 v[140:143], v22 offset:38912
    v_mfma_f32_16x16x32_bf16 v[76:79], v[176:179], v[172:175], v[76:79]
    ds_read_b64_tr_b16 v[228:229], v63 offset:0
    ds_read_b64_tr_b16 v[230:231], v63 offset:5120
    v_mfma_f32_16x16x32_bf16 v[92:95], v[180:183], v[172:175], v[92:95]
    buffer_load_dwordx4 v39, s[48:51], s9 offen offset:3072 lds
    ds_read_b64_tr_b16 v[232:233], v63 offset:128
    v_mfma_f32_16x16x32_bf16 v[108:111], v[184:187], v[172:175], v[108:111]
    ds_read_b64_tr_b16 v[234:235], v63 offset:5248
    ds_read_b64_tr_b16 v[236:237], v63 offset:256
    v_mfma_f32_16x16x32_bf16 v[124:127], v[188:191], v[172:175], v[124:127]
    ds_read_b64_tr_b16 v[238:239], v63 offset:5376
    v_mfma_f32_16x16x32_bf16 v[44:47], v[40:43], v[176:179], v[44:47]
    v_mfma_f32_16x16x32_bf16 v[48:51], v[40:43], v[180:183], v[48:51]
    s_add_u32 s8, s8, 128
    s_add_u32 s9, s9, 221184
    s_cmp_eq_u32 s85, 4
    s_cselect_b32 s83, 1280, 0
    s_cselect_b32 s82, 2211840, 0
    s_sub_u32 s8, s8, s83
    s_sub_u32 s9, s9, s82
    s_waitcnt lgkmcnt(0)
    v_mfma_f32_16x16x32_bf16 v[64:67], v[144:147], v[128:131], v[64:67]
    ds_read_b64_tr_b16 v[176:177], v28 offset:40960
    v_mfma_f32_16x16x32_bf16 v[80:83], v[148:151], v[128:131], v[80:83]
    ds_read_b64_tr_b16 v[178:179], v28 offset:41984
    buffer_store_dwordx4 v[228:231], v252, s[60:63], s96 offen sc1
    v_mfma_f32_16x16x32_bf16 v[68:71], v[144:147], v[132:135], v[68:71]
    ds_read_b128 v[160:163], v23 offset:32768
    v_mfma_f32_16x16x32_bf16 v[84:87], v[148:151], v[132:135], v[84:87]
    ds_read_b64_tr_b16 v[180:181], v29 offset:40960
    buffer_store_dwordx4 v[232:235], v252, s[60:63], s97 offen sc1
    v_mfma_f32_16x16x32_bf16 v[96:99], v[152:155], v[128:131], v[96:99]
    ds_read_b64_tr_b16 v[182:183], v29 offset:41984
    v_mfma_f32_16x16x32_bf16 v[100:103], v[152:155], v[132:135], v[100:103]
    ds_read_b128 v[164:167], v23 offset:34816
    buffer_store_dwordx4 v[236:239], v252, s[60:63], s98 offen sc1
    v_mfma_f32_16x16x32_bf16 v[72:75], v[144:147], v[136:139], v[72:75]
    ds_read_b64_tr_b16 v[184:185], v30 offset:40960
    s_add_u32 m0, s81, 65536
    v_mfma_f32_16x16x32_bf16 v[88:91], v[148:151], v[136:139], v[88:91]
    ds_read_b64_tr_b16 v[186:187], v30 offset:41984
    buffer_load_dwordx4 v32, s[36:39], s8 offen offset:0 lds
    v_mfma_f32_16x16x32_bf16 v[104:107], v[152:155], v[136:139], v[104:107]
    ds_read_b128 v[168:171], v23 offset:36864
    v_mfma_f32_16x16x32_bf16 v[112:115], v[156:159], v[128:131], v[112:115]
    ds_read_b64_tr_b16 v[188:189], v31 offset:40960
    v_mfma_f32_16x16x32_bf16 v[116:119], v[156:159], v[132:135], v[116:119]
    ds_read_b64_tr_b16 v[190:191], v31 offset:41984
    buffer_load_dwordx4 v33, s[36:39], s8 offen offset:1024 lds
    v_mfma_f32_16x16x32_bf16 v[120:123], v[156:159], v[136:139], v[120:123]
    ds_read_b128 v[172:175], v23 offset:38912
    v_mfma_f32_16x16x32_bf16 v[76:79], v[144:147], v[140:143], v[76:79]
    buffer_load_dwordx4 v34, s[36:39], s8 offen offset:2048 lds
    v_mfma_f32_16x16x32_bf16 v[92:95], v[148:151], v[140:143], v[92:95]
    v_mfma_f32_16x16x32_bf16 v[108:111], v[152:155], v[140:143], v[108:111]
    buffer_load_dwordx4 v35, s[36:39], s8 offen offset:3072 lds
    v_mfma_f32_16x16x32_bf16 v[124:127], v[156:159], v[140:143], v[124:127]
    v_mfma_f32_16x16x32_bf16 v[44:47], v[40:43], v[144:147], v[44:47]
    v_mfma_f32_16x16x32_bf16 v[48:51], v[40:43], v[148:151], v[48:51]
    s_waitcnt vmcnt(15) lgkmcnt(0)
    s_barrier
    v_mfma_f32_16x16x32_bf16 v[64:67], v[176:179], v[160:163], v[64:67]
    ds_read_b64_tr_b16 v[144:145], v24 offset:0
    s_add_u32 m0, s81, 81920
    v_mfma_f32_16x16x32_bf16 v[80:83], v[180:183], v[160:163], v[80:83]
    ds_read_b64_tr_b16 v[146:147], v24 offset:1024
    buffer_load_dwordx4 v36, s[48:51], s9 offen offset:0 lds
    v_mfma_f32_16x16x32_bf16 v[68:71], v[176:179], v[164:167], v[68:71]
    ds_read_b128 v[128:131], v20 offset:0
    v_mfma_f32_16x16x32_bf16 v[84:87], v[180:183], v[164:167], v[84:87]
    ds_read_b64_tr_b16 v[148:149], v25 offset:0
    v_mfma_f32_16x16x32_bf16 v[96:99], v[184:187], v[160:163], v[96:99]
    ds_read_b64_tr_b16 v[150:151], v25 offset:1024
    v_mfma_f32_16x16x32_bf16 v[100:103], v[184:187], v[164:167], v[100:103]
    ds_read_b128 v[132:135], v20 offset:2048
    buffer_load_dwordx4 v37, s[48:51], s9 offen offset:1024 lds
    v_mfma_f32_16x16x32_bf16 v[72:75], v[176:179], v[168:171], v[72:75]
    ds_read_b64_tr_b16 v[152:153], v26 offset:0
    v_mfma_f32_16x16x32_bf16 v[88:91], v[180:183], v[168:171], v[88:91]
    ds_read_b64_tr_b16 v[154:155], v26 offset:1024
    v_mfma_f32_16x16x32_bf16 v[104:107], v[184:187], v[168:171], v[104:107]
    ds_read_b128 v[136:139], v20 offset:4096
    v_mfma_f32_16x16x32_bf16 v[112:115], v[188:191], v[160:163], v[112:115]
    ds_read_b64_tr_b16 v[156:157], v27 offset:0
    buffer_load_dwordx4 v38, s[48:51], s9 offen offset:2048 lds
    v_mfma_f32_16x16x32_bf16 v[116:119], v[188:191], v[164:167], v[116:119]
    ds_read_b64_tr_b16 v[158:159], v27 offset:1024
    v_mfma_f32_16x16x32_bf16 v[120:123], v[188:191], v[168:171], v[120:123]
    ds_read_b128 v[140:143], v20 offset:6144
    v_mfma_f32_16x16x32_bf16 v[76:79], v[176:179], v[172:175], v[76:79]
    v_mfma_f32_16x16x32_bf16 v[92:95], v[180:183], v[172:175], v[92:95]
    buffer_load_dwordx4 v39, s[48:51], s9 offen offset:3072 lds
    v_mfma_f32_16x16x32_bf16 v[108:111], v[184:187], v[172:175], v[108:111]
    v_mfma_f32_16x16x32_bf16 v[124:127], v[188:191], v[172:175], v[124:127]
    v_mfma_f32_16x16x32_bf16 v[44:47], v[40:43], v[176:179], v[44:47]
    v_mfma_f32_16x16x32_bf16 v[48:51], v[40:43], v[180:183], v[48:51]
    s_add_u32 s8, s8, 128
    s_add_u32 s9, s9, 221184
    s_cmp_eq_u32 s85, 3
    s_cselect_b32 s83, 1280, 0
    s_cselect_b32 s82, 2211840, 0
    s_sub_u32 s8, s8, s83
    s_sub_u32 s9, s9, s82
    s_waitcnt lgkmcnt(0)
    v_mfma_f32_16x16x32_bf16 v[64:67], v[144:147], v[128:131], v[64:67]
    ds_read_b64_tr_b16 v[176:177], v24 offset:8192
    s_add_u32 m0, s81, 98304
    v_mfma_f32_16x16x32_bf16 v[80:83], v[148:151], v[128:131], v[80:83]
    ds_read_b64_tr_b16 v[178:179], v24 offset:9216
    buffer_load_dwordx4 v32, s[36:39], s8 offen offset:0 lds
    v_mfma_f32_16x16x32_bf16 v[68:71], v[144:147], v[132:135], v[68:71]
    ds_read_b128 v[160:163], v21 offset:0
    v_mfma_f32_16x16x32_bf16 v[84:87], v[148:151], v[132:135], v[84:87]
    ds_read_b64_tr_b16 v[180:181], v25 offset:8192
    v_mfma_f32_16x16x32_bf16 v[96:99], v[152:155], v[128:131], v[96:99]
    ds_read_b64_tr_b16 v[182:183], v25 offset:9216
    v_mfma_f32_16x16x32_bf16 v[100:103], v[152:155], v[132:135], v[100:103]
    ds_read_b128 v[164:167], v21 offset:2048
    buffer_load_dwordx4 v33, s[36:39], s8 offen offset:1024 lds
    v_mfma_f32_16x16x32_bf16 v[72:75], v[144:147], v[136:139], v[72:75]
    ds_read_b64_tr_b16 v[184:185], v26 offset:8192
    v_mfma_f32_16x16x32_bf16 v[88:91], v[148:151], v[136:139], v[88:91]
    ds_read_b64_tr_b16 v[186:187], v26 offset:9216
    v_mfma_f32_16x16x32_bf16 v[104:107], v[152:155], v[136:139], v[104:107]
    ds_read_b128 v[168:171], v21 offset:4096
    v_mfma_f32_16x16x32_bf16 v[112:115], v[156:159], v[128:131], v[112:115]
    ds_read_b64_tr_b16 v[188:189], v27 offset:8192
    buffer_load_dwordx4 v34, s[36:39], s8 offen offset:2048 lds
    v_mfma_f32_16x16x32_bf16 v[116:119], v[156:159], v[132:135], v[116:119]
    ds_read_b64_tr_b16 v[190:191], v27 offset:9216
    v_mfma_f32_16x16x32_bf16 v[120:123], v[156:159], v[136:139], v[120:123]
    ds_read_b128 v[172:175], v21 offset:6144
    v_mfma_f32_16x16x32_bf16 v[76:79], v[144:147], v[140:143], v[76:79]
    v_mfma_f32_16x16x32_bf16 v[92:95], v[148:151], v[140:143], v[92:95]
    buffer_load_dwordx4 v35, s[36:39], s8 offen offset:3072 lds
    v_mfma_f32_16x16x32_bf16 v[108:111], v[152:155], v[140:143], v[108:111]
    v_mfma_f32_16x16x32_bf16 v[124:127], v[156:159], v[140:143], v[124:127]
    v_mfma_f32_16x16x32_bf16 v[44:47], v[40:43], v[144:147], v[44:47]
    v_mfma_f32_16x16x32_bf16 v[48:51], v[40:43], v[148:151], v[48:51]
    s_waitcnt vmcnt(15) lgkmcnt(0)
    s_waitcnt vmcnt(12)
    s_barrier
    s_cmp_lg_u32 s5, 0
    s_cbranch_scc1 Lsig_7
    v_mov_b32 v14, 1
    s_mov_b64 exec, 1
    buffer_atomic_add v14, v255, s[60:63], s23 offen sc1
    s_mov_b64 exec, -1
Lsig_7:
    s_nop 0
    v_mfma_f32_16x16x32_bf16 v[64:67], v[176:179], v[160:163], v[64:67]
    ds_read_b64_tr_b16 v[144:145], v24 offset:32768
    s_add_u32 m0, s81, 114688
    v_mfma_f32_16x16x32_bf16 v[80:83], v[180:183], v[160:163], v[80:83]
    ds_read_b64_tr_b16 v[146:147], v24 offset:33792
    buffer_load_dwordx4 v36, s[48:51], s9 offen offset:0 lds
    v_mfma_f32_16x16x32_bf16 v[68:71], v[176:179], v[164:167], v[68:71]
    ds_read_b128 v[128:131], v20 offset:32768
    v_mfma_f32_16x16x32_bf16 v[84:87], v[180:183], v[164:167], v[84:87]
    ds_read_b64_tr_b16 v[148:149], v25 offset:32768
    v_mfma_f32_16x16x32_bf16 v[96:99], v[184:187], v[160:163], v[96:99]
    ds_read_b64_tr_b16 v[150:151], v25 offset:33792
    v_mfma_f32_16x16x32_bf16 v[100:103], v[184:187], v[164:167], v[100:103]
    ds_read_b128 v[132:135], v20 offset:34816
    buffer_load_dwordx4 v37, s[48:51], s9 offen offset:1024 lds
    v_mfma_f32_16x16x32_bf16 v[72:75], v[176:179], v[168:171], v[72:75]
    ds_read_b64_tr_b16 v[152:153], v26 offset:32768
    v_mfma_f32_16x16x32_bf16 v[88:91], v[180:183], v[168:171], v[88:91]
    ds_read_b64_tr_b16 v[154:155], v26 offset:33792
    v_mfma_f32_16x16x32_bf16 v[104:107], v[184:187], v[168:171], v[104:107]
    ds_read_b128 v[136:139], v20 offset:36864
    v_mfma_f32_16x16x32_bf16 v[112:115], v[188:191], v[160:163], v[112:115]
    ds_read_b64_tr_b16 v[156:157], v27 offset:32768
    buffer_load_dwordx4 v38, s[48:51], s9 offen offset:2048 lds
    v_mfma_f32_16x16x32_bf16 v[116:119], v[188:191], v[164:167], v[116:119]
    ds_read_b64_tr_b16 v[158:159], v27 offset:33792
    v_mfma_f32_16x16x32_bf16 v[120:123], v[188:191], v[168:171], v[120:123]
    ds_read_b128 v[140:143], v20 offset:38912
    v_mfma_f32_16x16x32_bf16 v[76:79], v[176:179], v[172:175], v[76:79]
    v_mfma_f32_16x16x32_bf16 v[92:95], v[180:183], v[172:175], v[92:95]
    buffer_load_dwordx4 v39, s[48:51], s9 offen offset:3072 lds
    v_mfma_f32_16x16x32_bf16 v[108:111], v[184:187], v[172:175], v[108:111]
    v_mfma_f32_16x16x32_bf16 v[124:127], v[188:191], v[172:175], v[124:127]
    v_mfma_f32_16x16x32_bf16 v[44:47], v[40:43], v[176:179], v[44:47]
    v_mfma_f32_16x16x32_bf16 v[48:51], v[40:43], v[180:183], v[48:51]
    s_add_u32 s8, s8, 128
    s_add_u32 s9, s9, 221184
    s_cmp_eq_u32 s85, 2
    s_cselect_b32 s83, 1280, 0
    s_cselect_b32 s82, 2211840, 0
    s_sub_u32 s8, s8, s83
    s_sub_u32 s9, s9, s82
    s_waitcnt lgkmcnt(0)
    v_mfma_f32_16x16x32_bf16 v[64:67], v[144:147], v[128:131], v[64:67]
    ds_read_b64_tr_b16 v[176:177], v24 offset:40960
    s_add_u32 m0, s81, 0
    v_mfma_f32_16x16x32_bf16 v[80:83], v[148:151], v[128:131], v[80:83]
    ds_read_b64_tr_b16 v[178:179], v24 offset:41984
    buffer_load_dwordx4 v32, s[36:39], s8 offen offset:0 lds
    v_mfma_f32_16x16x32_bf16 v[68:71], v[144:147], v[132:135], v[68:71]
    ds_read_b128 v[160:163], v21 offset:32768
    v_mfma_f32_16x16x32_bf16 v[84:87], v[148:151], v[132:135], v[84:87]
    ds_read_b64_tr_b16 v[180:181], v25 offset:40960
    v_mfma_f32_16x16x32_bf16 v[96:99], v[152:155], v[128:131], v[96:99]
    ds_read_b64_tr_b16 v[182:183], v25 offset:41984
    v_mfma_f32_16x16x32_bf16 v[100:103], v[152:155], v[132:135], v[100:103]
    ds_read_b128 v[164:167], v21 offset:34816
    buffer_load_dwordx4 v33, s[36:39], s8 offen offset:1024 lds
    v_mfma_f32_16x16x32_bf16 v[72:75], v[144:147], v[136:139], v[72:75]
    ds_read_b64_tr_b16 v[184:185], v26 offset:40960
    v_mfma_f32_16x16x32_bf16 v[88:91], v[148:151], v[136:139], v[88:91]
    ds_read_b64_tr_b16 v[186:187], v26 offset:41984
    v_mfma_f32_16x16x32_bf16 v[104:107], v[152:155], v[136:139], v[104:107]
    ds_read_b128 v[168:171], v21 offset:36864
    v_mfma_f32_16x16x32_bf16 v[112:115], v[156:159], v[128:131], v[112:115]
    ds_read_b64_tr_b16 v[188:189], v27 offset:40960
    buffer_load_dwordx4 v34, s[36:39], s8 offen offset:2048 lds
    v_mfma_f32_16x16x32_bf16 v[116:119], v[156:159], v[132:135], v[116:119]
    ds_read_b64_tr_b16 v[190:191], v27 offset:41984
    v_mfma_f32_16x16x32_bf16 v[120:123], v[156:159], v[136:139], v[120:123]
    ds_read_b128 v[172:175], v21 offset:38912
    v_mfma_f32_16x16x32_bf16 v[76:79], v[144:147], v[140:143], v[76:79]
    v_mfma_f32_16x16x32_bf16 v[92:95], v[148:151], v[140:143], v[92:95]
    buffer_load_dwordx4 v35, s[36:39], s8 offen offset:3072 lds
    v_mfma_f32_16x16x32_bf16 v[108:111], v[152:155], v[140:143], v[108:111]
    v_mfma_f32_16x16x32_bf16 v[124:127], v[156:159], v[140:143], v[124:127]
    v_mfma_f32_16x16x32_bf16 v[44:47], v[40:43], v[144:147], v[44:47]
    v_mfma_f32_16x16x32_bf16 v[48:51], v[40:43], v[148:151], v[48:51]
    s_waitcnt vmcnt(12) lgkmcnt(0)
    s_barrier
    v_mfma_f32_16x16x32_bf16 v[64:67], v[176:179], v[160:163], v[64:67]
    ds_read_b64_tr_b16 v[144:145], v28 offset:0
    s_add_u32 m0, s81, 16384
    v_mfma_f32_16x16x32_bf16 v[80:83], v[180:183], v[160:163], v[80:83]
    ds_read_b64_tr_b16 v[146:147], v28 offset:1024
    buffer_load_dwordx4 v36, s[48:51], s9 offen offset:0 lds
    v_mfma_f32_16x16x32_bf16 v[68:71], v[176:179], v[164:167], v[68:71]
    ds_read_b128 v[128:131], v22 offset:0
    v_mfma_f32_16x16x32_bf16 v[84:87], v[180:183], v[164:167], v[84:87]
    ds_read_b64_tr_b16 v[148:149], v29 offset:0
    v_mfma_f32_16x16x32_bf16 v[96:99], v[184:187], v[160:163], v[96:99]
    ds_read_b64_tr_b16 v[150:151], v29 offset:1024
    v_mfma_f32_16x16x32_bf16 v[100:103], v[184:187], v[164:167], v[100:103]
    ds_read_b128 v[132:135], v22 offset:2048
    buffer_load_dwordx4 v37, s[48:51], s9 offen offset:1024 lds
    v_mfma_f32_16x16x32_bf16 v[72:75], v[176:179], v[168:171], v[72:75]
    ds_read_b64_tr_b16 v[152:153], v30 offset:0
    v_mfma_f32_16x16x32_bf16 v[88:91], v[180:183], v[168:171], v[88:91]
    ds_read_b64_tr_b16 v[154:155], v30 offset:1024
    v_mfma_f32_16x16x32_bf16 v[104:107], v[184:187], v[168:171], v[104:107]
    ds_read_b128 v[136:139], v22 offset:4096
    v_mfma_f32_16x16x32_bf16 v[112:115], v[188:191], v[160:163], v[112:115]
    ds_read_b64_tr_b16 v[156:157], v31 offset:0
    buffer_load_dwordx4 v38, s[48:51], s9 offen offset:2048 lds
    v_mfma_f32_16x16x32_bf16 v[116:119], v[188:191], v[164:167], v[116:119]
    ds_read_b64_tr_b16 v[158:159], v31 offset:1024
    v_mfma_f32_16x16x32_bf16 v[120:123], v[188:191], v[168:171], v[120:123]
    ds_read_b128 v[140:143], v22 offset:6144
    v_mfma_f32_16x16x32_bf16 v[76:79], v[176:179], v[172:175], v[76:79]
    v_mfma_f32_16x16x32_bf16 v[92:95], v[180:183], v[172:175], v[92:95]
    buffer_load_dwordx4 v39, s[48:51], s9 offen offset:3072 lds
    v_mfma_f32_16x16x32_bf16 v[108:111], v[184:187], v[172:175], v[108:111]
    v_mfma_f32_16x16x32_bf16 v[124:127], v[188:191], v[172:175], v[124:127]
    v_mfma_f32_16x16x32_bf16 v[44:47], v[40:43], v[176:179], v[44:47]
    v_mfma_f32_16x16x32_bf16 v[48:51], v[40:43], v[180:183], v[48:51]
    s_add_u32 s8, s8, 128
    s_add_u32 s9, s9, 221184
    s_cmp_eq_u32 s85, 1
    s_cselect_b32 s83, 1280, 0
    s_cselect_b32 s82, 2211840, 0
    s_sub_u32 s8, s8, s83
    s_sub_u32 s9, s9, s82
    s_waitcnt lgkmcnt(0)
    v_mfma_f32_16x16x32_bf16 v[64:67], v[144:147], v[128:131], v[64:67]
    ds_read_b64_tr_b16 v[176:177], v28 offset:8192
    s_add_u32 m0, s81, 32768
    v_mfma_f32_16x16x32_bf16 v[80:83], v[148:151], v[128:131], v[80:83]
    ds_read_b64_tr_b16 v[178:179], v28 offset:9216
    buffer_load_dwordx4 v32, s[36:39], s8 offen offset:0 lds
    v_mfma_f32_16x16x32_bf16 v[68:71], v[144:147], v[132:135], v[68:71]
    ds_read_b128 v[160:163], v23 offset:0
    v_mfma_f32_16x16x32_bf16 v[84:87], v[148:151], v[132:135], v[84:87]
    ds_read_b64_tr_b16 v[180:181], v29 offset:8192
    v_mfma_f32_16x16x32_bf16 v[96:99], v[152:155], v[128:131], v[96:99]
    ds_read_b64_tr_b16 v[182:183], v29 offset:9216
    v_mfma_f32_16x16x32_bf16 v[100:103], v[152:155], v[132:135], v[100:103]
    ds_read_b128 v[164:167], v23 offset:2048
    buffer_load_dwordx4 v33, s[36:39], s8 offen offset:1024 lds
    v_mfma_f32_16x16x32_bf16 v[72:75], v[144:147], v[136:139], v[72:75]
    ds_read_b64_tr_b16 v[184:185], v30 offset:8192
    v_mfma_f32_16x16x32_bf16 v[88:91], v[148:151], v[136:139], v[88:91]
    ds_read_b64_tr_b16 v[186:187], v30 offset:9216
    v_mfma_f32_16x16x32_bf16 v[104:107], v[152:155], v[136:139], v[104:107]
    ds_read_b128 v[168:171], v23 offset:4096
    v_mfma_f32_16x16x32_bf16 v[112:115], v[156:159], v[128:131], v[112:115]
    ds_read_b64_tr_b16 v[188:189], v31 offset:8192
    buffer_load_dwordx4 v34, s[36:39], s8 offen offset:2048 lds
    v_mfma_f32_16x16x32_bf16 v[116:119], v[156:159], v[132:135], v[116:119]
    ds_read_b64_tr_b16 v[190:191], v31 offset:9216
    v_mfma_f32_16x16x32_bf16 v[120:123], v[156:159], v[136:139], v[120:123]
    ds_read_b128 v[172:175], v23 offset:6144
    v_mfma_f32_16x16x32_bf16 v[76:79], v[144:147], v[140:143], v[76:79]
    v_mfma_f32_16x16x32_bf16 v[92:95], v[148:151], v[140:143], v[92:95]
    buffer_load_dwordx4 v35, s[36:39], s8 offen offset:3072 lds
    v_mfma_f32_16x16x32_bf16 v[108:111], v[152:155], v[140:143], v[108:111]
    v_mfma_f32_16x16x32_bf16 v[124:127], v[156:159], v[140:143], v[124:127]
    v_mfma_f32_16x16x32_bf16 v[44:47], v[40:43], v[144:147], v[44:47]
    v_mfma_f32_16x16x32_bf16 v[48:51], v[40:43], v[148:151], v[48:51]
    s_waitcnt vmcnt(12) lgkmcnt(0)
    s_barrier
    v_mfma_f32_16x16x32_bf16 v[64:67], v[176:179], v[160:163], v[64:67]
    ds_read_b64_tr_b16 v[144:145], v28 offset:32768
    s_add_u32 m0, s81, 49152
    v_mfma_f32_16x16x32_bf16 v[80:83], v[180:183], v[160:163], v[80:83]
    ds_read_b64_tr_b16 v[146:147], v28 offset:33792
    buffer_load_dwordx4 v36, s[48:51], s9 offen offset:0 lds
    v_mfma_f32_16x16x32_bf16 v[68:71], v[176:179], v[164:167], v[68:71]
    ds_read_b128 v[128:131], v22 offset:32768
    v_mfma_f32_16x16x32_bf16 v[84:87], v[180:183], v[164:167], v[84:87]
    ds_read_b64_tr_b16 v[148:149], v29 offset:32768
    buffer_load_dwordx4 v37, s[48:51], s9 offen offset:1024 lds
    v_mfma_f32_16x16x32_bf16 v[96:99], v[184:187], v[160:163], v[96:99]
    ds_read_b64_tr_b16 v[150:151], v29 offset:33792
    v_mfma_f32_16x16x32_bf16 v[100:103], v[184:187], v[164:167], v[100:103]
    ds_read_b128 v[132:135], v22 offset:34816
    buffer_load_dwordx4 v38, s[48:51], s9 offen offset:2048 lds
    v_mfma_f32_16x16x32_bf16 v[72:75], v[176:179], v[168:171], v[72:75]
    ds_read_b64_tr_b16 v[152:153], v30 offset:32768
    v_mfma_f32_16x16x32_bf16 v[88:91], v[180:183], v[168:171], v[88:91]
    ds_read_b64_tr_b16 v[154:155], v30 offset:33792
    buffer_load_dwordx4 v39, s[48:51], s9 offen offset:3072 lds
    v_mfma_f32_16x16x32_bf16 v[104:107], v[184:187], v[168:171], v[104:107]
    ds_read_b128 v[136:139], v22 offset:36864
    v_mfma_f32_16x16x32_bf16 v[112:115], v[188:191], v[160:163], v[112:115]
    ds_read_b64_tr_b16 v[156:157], v31 offset:32768
    s_mov_b32 m0, s99
    v_mfma_f32_16x16x32_bf16 v[116:119], v[188:191], v[164:167], v[116:119]
    ds_read_b64_tr_b16 v[158:159], v31 offset:33792
    global_load_ushort v244, v55, s[18:19]
    v_mfma_f32_16x16x32_bf16 v[120:123], v[188:191], v[168:171], v[120:123]
    ds_read_b128 v[140:143], v22 offset:38912
    v_mfma_f32_16x16x32_bf16 v[76:79], v[176:179], v[172:175], v[76:79]
    buffer_load_dwordx4 v252, s[56:59], s35 offen offset:0 lds
    s_cmp_lg_u32 s5, 0
    s_cbranch_scc1 Lz_8
    v_mov_b32 v243, 0
    s_mov_b64 exec, 7
    buffer_atomic_add v243, v241, s[60:63], 0 offen sc0 sc1
    s_mov_b64 exec, -1
Lz_8:
    s_nop 0
    v_mfma_f32_16x16x32_bf16 v[92:95], v[180:183], v[172:175], v[92:95]
    v_mfma_f32_16x16x32_bf16 v[108:111], v[184:187], v[172:175], v[108:111]
    buffer_load_dwordx4 v252, s[56:59], s35 offen offset:1024 lds
    v_mfma_f32_16x16x32_bf16 v[124:127], v[188:191], v[172:175], v[124:127]
    v_mfma_f32_16x16x32_bf16 v[44:47], v[40:43], v[176:179], v[44:47]
    v_mfma_f32_16x16x32_bf16 v[48:51], v[40:43], v[180:183], v[48:51]
    s_waitcnt lgkmcnt(0)
    v_mfma_f32_16x16x32_bf16 v[64:67], v[144:147], v[128:131], v[64:67]
    ds_read_b64_tr_b16 v[176:177], v28 offset:40960
    v_mfma_f32_16x16x32_bf16 v[80:83], v[148:151], v[128:131], v[80:83]
    ds_read_b64_tr_b16 v[178:179], v28 offset:41984
    global_load_dword v245, v[246:247], off
    v_mfma_f32_16x16x32_bf16 v[68:71], v[144:147], v[132:135], v[68:71]
    ds_read_b128 v[160:163], v23 offset:32768
    ds_write_b32 v56, v255
    v_mfma_f32_16x16x32_bf16 v[84:87], v[148:151], v[132:135], v[84:87]
    ds_read_b64_tr_b16 v[180:181], v29 offset:40960
    v_mfma_f32_16x16x32_bf16 v[96:99], v[152:155], v[128:131], v[96:99]
    ds_read_b64_tr_b16 v[182:183], v29 offset:41984
    ds_write_b32 v57, v255
    v_mfma_f32_16x16x32_bf16 v[100:103], v[152:155], v[132:135], v[100:103]
    ds_read_b128 v[164:167], v23 offset:34816
    v_mfma_f32_16x16x32_bf16 v[72:75], v[144:147], v[136:139], v[72:75]
    ds_read_b64_tr_b16 v[184:185], v30 offset:40960
    v_mov_b32 v227, 0
    v_mfma_f32_16x16x32_bf16 v[88:91], v[148:151], v[136:139], v[88:91]
    ds_read_b64_tr_b16 v[186:187], v30 offset:41984
    v_mfma_f32_16x16x32_bf16 v[104:107], v[152:155], v[136:139], v[104:107]
    ds_read_b128 v[168:171], v23 offset:36864
    v_mov_b32 v231, 0
    v_mfma_f32_16x16x32_bf16 v[112:115], v[156:159], v[128:131], v[112:115]
    ds_read_b64_tr_b16 v[188:189], v31 offset:40960
    v_mfma_f32_16x16x32_bf16 v[116:119], v[156:159], v[132:135], v[116:119]
    ds_read_b64_tr_b16 v[190:191], v31 offset:41984
    v_mov_b32 v235, 0
    v_mfma_f32_16x16x32_bf16 v[120:123], v[156:159], v[136:139], v[120:123]
    ds_read_b128 v[172:175], v23 offset:38912
    v_mfma_f32_16x16x32_bf16 v[76:79], v[144:147], v[140:143], v[76:79]
    v_mov_b32 v239, 0
    v_mfma_f32_16x16x32_bf16 v[92:95], v[148:151], v[140:143], v[92:95]
    v_mfma_f32_16x16x32_bf16 v[108:111], v[152:155], v[140:143], v[108:111]
    ds_write2_b32 v52, v255, v255 offset0:0 offset1:1
    v_mfma_f32_16x16x32_bf16 v[124:127], v[156:159], v[140:143], v[124:127]
    v_mfma_f32_16x16x32_bf16 v[44:47], v[40:43], v[144:147], v[44:47]
    ds_write2_b32 v52, v255, v255 offset0:2 offset1:3
    v_mfma_f32_16x16x32_bf16 v[48:51], v[40:43], v[148:151], v[48:51]
    s_waitcnt vmcnt(12) lgkmcnt(0)
    s_cmp_lg_u32 s5, 0
    s_cbranch_scc1 Lok_9
    s_mov_b32 s82, 0
    s_waitcnt vmcnt(2)
Lspin_10:
    v_cmp_gt_u32 vcc, v242, v243
    s_add_u32 s82, s82, 1
    s_cmp_ge_u32 s82, 200000
    s_cbranch_scc1 Lok_9
    s_and_b32 s83, vcc_lo, 7
    s_cbranch_scc0 Lok_9
    s_sleep 8
    v_mov_b32 v243, 0
    s_mov_b64 exec, 7
    buffer_atomic_add v243, v241, s[60:63], 0 offen sc0 sc1
    s_mov_b64 exec, -1
    s_waitcnt vmcnt(0)
    s_branch Lspin_10
Lok_9:
    s_barrier
    v_mfma_f32_16x16x32_bf16 v[64:67], v[176:179], v[160:163], v[64:67]
    ds_read_b64_tr_b16 v[144:145], v24 offset:0
    s_mov_b32 m0, s84
    v_mfma_f32_16x16x32_bf16 v[80:83], v[180:183], v[160:163], v[80:83]
    ds_read_b64_tr_b16 v[146:147], v24 offset:1024
    buffer_load_dwordx4 v252, s[60:63], s94 offen sc1 lds
    v_mfma_f32_16x16x32_bf16 v[68:71], v[176:179], v[164:167], v[68:71]
    ds_read_b128 v[128:131], v20 offset:0
    v_mfma_f32_16x16x32_bf16 v[84:87], v[180:183], v[164:167], v[84:87]
    ds_read_b64_tr_b16 v[148:149], v25 offset:0
    v_mfma_f32_16x16x32_bf16 v[96:99], v[184:187], v[160:163], v[96:99]
    ds_read_b64_tr_b16 v[150:151], v25 offset:1024
    s_add_u32 m0, s84, 1024
    s_add_u32 s94, s94, 32768
    v_mfma_f32_16x16x32_bf16 v[100:103], v[184:187], v[164:167], v[100:103]
    ds_read_b128 v[132:135], v20 offset:2048
    buffer_load_dwordx4 v252, s[60:63], s94 offen sc1 lds
    v_mfma_f32_16x16x32_bf16 v[72:75], v[176:179], v[168:171], v[72:75]
    ds_read_b64_tr_b16 v[152:153], v26 offset:0
    v_mfma_f32_16x16x32_bf16 v[88:91], v[180:183], v[168:171], v[88:91]
    ds_read_b64_tr_b16 v[154:155], v26 offset:1024
    v_mfma_f32_16x16x32_bf16 v[104:107], v[184:187], v[168:171], v[104:107]
    ds_read_b128 v[136:139], v20 offset:4096
    v_mfma_f32_16x16x32_bf16 v[112:115], v[188:191], v[160:163], v[112:115]
    ds_read_b64_tr_b16 v[156:157], v27 offset:0
    buffer_load_dwordx4 a[240:243], v252, s[60:63], s95 offen offset:0 sc1
    v_mfma_f32_16x16x32_bf16 v[116:119], v[188:191], v[164:167], v[116:119]
    ds_read_b64_tr_b16 v[158:159], v27 offset:1024
    v_mfma_f32_16x16x32_bf16 v[120:123], v[188:191], v[168:171], v[120:123]
    ds_read_b128 v[140:143], v20 offset:6144
    v_mfma_f32_16x16x32_bf16 v[76:79], v[176:179], v[172:175], v[76:79]
    v_mfma_f32_16x16x32_bf16 v[92:95], v[180:183], v[172:175], v[92:95]
    buffer_load_dwordx4 a[244:247], v252, s[60:63], s95 offen offset:1024 sc1
    v_mfma_f32_16x16x32_bf16 v[108:111], v[184:187], v[172:175], v[108:111]
    v_mfma_f32_16x16x32_bf16 v[124:127], v[188:191], v[172:175], v[124:127]
    v_mfma_f32_16x16x32_bf16 v[44:47], v[40:43], v[176:179], v[44:47]
    v_mfma_f32_16x16x32_bf16 v[48:51], v[40:43], v[180:183], v[48:51]
    s_waitcnt lgkmcnt(0)
    v_mfma_f32_16x16x32_bf16 v[64:67], v[144:147], v[128:131], v[64:67]
    ds_read_b64_tr_b16 v[176:177], v24 offset:8192
    v_mfma_f32_16x16x32_bf16 v[80:83], v[148:151], v[128:131], v[80:83]
    ds_read_b64_tr_b16 v[178:179], v24 offset:9216
    buffer_load_dwordx4 a[0:3], v252, s[60:63], s27 offen offset:0 sc1
    v_mfma_f32_16x16x32_bf16 v[68:71], v[144:147], v[132:135], v[68:71]
    ds_read_b128 v[160:163], v21 offset:0
    v_mfma_f32_16x16x32_bf16 v[84:87], v[148:151], v[132:135], v[84:87]
    ds_read_b64_tr_b16 v[180:181], v25 offset:8192
    v_mfma_f32_16x16x32_bf16 v[96:99], v[152:155], v[128:131], v[96:99]
    ds_read_b64_tr_b16 v[182:183], v25 offset:9216
    v_mfma_f32_16x16x32_bf16 v[100:103], v[152:155], v[132:135], v[100:103]
    ds_read_b128 v[164:167], v21 offset:2048
    buffer_load_dwordx4 a[4:7], v252, s[60:63], s27 offen offset:1024 sc1
    v_mfma_f32_16x16x32_bf16 v[72:75], v[144:147], v[136:139], v[72:75]
    ds_read_b64_tr_b16 v[184:185], v26 offset:8192
    v_mfma_f32_16x16x32_bf16 v[88:91], v[148:151], v[136:139], v[88:91]
    ds_read_b64_tr_b16 v[186:187], v26 offset:9216
    v_mfma_f32_16x16x32_bf16 v[104:107], v[152:155], v[136:139], v[104:107]
    ds_read_b128 v[168:171], v21 offset:4096
    v_mfma_f32_16x16x32_bf16 v[112:115], v[156:159], v[128:131], v[112:115]
    ds_read_b64_tr_b16 v[188:189], v27 offset:8192
    buffer_load_dwordx4 a[8:11], v252, s[60:63], s27 offen offset:2048 sc1
    v_mfma_f32_16x16x32_bf16 v[116:119], v[156:159], v[132:135], v[116:119]
    ds_read_b64_tr_b16 v[190:191], v27 offset:9216
    v_mfma_f32_16x16x32_bf16 v[120:123], v[156:159], v[136:139], v[120:123]
    ds_read_b128 v[172:175], v21 offset:6144
    v_mfma_f32_16x16x32_bf16 v[76:79], v[144:147], v[140:143], v[76:79]
    s_waitcnt vmcnt(8)
    ds_read_u16 v15, v58 offset:32
    v_mfma_f32_16x16x32_bf16 v[92:95], v[148:151], v[140:143], v[92:95]
    buffer_load_dwordx4 a[12:15], v252, s[60:63], s27 offen offset:3072 sc1
    v_mfma_f32_16x16x32_bf16 v[108:111], v[152:155], v[140:143], v[108:111]
    v_mfma_f32_16x16x32_bf16 v[124:127], v[156:159], v[140:143], v[124:127]
    v_mfma_f32_16x16x32_bf16 v[44:47], v[40:43], v[144:147], v[44:47]
    v_mfma_f32_16x16x32_bf16 v[48:51], v[40:43], v[148:151], v[48:51]
    s_waitcnt lgkmcnt(0)
    s_barrier
    v_mfma_f32_16x16x32_bf16 v[64:67], v[176:179], v[160:163], v[64:67]
    ds_read_b64_tr_b16 v[144:145], v24 offset:32768
    s_add_u32 s27, s27, 4096
    v_mfma_f32_16x16x32_bf16 v[80:83], v[180:183], v[160:163], v[80:83]
    ds_read_b64_tr_b16 v[146:147], v24 offset:33792
    buffer_load_dwordx4 a[16:19], v252, s[60:63], s27 offen offset:0 sc1
    v_mfma_f32_16x16x32_bf16 v[68:71], v[176:179], v[164:167], v[68:71]
    ds_read_b128 v[128:131], v20 offset:32768
    v_mfma_f32_16x16x32_bf16 v[84:87], v[180:183], v[164:167], v[84:87]
    ds_read_b64_tr_b16 v[148:149], v25 offset:32768
    v_mfma_f32_16x16x32_bf16 v[96:99], v[184:187], v[160:163], v[96:99]
    ds_read_b64_tr_b16 v[150:151], v25 offset:33792
    v_mfma_f32_16x16x32_bf16 v[100:103], v[184:187], v[164:167], v[100:103]
    ds_read_b128 v[132:135], v20 offset:34816
    buffer_load_dwordx4 a[20:23], v252, s[60:63], s27 offen offset:1024 sc1
    v_mfma_f32_16x16x32_bf16 v[72:75], v[176:179], v[168:171], v[72:75]
    ds_read_b64_tr_b16 v[152:153], v26 offset:32768
    v_mfma_f32_16x16x32_bf16 v[88:91], v[180:183], v[168:171], v[88:91]
    ds_read_b64_tr_b16 v[154:155], v26 offset:33792
    v_mfma_f32_16x16x32_bf16 v[104:107], v[184:187], v[168:171], v[104:107]
    ds_read_b128 v[136:139], v20 offset:36864
    v_mfma_f32_16x16x32_bf16 v[112:115], v[188:191], v[160:163], v[112:115]
    ds_read_b64_tr_b16 v[156:157], v27 offset:32768
    buffer_load_dwordx4 a[24:27], v252, s[60:63], s27 offen offset:2048 sc1
    v_mfma_f32_16x16x32_bf16 v[116:119], v[188:191], v[164:167], v[116:119]
    ds_read_b64_tr_b16 v[158:159], v27 offset:33792
    v_mfma_f32_16x16x32_bf16 v[120:123], v[188:191], v[168:171], v[120:123]
    ds_read_b128 v[140:143], v20 offset:38912
    v_mfma_f32_16x16x32_bf16 v[76:79], v[176:179], v[172:175], v[76:79]
    v_lshlrev_b32 v6, 16, v244
    v_lshlrev_b32 v15, 16, v15
    v_mfma_f32_16x16x32_bf16 v[92:95], v[180:183], v[172:175], v[92:95]
    buffer_load_dwordx4 a[28:31], v252, s[60:63], s27 offen offset:3072 sc1
    v_add_f32 v15, v15, v6
    v_mfma_f32_16x16x32_bf16 v[108:111], v[184:187], v[172:175], v[108:111]
    v_cvt_pk_bf16_f32 v15, v15, v15
    ds_write_b16 v58, v15 offset:32
    v_mfma_f32_16x16x32_bf16 v[124:127], v[188:191], v[172:175], v[124:127]
    v_mfma_f32_16x16x32_bf16 v[44:47], v[40:43], v[176:179], v[44:47]
    v_mfma_f32_16x16x32_bf16 v[48:51], v[40:43], v[180:183], v[48:51]
    s_waitcnt lgkmcnt(0)
    v_mfma_f32_16x16x32_bf16 v[64:67], v[144:147], v[128:131], v[64:67]
    ds_read_b64_tr_b16 v[176:177], v24 offset:40960
    s_add_u32 s27, s27, 4096
    v_mfma_f32_16x16x32_bf16 v[80:83], v[148:151], v[128:131], v[80:83]
    ds_read_b64_tr_b16 v[178:179], v24 offset:41984
    buffer_load_dwordx4 a[32:35], v252, s[60:63], s27 offen offset:0 sc1
    s_waitcnt vmcnt(11)
    v_mfma_f32_16x16x32_bf16 v[68:71], v[144:147], v[132:135], v[68:71]
    ds_read_b128 v[160:163], v21 offset:32768
    ds_read_b128 v[192:195], v54 offset:0
    v_mfma_f32_16x16x32_bf16 v[84:87], v[148:151], v[132:135], v[84:87]
    ds_read_b64_tr_b16 v[180:181], v25 offset:40960
    v_mfma_f32_16x16x32_bf16 v[96:99], v[152:155], v[128:131], v[96:99]
    ds_read_b64_tr_b16 v[182:183], v25 offset:41984
    ds_read_b128 v[208:211], v53 offset:1024
    v_mfma_f32_16x16x32_bf16 v[100:103], v[152:155], v[132:135], v[100:103]
    ds_read_b128 v[164:167], v21 offset:34816
    buffer_load_dwordx4 a[36:39], v252, s[60:63], s27 offen offset:1024 sc1
    v_mfma_f32_16x16x32_bf16 v[72:75], v[144:147], v[136:139], v[72:75]
    ds_read_b64_tr_b16 v[184:185], v26 offset:40960
    ds_read_b128 v[196:199], v54 offset:256
    v_mfma_f32_16x16x32_bf16 v[88:91], v[148:151], v[136:139], v[88:91]
    ds_read_b64_tr_b16 v[186:187], v26 offset:41984
    v_mfma_f32_16x16x32_bf16 v[104:107], v[152:155], v[136:139], v[104:107]
    ds_read_b128 v[168:171], v21 offset:36864
    ds_read_b128 v[212:215], v53 offset:1280
    v_mfma_f32_16x16x32_bf16 v[112:115], v[156:159], v[128:131], v[112:115]
    ds_read_b64_tr_b16 v[188:189], v27 offset:40960
    buffer_load_dwordx4 a[40:43], v252, s[60:63], s27 offen offset:2048 sc1
    v_mfma_f32_16x16x32_bf16 v[116:119], v[156:159], v[132:135], v[116:119]
    ds_read_b64_tr_b16 v[190:191], v27 offset:41984
    ds_read_b128 v[200:203], v54 offset:512
    v_mfma_f32_16x16x32_bf16 v[120:123], v[156:159], v[136:139], v[120:123]
    ds_read_b128 v[172:175], v21 offset:38912
    v_mfma_f32_16x16x32_bf16 v[76:79], v[144:147], v[140:143], v[76:79]
    ds_read_b128 v[216:219], v53 offset:1536
    v_mfma_f32_16x16x32_bf16 v[92:95], v[148:151], v[140:143], v[92:95]
    buffer_load_dwordx4 a[44:47], v252, s[60:63], s27 offen offset:3072 sc1
    v_mfma_f32_16x16x32_bf16 v[108:111], v[152:155], v[140:143], v[108:111]
    ds_read_b128 v[204:207], v54 offset:768
    v_mfma_f32_16x16x32_bf16 v[124:127], v[156:159], v[140:143], v[124:127]
    v_mfma_f32_16x16x32_bf16 v[44:47], v[40:43], v[144:147], v[44:47]
    ds_read_b128 v[220:223], v53 offset:1792
    v_mfma_f32_16x16x32_bf16 v[48:51], v[40:43], v[148:151], v[48:51]
    s_waitcnt lgkmcnt(0)
    v_mfma_f32_16x16x32_bf16 v[44:47], v[40:43], v[176:179], v[44:47]
    v_mfma_f32_16x16x32_bf16 v[48:51], v[40:43], v[180:183], v[48:51]
    v_mfma_f32_16x16x32_bf16 v[64:67], v[176:179], v[160:163], v[64:67]
    s_add_u32 s27, s27, 4096
    buffer_load_dwordx4 a[48:51], v252, s[60:63], s27 offen offset:0 sc1
    v_mfma_f32_16x16x32_bf16 v[80:83], v[180:183], v[160:163], v[80:83]
    v_mfma_f32_16x16x32_bf16 v[68:71], v[176:179], v[164:167], v[68:71]
    buffer_load_dwordx4 a[52:55], v252, s[60:63], s27 offen offset:1024 sc1
    v_mfma_f32_16x16x32_bf16 v[84:87], v[180:183], v[164:167], v[84:87]
    v_mfma_f32_16x16x32_bf16 v[96:99], v[184:187], v[160:163], v[96:99]
    buffer_load_dwordx4 a[56:59], v252, s[60:63], s27 offen offset:2048 sc1
    buffer_load_dwordx4 a[60:63], v252, s[60:63], s27 offen offset:3072 sc1
    ds_write2_b32 v16, v44, v48 offset1:16
    v_mfma_f32_16x16x32_bf16 v[100:103], v[184:187], v[164:167], v[100:103]
    v_mfma_f32_16x16x32_bf16 v[72:75], v[176:179], v[168:171], v[72:75]
    s_waitcnt lgkmcnt(0)
    s_barrier
    ds_read2_b32 v[18:19], v17 offset1:16
    v_mfma_f32_16x16x32_bf16 v[88:91], v[180:183], v[168:171], v[88:91]
    v_cvt_pk_bf16_f32 v6, v44, v44
    v_mov_b32 v226, v248
    v_mfma_f32_16x16x32_bf16 v[104:107], v[184:187], v[168:171], v[104:107]
    v_and_b32 v7, 0xffff0000, v6
    v_sub_f32 v7, v44, v7
    v_mfma_f32_16x16x32_bf16 v[112:115], v[188:191], v[160:163], v[112:115]
    v_and_b32 v6, 0xffff, v6
    v_cvt_pk_bf16_f32 v224, v44, v7
    v_mfma_f32_16x16x32_bf16 v[116:119], v[188:191], v[164:167], v[116:119]
    v_lshl_or_b32 v225, v248, 16, v6
    v_cvt_pk_bf16_f32 v6, v48, v48
    v_mfma_f32_16x16x32_bf16 v[120:123], v[188:191], v[168:171], v[120:123]
    v_mov_b32 v230, v249
    v_and_b32 v7, 0xffff0000, v6
    v_mfma_f32_16x16x32_bf16 v[76:79], v[176:179], v[172:175], v[76:79]
    v_sub_f32 v7, v48, v7
    v_mfma_f32_16x16x32_bf16 v[92:95], v[180:183], v[172:175], v[92:95]
    v_and_b32 v6, 0xffff, v6
    v_cvt_pk_bf16_f32 v228, v48, v7
    v_mfma_f32_16x16x32_bf16 v[108:111], v[184:187], v[172:175], v[108:111]
    v_lshl_or_b32 v229, v249, 16, v6
    s_waitcnt lgkmcnt(0)
    v_cvt_pk_bf16_f32 v6, v18, v18
    v_mov_b32 v234, v250
    v_mfma_f32_16x16x32_bf16 v[124:127], v[188:191], v[172:175], v[124:127]
    v_and_b32 v7, 0xffff0000, v6
    v_sub_f32 v7, v18, v7
    v_and_b32 v6, 0xffff, v6
    v_cvt_pk_bf16_f32 v232, v18, v7
    v_lshl_or_b32 v233, v250, 16, v6
    v_cvt_pk_bf16_f32 v6, v19, v19
    v_mov_b32 v238, v251
    v_and_b32 v7, 0xffff0000, v6
    v_sub_f32 v7, v19, v7
    v_and_b32 v6, 0xffff, v6
    v_cvt_pk_bf16_f32 v236, v19, v7
    v_lshl_or_b32 v237, v251, 16, v6
    v_mfma_f32_16x16x32_bf16 v[64:67], v[224:227], v[192:195], v[64:67]
    v_mfma_f32_16x16x32_bf16 v[80:83], v[228:231], v[192:195], v[80:83]
    v_mfma_f32_16x16x32_bf16 v[68:71], v[224:227], v[196:199], v[68:71]
    v_mfma_f32_16x16x32_bf16 v[84:87], v[228:231], v[196:199], v[84:87]
    s_add_u32 s27, s27, 4096
    buffer_load_dwordx4 a[64:67], v252, s[60:63], s27 offen offset:0 sc1
    v_mfma_f32_16x16x32_bf16 v[72:75], v[224:227], v[200:203], v[72:75]
    v_mfma_f32_16x16x32_bf16 v[88:91], v[228:231], v[200:203], v[88:91]
    v_mfma_f32_16x16x32_bf16 v[76:79], v[224:227], v[204:207], v[76:79]
    v_mfma_f32_16x16x32_bf16 v[92:95], v[228:231], v[204:207], v[92:95]
    buffer_load_dwordx4 a[68:71], v252, s[60:63], s27 offen offset:1024 sc1
    v_mfma_f32_16x16x32_bf16 v[96:99], v[232:235], v[192:195], v[96:99]
    v_mfma_f32_16x16x32_bf16 v[112:115], v[236:239], v[192:195], v[112:115]
    v_mfma_f32_16x16x32_bf16 v[100:103], v[232:235], v[196:199], v[100:103]
    v_mfma_f32_16x16x32_bf16 v[116:119], v[236:239], v[196:199], v[116:119]
    buffer_load_dwordx4 a[72:75], v252, s[60:63], s27 offen offset:2048 sc1
    v_mfma_f32_16x16x32_bf16 v[104:107], v[232:235], v[200:203], v[104:107]
    v_mfma_f32_16x16x32_bf16 v[120:123], v[236:239], v[200:203], v[120:123]
    v_mfma_f32_16x16x32_bf16 v[108:111], v[232:235], v[204:207], v[108:111]
    v_mfma_f32_16x16x32_bf16 v[124:127], v[236:239], v[204:207], v[124:127]
    buffer_load_dwordx4 a[76:79], v252, s[60:63], s27 offen offset:3072 sc1
    v_pk_mul_f32 v[128:129], v[64:65], v[64:65]
    v_pk_mul_f32 v[130:131], v[66:67], v[66:67]
    v_pk_mul_f32 v[132:133], v[80:81], v[80:81]
    s_add_u32 s27, s27, 4096
    s_cmp_eq_u32 s68, 4
    s_cselect_b32 s27, s74, s27
    v_pk_mul_f32 v[134:135], v[82:83], v[82:83]
    buffer_load_dwordx4 a[80:83], v252, s[60:63], s27 offen offset:0 sc1
    v_pk_fma_f32 v[128:129], v[128:129], v[208:209], v[208:209] op_sel:[0,1,0] op_sel_hi:[1,1,0]
    v_pk_fma_f32 v[130:131], v[130:131], v[208:209], v[208:209] op_sel:[0,1,0] op_sel_hi:[1,1,0]
    v_pk_fma_f32 v[132:133], v[132:133], v[208:209], v[208:209] op_sel:[0,1,0] op_sel_hi:[1,1,0]
    v_pk_fma_f32 v[134:135], v[134:135], v[208:209], v[208:209] op_sel:[0,1,0] op_sel_hi:[1,1,0]
    v_pk_mul_f32 v[128:129], v[128:129], v[64:65]
    v_pk_mul_f32 v[130:131], v[130:131], v[66:67]
    v_pk_mul_f32 v[132:133], v[132:133], v[80:81]
    v_pk_mul_f32 v[134:135], v[134:135], v[82:83]
    v_exp_f32 v128, v128
    v_exp_f32 v129, v129
    v_exp_f32 v130, v130
    buffer_load_dwordx4 a[84:87], v252, s[60:63], s27 offen offset:1024 sc1
    v_exp_f32 v131, v131
    v_exp_f32 v132, v132
    v_exp_f32 v133, v133
    v_exp_f32 v134, v134
    v_exp_f32 v135, v135
    v_pk_fma_f32 v[128:129], v[128:129], v[210:211], v[210:211] op_sel:[0,0,0] op_sel_hi:[1,0,0]
    v_pk_fma_f32 v[130:131], v[130:131], v[210:211], v[210:211] op_sel:[0,0,0] op_sel_hi:[1,0,0]
    v_pk_fma_f32 v[132:133], v[132:133], v[210:211], v[210:211] op_sel:[0,0,0] op_sel_hi:[1,0,0]
    v_pk_fma_f32 v[134:135], v[134:135], v[210:211], v[210:211] op_sel:[0,0,0] op_sel_hi:[1,0,0]
    v_rcp_f32 v128, v128
    v_rcp_f32 v129, v129
    buffer_load_dwordx4 a[88:91], v252, s[60:63], s27 offen offset:2048 sc1
    v_rcp_f32 v130, v130
    v_rcp_f32 v131, v131
    v_rcp_f32 v132, v132
    v_rcp_f32 v133, v133
    v_rcp_f32 v134, v134
    v_rcp_f32 v135, v135
    v_pk_mul_f32 v[136:137], v[128:129], v[64:65]
    v_pk_mul_f32 v[138:139], v[130:131], v[66:67]
    v_pk_mul_f32 v[140:141], v[132:133], v[80:81]
    v_pk_mul_f32 v[142:143], v[134:135], v[82:83]
    v_cvt_pk_bf16_f32 v160, v136, v137
    v_cvt_pk_bf16_f32 v161, v138, v139
    v_cvt_pk_bf16_f32 v162, v140, v141
    v_cvt_pk_bf16_f32 v163, v142, v143
    buffer_store_dwordx4 v[160:163], v252, s[60:63], s92 offen offset:0 sc1
    v_pk_mul_f32 v[144:145], v[68:69], v[68:69]
    v_pk_mul_f32 v[146:147], v[70:71], v[70:71]
    v_pk_mul_f32 v[148:149], v[84:85], v[84:85]
    v_pk_mul_f32 v[150:151], v[86:87], v[86:87]
    buffer_load_dwordx4 a[92:95], v252, s[60:63], s27 offen offset:3072 sc1
    v_pk_fma_f32 v[144:145], v[144:145], v[212:213], v[212:213] op_sel:[0,1,0] op_sel_hi:[1,1,0]
    v_pk_fma_f32 v[146:147], v[146:147], v[212:213], v[212:213] op_sel:[0,1,0] op_sel_hi:[1,1,0]
    v_pk_fma_f32 v[148:149], v[148:149], v[212:213], v[212:213] op_sel:[0,1,0] op_sel_hi:[1,1,0]
    v_pk_fma_f32 v[150:151], v[150:151], v[212:213], v[212:213] op_sel:[0,1,0] op_sel_hi:[1,1,0]
    v_pk_mul_f32 v[144:145], v[144:145], v[68:69]
    v_pk_mul_f32 v[146:147], v[146:147], v[70:71]
    v_pk_mul_f32 v[148:149], v[148:149], v[84:85]
    v_pk_mul_f32 v[150:151], v[150:151], v[86:87]
    v_exp_f32 v144, v144
    v_exp_f32 v145, v145
    s_add_u32 s27, s27, 4096
    v_exp_f32 v146, v146
    buffer_load_dwordx4 a[96:99], v252, s[60:63], s27 offen offset:0 sc1
    v_exp_f32 v147, v147
    v_exp_f32 v148, v148
    v_exp_f32 v149, v149
    v_exp_f32 v150, v150
    v_exp_f32 v151, v151
    v_pk_fma_f32 v[144:145], v[144:145], v[214:215], v[214:215] op_sel:[0,0,0] op_sel_hi:[1,0,0]
    v_pk_fma_f32 v[146:147], v[146:147], v[214:215], v[214:215] op_sel:[0,0,0] op_sel_hi:[1,0,0]
    v_pk_fma_f32 v[148:149], v[148:149], v[214:215], v[214:215] op_sel:[0,0,0] op_sel_hi:[1,0,0]
    v_pk_fma_f32 v[150:151], v[150:151], v[214:215], v[214:215] op_sel:[0,0,0] op_sel_hi:[1,0,0]
    v_rcp_f32 v144, v144
    v_rcp_f32 v145, v145
    buffer_load_dwordx4 a[100:103], v252, s[60:63], s27 offen offset:1024 sc1
    v_rcp_f32 v146, v146
    v_rcp_f32 v147, v147
    v_rcp_f32 v148, v148
    v_rcp_f32 v149, v149
    v_rcp_f32 v150, v150
    v_rcp_f32 v151, v151
    v_pk_mul_f32 v[152:153], v[144:145], v[68:69]
    v_pk_mul_f32 v[154:155], v[146:147], v[70:71]
    v_pk_mul_f32 v[156:157], v[148:149], v[84:85]
    v_pk_mul_f32 v[158:159], v[150:151], v[86:87]
    v_cvt_pk_bf16_f32 v164, v152, v153
    v_cvt_pk_bf16_f32 v165, v154, v155
    v_cvt_pk_bf16_f32 v166, v156, v157
    v_cvt_pk_bf16_f32 v167, v158, v159
    buffer_store_dwordx4 v[164:167], v252, s[60:63], s92 offen offset:1024 sc1
    s_waitcnt vmcnt(29)
    ds_write2_b64 v59, a[240:241], a[242:243] offset0:0 offset1:4
    s_waitcnt vmcnt(28)
    ds_write2_b64 v59, a[244:245], a[246:247] offset0:128 offset1:132
    v_pk_mul_f32 v[128:129], v[72:73], v[72:73]
    v_pk_mul_f32 v[130:131], v[74:75], v[74:75]
    v_pk_mul_f32 v[132:133], v[88:89], v[88:89]
    v_pk_mul_f32 v[134:135], v[90:91], v[90:91]
    buffer_load_dwordx4 a[104:107], v252, s[60:63], s27 offen offset:2048 sc1
    v_pk_fma_f32 v[128:129], v[128:129], v[216:217], v[216:217] op_sel:[0,1,0] op_sel_hi:[1,1,0]
    v_pk_fma_f32 v[130:131], v[130:131], v[216:217], v[216:217] op_sel:[0,1,0] op_sel_hi:[1,1,0]
    v_pk_fma_f32 v[132:133], v[132:133], v[216:217], v[216:217] op_sel:[0,1,0] op_sel_hi:[1,1,0]
    v_pk_fma_f32 v[134:135], v[134:135], v[216:217], v[216:217] op_sel:[0,1,0] op_sel_hi:[1,1,0]
    v_pk_mul_f32 v[128:129], v[128:129], v[72:73]
    v_pk_mul_f32 v[130:131], v[130:131], v[74:75]
    v_pk_mul_f32 v[132:133], v[132:133], v[88:89]
    v_pk_mul_f32 v[134:135], v[134:135], v[90:91]
    v_exp_f32 v128, v128
    v_exp_f32 v129, v129
    v_exp_f32 v130, v130
    buffer_load_dwordx4 a[108:111], v252, s[60:63], s27 offen offset:3072 sc1
    v_exp_f32 v131, v131
    v_exp_f32 v132, v132
    v_exp_f32 v133, v133
    v_exp_f32 v134, v134
    v_exp_f32 v135, v135
    v_pk_fma_f32 v[128:129], v[128:129], v[218:219], v[218:219] op_sel:[0,0,0] op_sel_hi:[1,0,0]
    v_pk_fma_f32 v[130:131], v[130:131], v[218:219], v[218:219] op_sel:[0,0,0] op_sel_hi:[1,0,0]
    v_pk_fma_f32 v[132:133], v[132:133], v[218:219], v[218:219] op_sel:[0,0,0] op_sel_hi:[1,0,0]
    v_pk_fma_f32 v[134:135], v[134:135], v[218:219], v[218:219] op_sel:[0,0,0] op_sel_hi:[1,0,0]
    v_rcp_f32 v128, v128
    s_add_u32 s27, s27, 4096
    v_rcp_f32 v129, v129
    buffer_load_dwordx4 a[112:115], v252, s[60:63], s27 offen offset:0 sc1
    v_rcp_f32 v130, v130
    v_rcp_f32 v131, v131
    v_rcp_f32 v132, v132
    v_rcp_f32 v133, v133
    v_rcp_f32 v134, v134
    v_rcp_f32 v135, v135
    v_pk_mul_f32 v[136:137], v[128:129], v[72:73]
    v_pk_mul_f32 v[138:139], v[130:131], v[74:75]
    v_pk_mul_f32 v[140:141], v[132:133], v[88:89]
    v_pk_mul_f32 v[142:143], v[134:135], v[90:91]
    v_cvt_pk_bf16_f32 v168, v136, v137
    v_cvt_pk_bf16_f32 v169, v138, v139
    v_cvt_pk_bf16_f32 v170, v140, v141
    v_cvt_pk_bf16_f32 v171, v142, v143
    buffer_store_dwordx4 v[168:171], v252, s[60:63], s92 offen offset:2048 sc1
    v_pk_mul_f32 v[144:145], v[76:77], v[76:77]
    v_pk_mul_f32 v[146:147], v[78:79], v[78:79]
    v_pk_mul_f32 v[148:149], v[92:93], v[92:93]
    v_pk_mul_f32 v[150:151], v[94:95], v[94:95]
    buffer_load_dwordx4 a[116:119], v252, s[60:63], s27 offen offset:1024 sc1
    v_pk_fma_f32 v[144:145], v[144:145], v[220:221], v[220:221] op_sel:[0,1,0] op_sel_hi:[1,1,0]
    v_pk_fma_f32 v[146:147], v[146:147], v[220:221], v[220:221] op_sel:[0,1,0] op_sel_hi:[1,1,0]
    v_pk_fma_f32 v[148:149], v[148:149], v[220:221], v[220:221] op_sel:[0,1,0] op_sel_hi:[1,1,0]
    v_pk_fma_f32 v[150:151], v[150:151], v[220:221], v[220:221] op_sel:[0,1,0] op_sel_hi:[1,1,0]
    v_pk_mul_f32 v[144:145], v[144:145], v[76:77]
    v_pk_mul_f32 v[146:147], v[146:147], v[78:79]
    v_pk_mul_f32 v[148:149], v[148:149], v[92:93]
    v_pk_mul_f32 v[150:151], v[150:151], v[94:95]
    v_exp_f32 v144, v144
    v_exp_f32 v145, v145
    v_exp_f32 v146, v146
    buffer_load_dwordx4 a[120:123], v252, s[60:63], s27 offen offset:2048 sc1
    v_exp_f32 v147, v147
    v_exp_f32 v148, v148
    v_exp_f32 v149, v149
    v_exp_f32 v150, v150
    v_exp_f32 v151, v151
    v_pk_fma_f32 v[144:145], v[144:145], v[222:223], v[222:223] op_sel:[0,0,0] op_sel_hi:[1,0,0]
    v_pk_fma_f32 v[146:147], v[146:147], v[222:223], v[222:223] op_sel:[0,0,0] op_sel_hi:[1,0,0]
    v_pk_fma_f32 v[148:149], v[148:149], v[222:223], v[222:223] op_sel:[0,0,0] op_sel_hi:[1,0,0]
    v_pk_fma_f32 v[150:151], v[150:151], v[222:223], v[222:223] op_sel:[0,0,0] op_sel_hi:[1,0,0]
    v_rcp_f32 v144, v144
    v_rcp_f32 v145, v145
    buffer_load_dwordx4 a[124:127], v252, s[60:63], s27 offen offset:3072 sc1
    v_rcp_f32 v146, v146
    v_rcp_f32 v147, v147
    v_rcp_f32 v148, v148
    v_rcp_f32 v149, v149
    v_rcp_f32 v150, v150
    v_rcp_f32 v151, v151
    v_pk_mul_f32 v[152:153], v[144:145], v[76:77]
    v_pk_mul_f32 v[154:155], v[146:147], v[78:79]
    v_pk_mul_f32 v[156:157], v[148:149], v[92:93]
    v_pk_mul_f32 v[158:159], v[150:151], v[94:95]
    v_cvt_pk_bf16_f32 v172, v152, v153
    v_cvt_pk_bf16_f32 v173, v154, v155
    v_cvt_pk_bf16_f32 v174, v156, v157
    v_cvt_pk_bf16_f32 v175, v158, v159
    buffer_store_dwordx4 v[172:175], v252, s[60:63], s92 offen offset:3072 sc1
    s_waitcnt lgkmcnt(0)
    s_barrier
    v_pk_mul_f32 v[128:129], v[96:97], v[96:97]
    v_pk_mul_f32 v[130:131], v[98:99], v[98:99]
    ds_read_b64_tr_b16 v[16:17], v4 offset:0
    v_pk_mul_f32 v[132:133], v[112:113], v[112:113]
    s_add_u32 s27, s27, 4096
    v_pk_mul_f32 v[134:135], v[114:115], v[114:115]
    buffer_load_dwordx4 a[128:131], v252, s[60:63], s27 offen offset:0 sc1
    v_pk_fma_f32 v[128:129], v[128:129], v[208:209], v[208:209] op_sel:[0,1,0] op_sel_hi:[1,1,0]
    ds_read_b64_tr_b16 v[18:19], v4 offset:32
    v_pk_fma_f32 v[130:131], v[130:131], v[208:209], v[208:209] op_sel:[0,1,0] op_sel_hi:[1,1,0]
    v_pk_fma_f32 v[132:133], v[132:133], v[208:209], v[208:209] op_sel:[0,1,0] op_sel_hi:[1,1,0]
    v_pk_fma_f32 v[134:135], v[134:135], v[208:209], v[208:209] op_sel:[0,1,0] op_sel_hi:[1,1,0]
    ds_read_b64_tr_b16 v[20:21], v4 offset:256
    v_pk_mul_f32 v[128:129], v[128:129], v[96:97]
    v_pk_mul_f32 v[130:131], v[130:131], v[98:99]
    v_pk_mul_f32 v[132:133], v[132:133], v[112:113]
    ds_read_b64_tr_b16 v[22:23], v4 offset:288
    v_pk_mul_f32 v[134:135], v[134:135], v[114:115]
    v_exp_f32 v128, v128
    v_exp_f32 v129, v129
    ds_read_b64_tr_b16 v[24:25], v4 offset:512
    v_exp_f32 v130, v130
    buffer_load_dwordx4 a[132:135], v252, s[60:63], s27 offen offset:1024 sc1
    v_exp_f32 v131, v131
    v_exp_f32 v132, v132
    ds_read_b64_tr_b16 v[26:27], v4 offset:544
    v_exp_f32 v133, v133
    v_exp_f32 v134, v134
    v_exp_f32 v135, v135
    ds_read_b64_tr_b16 v[28:29], v4 offset:768
    v_pk_fma_f32 v[128:129], v[128:129], v[210:211], v[210:211] op_sel:[0,0,0] op_sel_hi:[1,0,0]
    v_pk_fma_f32 v[130:131], v[130:131], v[210:211], v[210:211] op_sel:[0,0,0] op_sel_hi:[1,0,0]
    v_pk_fma_f32 v[132:133], v[132:133], v[210:211], v[210:211] op_sel:[0,0,0] op_sel_hi:[1,0,0]
    ds_read_b64_tr_b16 v[30:31], v4 offset:800
    v_pk_fma_f32 v[134:135], v[134:135], v[210:211], v[210:211] op_sel:[0,0,0] op_sel_hi:[1,0,0]
    v_rcp_f32 v128, v128
    v_rcp_f32 v129, v129
    buffer_load_dwordx4 a[136:139], v252, s[60:63], s27 offen offset:2048 sc1
    ds_read_b64_tr_b16 v[32:33], v4 offset:1024
    v_rcp_f32 v130, v130
    v_rcp_f32 v131, v131
    v_rcp_f32 v132, v132
    ds_read_b64_tr_b16 v[34:35], v4 offset:1056
    v_rcp_f32 v133, v133
    v_rcp_f32 v134, v134
    v_rcp_f32 v135, v135
    ds_read_b64_tr_b16 v[36:37], v4 offset:1280
    v_pk_mul_f32 v[136:137], v[128:129], v[96:97]
    v_pk_mul_f32 v[138:139], v[130:131], v[98:99]
    v_pk_mul_f32 v[140:141], v[132:133], v[112:113]
    v_pk_mul_f32 v[142:143], v[134:135], v[114:115]
    v_cvt_pk_bf16_f32 v176, v136, v137
    v_cvt_pk_bf16_f32 v177, v138, v139
    v_cvt_pk_bf16_f32 v178, v140, v141
    v_cvt_pk_bf16_f32 v179, v142, v143
    buffer_store_dwordx4 v[176:179], v252, s[60:63], s93 offen offset:0 sc1
    v_pk_mul_f32 v[144:145], v[100:101], v[100:101]
    v_pk_mul_f32 v[146:147], v[102:103], v[102:103]
    ds_read_b64_tr_b16 v[38:39], v4 offset:1312
    v_pk_mul_f32 v[148:149], v[116:117], v[116:117]
    v_pk_mul_f32 v[150:151], v[118:119], v[118:119]
    buffer_load_dwordx4 a[140:143], v252, s[60:63], s27 offen offset:3072 sc1
    v_pk_fma_f32 v[144:145], v[144:145], v[212:213], v[212:213] op_sel:[0,1,0] op_sel_hi:[1,1,0]
    ds_read_b64_tr_b16 v[40:41], v4 offset:1536
    v_pk_fma_f32 v[146:147], v[146:147], v[212:213], v[212:213] op_sel:[0,1,0] op_sel_hi:[1,1,0]
    v_pk_fma_f32 v[148:149], v[148:149], v[212:213], v[212:213] op_sel:[0,1,0] op_sel_hi:[1,1,0]
    v_pk_fma_f32 v[150:151], v[150:151], v[212:213], v[212:213] op_sel:[0,1,0] op_sel_hi:[1,1,0]
    ds_read_b64_tr_b16 v[42:43], v4 offset:1568
    v_pk_mul_f32 v[144:145], v[144:145], v[100:101]
    v_pk_mul_f32 v[146:147], v[146:147], v[102:103]
    v_pk_mul_f32 v[148:149], v[148:149], v[116:117]
    ds_read_b64_tr_b16 v[44:45], v4 offset:1792
    v_pk_mul_f32 v[150:151], v[150:151], v[118:119]
    v_exp_f32 v144, v144
    v_exp_f32 v145, v145
    s_add_u32 s27, s27, 4096
    ds_read_b64_tr_b16 v[46:47], v4 offset:1824
    v_exp_f32 v146, v146
    buffer_load_dwordx4 a[144:147], v252, s[60:63], s27 offen offset:0 sc1
    v_exp_f32 v147, v147
    v_exp_f32 v148, v148
    ds_read_b64_tr_b16 v[48:49], v4 offset:2048
    v_exp_f32 v149, v149
    v_exp_f32 v150, v150
    v_exp_f32 v151, v151
    ds_read_b64_tr_b16 v[50:51], v4 offset:2080
    v_pk_fma_f32 v[144:145], v[144:145], v[214:215], v[214:215] op_sel:[0,0,0] op_sel_hi:[1,0,0]
    v_pk_fma_f32 v[146:147], v[146:147], v[214:215], v[214:215] op_sel:[0,0,0] op_sel_hi:[1,0,0]
    v_pk_fma_f32 v[148:149], v[148:149], v[214:215], v[214:215] op_sel:[0,0,0] op_sel_hi:[1,0,0]
    ds_read_b64_tr_b16 v[52:53], v4 offset:2304
    v_pk_fma_f32 v[150:151], v[150:151], v[214:215], v[214:215] op_sel:[0,0,0] op_sel_hi:[1,0,0]
    v_rcp_f32 v144, v144
    v_rcp_f32 v145, v145
    buffer_load_dwordx4 a[148:151], v252, s[60:63], s27 offen offset:1024 sc1
    ds_read_b64_tr_b16 v[54:55], v4 offset:2336
    v_rcp_f32 v146, v146
    v_rcp_f32 v147, v147
    v_rcp_f32 v148, v148
    ds_read_b64_tr_b16 v[56:57], v4 offset:2560
    v_rcp_f32 v149, v149
    v_rcp_f32 v150, v150
    v_rcp_f32 v151, v151
    ds_read_b64_tr_b16 v[58:59], v4 offset:2592
    v_pk_mul_f32 v[152:153], v[144:145], v[100:101]
    v_pk_mul_f32 v[154:155], v[146:147], v[102:103]
    v_pk_mul_f32 v[156:157], v[148:149], v[116:117]
    v_pk_mul_f32 v[158:159], v[150:151], v[118:119]
    v_cvt_pk_bf16_f32 v180, v152, v153
    v_cvt_pk_bf16_f32 v181, v154, v155
    v_cvt_pk_bf16_f32 v182, v156, v157
    v_cvt_pk_bf16_f32 v183, v158, v159
    buffer_store_dwordx4 v[180:183], v252, s[60:63], s93 offen offset:1024 sc1
    v_pk_mul_f32 v[128:129], v[104:105], v[104:105]
    v_pk_mul_f32 v[130:131], v[106:107], v[106:107]
    ds_read_b64_tr_b16 v[60:61], v4 offset:2816
    v_pk_mul_f32 v[132:133], v[120:121], v[120:121]
    v_pk_mul_f32 v[134:135], v[122:123], v[122:123]
    buffer_load_dwordx4 a[152:155], v252, s[60:63], s27 offen offset:2048 sc1
    v_pk_fma_f32 v[128:129], v[128:129], v[216:217], v[216:217] op_sel:[0,1,0] op_sel_hi:[1,1,0]
    ds_read_b64_tr_b16 v[62:63], v4 offset:2848
    v_pk_fma_f32 v[130:131], v[130:131], v[216:217], v[216:217] op_sel:[0,1,0] op_sel_hi:[1,1,0]
    v_pk_fma_f32 v[132:133], v[132:133], v[216:217], v[216:217] op_sel:[0,1,0] op_sel_hi:[1,1,0]
    v_pk_fma_f32 v[134:135], v[134:135], v[216:217], v[216:217] op_sel:[0,1,0] op_sel_hi:[1,1,0]
    ds_read_b64_tr_b16 v[192:193], v4 offset:3072
    v_pk_mul_f32 v[128:129], v[128:129], v[104:105]
    v_pk_mul_f32 v[130:131], v[130:131], v[106:107]
    v_pk_mul_f32 v[132:133], v[132:133], v[120:121]
    ds_read_b64_tr_b16 v[194:195], v4 offset:3104
    v_pk_mul_f32 v[134:135], v[134:135], v[122:123]
    v_exp_f32 v128, v128
    v_exp_f32 v129, v129
    ds_read_b64_tr_b16 v[196:197], v4 offset:3328
    v_exp_f32 v130, v130
    buffer_load_dwordx4 a[156:159], v252, s[60:63], s27 offen offset:3072 sc1
    v_exp_f32 v131, v131
    v_exp_f32 v132, v132
    ds_read_b64_tr_b16 v[198:199], v4 offset:3360
    v_exp_f32 v133, v133
    v_exp_f32 v134, v134
    v_exp_f32 v135, v135
    ds_read_b64_tr_b16 v[200:201], v4 offset:3584
    v_pk_fma_f32 v[128:129], v[128:129], v[218:219], v[218:219] op_sel:[0,0,0] op_sel_hi:[1,0,0]
    v_pk_fma_f32 v[130:131], v[130:131], v[218:219], v[218:219] op_sel:[0,0,0] op_sel_hi:[1,0,0]
    v_pk_fma_f32 v[132:133], v[132:133], v[218:219], v[218:219] op_sel:[0,0,0] op_sel_hi:[1,0,0]
    ds_read_b64_tr_b16 v[202:203], v4 offset:3616
    v_pk_fma_f32 v[134:135], v[134:135], v[218:219], v[218:219] op_sel:[0,0,0] op_sel_hi:[1,0,0]
    v_rcp_f32 v128, v128
    v_rcp_f32 v129, v129
    s_add_u32 s27, s27, 4096
    ds_read_b64_tr_b16 v[204:205], v4 offset:3840
    v_rcp_f32 v130, v130
    v_rcp_f32 v131, v131
    v_rcp_f32 v132, v132
    ds_read_b64_tr_b16 v[206:207], v4 offset:3872
    v_rcp_f32 v133, v133
    v_rcp_f32 v134, v134
    v_rcp_f32 v135, v135
    v_pk_mul_f32 v[136:137], v[128:129], v[104:105]
    v_pk_mul_f32 v[138:139], v[130:131], v[106:107]
    v_pk_mul_f32 v[140:141], v[132:133], v[120:121]
    v_pk_mul_f32 v[142:143], v[134:135], v[122:123]
    v_cvt_pk_bf16_f32 v184, v136, v137
    v_cvt_pk_bf16_f32 v185, v138, v139
    v_cvt_pk_bf16_f32 v186, v140, v141
    v_cvt_pk_bf16_f32 v187, v142, v143
    buffer_store_dwordx4 v[184:187], v252, s[60:63], s93 offen offset:2048 sc1
    v_pk_mul_f32 v[144:145], v[108:109], v[108:109]
    v_pk_mul_f32 v[146:147], v[110:111], v[110:111]
    ds_read2_b64 v[164:167], v2 offset0:4 offset1:0
    v_pk_mul_f32 v[148:149], v[124:125], v[124:125]
    v_pk_mul_f32 v[150:151], v[126:127], v[126:127]
    v_pk_fma_f32 v[144:145], v[144:145], v[220:221], v[220:221] op_sel:[0,1,0] op_sel_hi:[1,1,0]
    ds_read2_b64 v[168:171], v2 offset0:20 offset1:16
    v_pk_fma_f32 v[146:147], v[146:147], v[220:221], v[220:221] op_sel:[0,1,0] op_sel_hi:[1,1,0]
    v_pk_fma_f32 v[148:149], v[148:149], v[220:221], v[220:221] op_sel:[0,1,0] op_sel_hi:[1,1,0]
    v_pk_fma_f32 v[150:151], v[150:151], v[220:221], v[220:221] op_sel:[0,1,0] op_sel_hi:[1,1,0]
    v_pk_mul_f32 v[144:145], v[144:145], v[108:109]
    v_pk_mul_f32 v[146:147], v[146:147], v[110:111]
    v_pk_mul_f32 v[148:149], v[148:149], v[124:125]
    v_pk_mul_f32 v[150:151], v[150:151], v[126:127]
    v_exp_f32 v144, v144
    v_exp_f32 v145, v145
    v_exp_f32 v146, v146
    v_exp_f32 v147, v147
    v_exp_f32 v148, v148
    v_exp_f32 v149, v149
    v_exp_f32 v150, v150
    v_exp_f32 v151, v151
    v_pk_fma_f32 v[144:145], v[144:145], v[222:223], v[222:223] op_sel:[0,0,0] op_sel_hi:[1,0,0]
    v_pk_fma_f32 v[146:147], v[146:147], v[222:223], v[222:223] op_sel:[0,0,0] op_sel_hi:[1,0,0]
    v_pk_fma_f32 v[148:149], v[148:149], v[222:223], v[222:223] op_sel:[0,0,0] op_sel_hi:[1,0,0]
    v_pk_fma_f32 v[150:151], v[150:151], v[222:223], v[222:223] op_sel:[0,0,0] op_sel_hi:[1,0,0]
    v_rcp_f32 v144, v144
    v_rcp_f32 v145, v145
    v_rcp_f32 v146, v146
    v_rcp_f32 v147, v147
    v_rcp_f32 v148, v148
    v_rcp_f32 v149, v149
    v_rcp_f32 v150, v150
    v_rcp_f32 v151, v151
    v_pk_mul_f32 v[152:153], v[144:145], v[108:109]
    v_pk_mul_f32 v[154:155], v[146:147], v[110:111]
    v_pk_mul_f32 v[156:157], v[148:149], v[124:125]
    v_pk_mul_f32 v[158:159], v[150:151], v[126:127]
    v_cvt_pk_bf16_f32 v188, v152, v153
    v_cvt_pk_bf16_f32 v189, v154, v155
    v_cvt_pk_bf16_f32 v190, v156, v157
    v_cvt_pk_bf16_f32 v191, v158, v159
    buffer_store_dwordx4 v[188:191], v252, s[60:63], s93 offen offset:3072 sc1
    s_mov_b32 s85, 1
L_conv:
    s_lshl_b32 s81, s10, 7
    s_add_u32 s81, s81, 2048
    s_lshl_b32 s13, s86, 7
    s_add_u32 s13, s13, 4194304
    s_waitcnt lgkmcnt(0)
    s_bitcmp1_b32 s5, 0
    s_cbranch_scc1 LconvB_11
    v_mfma_f32_16x16x32_bf16 v[64:67], v[164:167], v[16:19], 0
    ds_read2_b64 v[172:175], v2 offset0:36 offset1:32
    v_mfma_f32_16x16x32_bf16 v[72:75], v[164:167], v[20:23], 0
    v_mfma_f32_16x16x32_bf16 v[80:83], v[164:167], v[24:27], 0
    v_mfma_f32_16x16x32_bf16 v[88:91], v[164:167], v[28:31], 0
    s_nop 3
    v_add_f32_dpp v132, v67, v66 wave_shr:1 row_mask:0xf bank_mask:0xf bound_ctrl:0
    v_mfma_f32_16x16x32_bf16 v[100:103], v[164:167], v[192:195], 0
    s_nop 0
    v_add_f32_dpp v134, v132, v65 wave_shr:1 row_mask:0xf bank_mask:0xf bound_ctrl:0
    v_mfma_f32_16x16x32_bf16 v[108:111], v[164:167], v[196:199], 0
    s_add_u32 m0, s21, 0
    s_add_u32 s79, s7, 0
    buffer_load_dwordx4 v12, s[36:39], s79 offen lds
    v_add_f32_dpp v136, v134, v64 wave_shr:1 row_mask:0xf bank_mask:0xf bound_ctrl:0
    v_mfma_f32_16x16x32_bf16 v[116:119], v[164:167], v[200:203], 0
    v_mfma_f32_16x16x32_bf16 v[124:127], v[164:167], v[204:207], 0
    v_mfma_f32_16x16x32_bf16 v[68:71], v[168:171], v[16:19], 0
    ds_read2_b64 v[176:179], v2 offset0:52 offset1:48
    s_add_u32 m0, s21, 1088
    s_add_u32 s79, s7, 327680
    buffer_load_dwordx4 v12, s[36:39], s79 offen lds
    v_mfma_f32_16x16x32_bf16 v[76:79], v[168:171], v[20:23], 0
    v_mfma_f32_16x16x32_bf16 v[84:87], v[168:171], v[24:27], 0
    s_add_u32 m0, s21, 2176
    s_add_u32 s79, s7, 1280
    buffer_load_dwordx4 v12, s[36:39], s79 offen lds
    v_mfma_f32_16x16x32_bf16 v[92:95], v[168:171], v[28:31], 0
    v_add_f32_dpp v133, v67, v70 wave_ror:1 row_mask:0xf bank_mask:0xf
    v_mfma_f32_16x16x32_bf16 v[96:99], v[168:171], v[60:63], 0
    s_add_u32 m0, s21, 3264
    s_add_u32 s79, s7, 328960
    buffer_load_dwordx4 v12, s[36:39], s79 offen lds
    v_add_f32_dpp v135, v132, v69 wave_ror:1 row_mask:0xf bank_mask:0xf
    v_mfma_f32_16x16x32_bf16 v[104:107], v[168:171], v[192:195], 0
    v_add_f32_dpp v137, v134, v68 wave_ror:1 row_mask:0xf bank_mask:0xf
    v_mfma_f32_16x16x32_bf16 v[112:115], v[168:171], v[196:199], 0
    s_mul_i32 s79, s12, 160
    v_min_u32 v14, 39, v1
    v_add_f32_dpp v133, v71, v70 wave_shr:1 row_mask:0xf bank_mask:0xf
    v_mfma_f32_16x16x32_bf16 v[120:123], v[168:171], v[200:203], 0
    s_nop 0
    v_add_f32_dpp v135, v133, v69 wave_shr:1 row_mask:0xf bank_mask:0xf
    v_mfma_f32_16x16x32_bf16 v[128:131], v[168:171], v[204:207], 0
    s_nop 0
    v_add_f32_dpp v137, v135, v68 wave_shr:1 row_mask:0xf bank_mask:0xf
    s_waitcnt lgkmcnt(1)
    v_mfma_f32_16x16x32_bf16 v[72:75], v[172:175], v[16:19], v[72:75]
    ds_read2_b64 v[164:167], v2 offset0:68 offset1:64
    v_lshl_add_u32 v14, v14, 2, s79
    v_cvt_pk_bf16_f32 v140, v136, v137
    v_mfma_f32_16x16x32_bf16 v[80:83], v[172:175], v[20:23], v[80:83]
    v_mfma_f32_16x16x32_bf16 v[88:91], v[172:175], v[24:27], v[88:91]
    s_add_u32 m0, s21, 4352
    s_nop 0
    global_load_lds_dword v14, s[28:29]
    v_mfma_f32_16x16x32_bf16 v[100:103], v[172:175], v[60:63], v[100:103]
    v_add_f32_dpp v132, v71, v74 wave_ror:1 row_mask:0xf bank_mask:0xf
    v_mfma_f32_16x16x32_bf16 v[108:111], v[172:175], v[192:195], v[108:111]
    v_lshrrev_b32 v15, 4, v1
    v_add_f32_dpp v134, v133, v73 wave_ror:1 row_mask:0xf bank_mask:0xf
    v_mfma_f32_16x16x32_bf16 v[116:119], v[172:175], v[196:199], v[116:119]
    v_add_f32_dpp v136, v135, v72 wave_ror:1 row_mask:0xf bank_mask:0xf
    v_mfma_f32_16x16x32_bf16 v[124:127], v[172:175], v[200:203], v[124:127]
    v_lshl_add_u32 v15, v15, 3, s21
    v_add_f32_dpp v132, v75, v74 wave_shr:1 row_mask:0xf bank_mask:0xf
    s_waitcnt lgkmcnt(1)
    v_mfma_f32_16x16x32_bf16 v[76:79], v[176:179], v[16:19], v[76:79]
    ds_read2_b64 v[168:171], v2 offset0:84 offset1:80
    v_add_f32_dpp v134, v132, v73 wave_shr:1 row_mask:0xf bank_mask:0xf
    v_mfma_f32_16x16x32_bf16 v[84:87], v[176:179], v[20:23], v[84:87]
    s_cmp_eq_u32 s68, 8
    s_cselect_b32 s27, s74, s27
    buffer_load_dwordx4 a[160:163], v252, s[60:63], s27 offen offset:0 sc1
    v_add_f32_dpp v136, v134, v72 wave_shr:1 row_mask:0xf bank_mask:0xf
    v_mfma_f32_16x16x32_bf16 v[92:95], v[176:179], v[24:27], v[92:95]
    v_mfma_f32_16x16x32_bf16 v[96:99], v[176:179], v[56:59], v[96:99]
    v_add_f32_dpp v133, v75, v78 wave_ror:1 row_mask:0xf bank_mask:0xf
    v_mfma_f32_16x16x32_bf16 v[104:107], v[176:179], v[60:63], v[104:107]
    v_add_f32_dpp v135, v132, v77 wave_ror:1 row_mask:0xf bank_mask:0xf
    v_mfma_f32_16x16x32_bf16 v[112:115], v[176:179], v[192:195], v[112:115]
    buffer_load_dwordx4 a[164:167], v252, s[60:63], s27 offen offset:1024 sc1
    v_add_f32_dpp v137, v134, v76 wave_ror:1 row_mask:0xf bank_mask:0xf
    v_mfma_f32_16x16x32_bf16 v[120:123], v[176:179], v[196:199], v[120:123]
    v_add_f32_dpp v133, v79, v78 wave_shr:1 row_mask:0xf bank_mask:0xf
    v_mfma_f32_16x16x32_bf16 v[128:131], v[176:179], v[200:203], v[128:131]
    s_nop 0
    v_add_f32_dpp v135, v133, v77 wave_shr:1 row_mask:0xf bank_mask:0xf
    s_waitcnt lgkmcnt(1)
    v_mfma_f32_16x16x32_bf16 v[80:83], v[164:167], v[16:19], v[80:83]
    ds_read2_b64 v[172:175], v2 offset0:100 offset1:96
    v_add_f32_dpp v137, v135, v76 wave_shr:1 row_mask:0xf bank_mask:0xf
    v_mfma_f32_16x16x32_bf16 v[88:91], v[164:167], v[20:23], v[88:91]
    buffer_load_dwordx4 a[168:171], v252, s[60:63], s27 offen offset:2048 sc1
    v_cvt_pk_bf16_f32 v141, v136, v137
    v_mfma_f32_16x16x32_bf16 v[100:103], v[164:167], v[56:59], v[100:103]
    v_mfma_f32_16x16x32_bf16 v[108:111], v[164:167], v[60:63], v[108:111]
    s_nop 0
    v_add_f32_dpp v132, v79, v82 wave_ror:1 row_mask:0xf bank_mask:0xf
    v_mfma_f32_16x16x32_bf16 v[116:119], v[164:167], v[192:195], v[116:119]
    v_add_f32_dpp v134, v133, v81 wave_ror:1 row_mask:0xf bank_mask:0xf
    v_mfma_f32_16x16x32_bf16 v[124:127], v[164:167], v[196:199], v[124:127]
    buffer_load_dwordx4 a[172:175], v252, s[60:63], s27 offen offset:3072 sc1
    v_add_f32_dpp v136, v135, v80 wave_ror:1 row_mask:0xf bank_mask:0xf
    s_waitcnt lgkmcnt(1)
    v_mfma_f32_16x16x32_bf16 v[84:87], v[168:171], v[16:19], v[84:87]
    ds_read2_b64 v[176:179], v2 offset0:116 offset1:112
    v_add_f32_dpp v132, v83, v82 wave_shr:1 row_mask:0xf bank_mask:0xf
    v_mfma_f32_16x16x32_bf16 v[92:95], v[168:171], v[20:23], v[92:95]
    s_nop 0
    v_add_f32_dpp v134, v132, v81 wave_shr:1 row_mask:0xf bank_mask:0xf
    v_mfma_f32_16x16x32_bf16 v[96:99], v[168:171], v[52:55], v[96:99]
    s_add_u32 s27, s27, 4096
    buffer_load_dwordx4 a[176:179], v252, s[60:63], s27 offen offset:0 sc1
    v_add_f32_dpp v136, v134, v80 wave_shr:1 row_mask:0xf bank_mask:0xf
    v_mfma_f32_16x16x32_bf16 v[104:107], v[168:171], v[56:59], v[104:107]
    v_add_f32_dpp v133, v83, v86 wave_ror:1 row_mask:0xf bank_mask:0xf
    v_mfma_f32_16x16x32_bf16 v[112:115], v[168:171], v[60:63], v[112:115]
    v_add_f32_dpp v135, v132, v85 wave_ror:1 row_mask:0xf bank_mask:0xf
    v_mfma_f32_16x16x32_bf16 v[120:123], v[168:171], v[192:195], v[120:123]
    s_cmp_eq_u32 s85, 0
    s_cbranch_scc1 Lh_13
    s_waitcnt vmcnt(10)
    v_mov_b32 v6, 1
    v_mov_b32 v7, 148992
    s_mov_b64 exec, 1
    ds_add_rtn_u32 v7, v7, v6
    s_mov_b64 exec, -1
Lh_13:
    s_nop 0
    v_add_f32_dpp v137, v134, v84 wave_ror:1 row_mask:0xf bank_mask:0xf
    v_mfma_f32_16x16x32_bf16 v[128:131], v[168:171], v[196:199], v[128:131]
    buffer_load_dwordx4 a[180:183], v252, s[60:63], s27 offen offset:1024 sc1
    v_add_f32_dpp v133, v87, v86 wave_shr:1 row_mask:0xf bank_mask:0xf
    s_waitcnt lgkmcnt(1)
    v_mfma_f32_16x16x32_bf16 v[88:91], v[172:175], v[16:19], v[88:91]
    ds_read2_b64 v[164:167], v2 offset0:132 offset1:128
    v_add_f32_dpp v135, v133, v85 wave_shr:1 row_mask:0xf bank_mask:0xf
    v_mfma_f32_16x16x32_bf16 v[100:103], v[172:175], v[52:55], v[100:103]
    s_nop 0
    v_add_f32_dpp v137, v135, v84 wave_shr:1 row_mask:0xf bank_mask:0xf
    v_mfma_f32_16x16x32_bf16 v[108:111], v[172:175], v[56:59], v[108:111]
    v_cvt_pk_bf16_f32 v142, v136, v137
    v_mfma_f32_16x16x32_bf16 v[116:119], v[172:175], v[60:63], v[116:119]
    buffer_load_dwordx4 a[184:187], v252, s[60:63], s27 offen offset:2048 sc1
    v_add_f32_dpp v132, v87, v90 wave_ror:1 row_mask:0xf bank_mask:0xf
    v_mfma_f32_16x16x32_bf16 v[124:127], v[172:175], v[192:195], v[124:127]
    v_add_f32_dpp v134, v133, v89 wave_ror:1 row_mask:0xf bank_mask:0xf
    s_waitcnt lgkmcnt(1)
    v_mfma_f32_16x16x32_bf16 v[92:95], v[176:179], v[16:19], v[92:95]
    ds_read2_b64 v[168:171], v2 offset0:148 offset1:144
    v_add_f32_dpp v136, v135, v88 wave_ror:1 row_mask:0xf bank_mask:0xf
    v_mfma_f32_16x16x32_bf16 v[96:99], v[176:179], v[48:51], v[96:99]
    buffer_load_dwordx4 a[188:191], v252, s[60:63], s27 offen offset:3072 sc1
    s_cmp_eq_u32 s85, 0
    s_cbranch_scc1 Lh_14
    s_lshl_b32 s6, s72, 7
    s_add_u32 s6, s6, 2048
    s_waitcnt lgkmcnt(2)
    v_readfirstlane_b32 s83, v7
    s_nop 1
    s_cmp_lg_u32 s83, 3
    s_cbranch_scc1 Lsig_15
    s_mov_b64 exec, 1
    buffer_atomic_add v6, v255, s[60:63], s6 offen sc1
    s_mov_b64 exec, -1
Lsig_15:
Lh_14:
    s_nop 0
    v_add_f32_dpp v132, v91, v90 wave_shr:1 row_mask:0xf bank_mask:0xf
    v_mfma_f32_16x16x32_bf16 v[104:107], v[176:179], v[52:55], v[104:107]
    s_nop 0
    v_add_f32_dpp v134, v132, v89 wave_shr:1 row_mask:0xf bank_mask:0xf
    v_mfma_f32_16x16x32_bf16 v[112:115], v[176:179], v[56:59], v[112:115]
    s_nop 0
    v_add_f32_dpp v136, v134, v88 wave_shr:1 row_mask:0xf bank_mask:0xf
    v_mfma_f32_16x16x32_bf16 v[120:123], v[176:179], v[60:63], v[120:123]
    v_add_f32_dpp v133, v91, v94 wave_ror:1 row_mask:0xf bank_mask:0xf
    v_mfma_f32_16x16x32_bf16 v[128:131], v[176:179], v[192:195], v[128:131]
    s_add_u32 s27, s27, 4096
    buffer_load_dwordx4 a[192:195], v252, s[60:63], s27 offen offset:0 sc1
    v_add_f32_dpp v135, v132, v93 wave_ror:1 row_mask:0xf bank_mask:0xf
    s_waitcnt lgkmcnt(1)
    v_mfma_f32_16x16x32_bf16 v[100:103], v[164:167], v[48:51], v[100:103]
    ds_read2_b64 v[172:175], v2 offset0:164 offset1:160
    v_add_f32_dpp v137, v134, v92 wave_ror:1 row_mask:0xf bank_mask:0xf
    v_mfma_f32_16x16x32_bf16 v[108:111], v[164:167], v[52:55], v[108:111]
    v_add_f32_dpp v133, v95, v94 wave_shr:1 row_mask:0xf bank_mask:0xf
    v_mfma_f32_16x16x32_bf16 v[116:119], v[164:167], v[56:59], v[116:119]
    s_nop 0
    v_add_f32_dpp v135, v133, v93 wave_shr:1 row_mask:0xf bank_mask:0xf
    v_mfma_f32_16x16x32_bf16 v[124:127], v[164:167], v[60:63], v[124:127]
    buffer_load_dwordx4 a[196:199], v252, s[60:63], s27 offen offset:1024 sc1
    v_add_f32_dpp v137, v135, v92 wave_shr:1 row_mask:0xf bank_mask:0xf
    s_waitcnt lgkmcnt(1)
    v_mfma_f32_16x16x32_bf16 v[96:99], v[168:171], v[44:47], v[96:99]
    ds_read2_b64 v[176:179], v2 offset0:180 offset1:176
    v_cvt_pk_bf16_f32 v143, v136, v137
    v_mfma_f32_16x16x32_bf16 v[104:107], v[168:171], v[48:51], v[104:107]
    s_add_u32 s6, s13, 0
    v_mfma_f32_16x16x32_bf16 v[112:115], v[168:171], v[52:55], v[112:115]
    buffer_load_dwordx4 a[200:203], v252, s[60:63], s27 offen offset:2048 sc1
    buffer_store_dwordx4 v[140:143], v5, s[60:63], s6 offen sc1
    v_mfma_f32_16x16x32_bf16 v[120:123], v[168:171], v[56:59], v[120:123]
    v_mfma_f32_16x16x32_bf16 v[128:131], v[168:171], v[60:63], v[128:131]
    s_waitcnt lgkmcnt(1)
    v_mfma_f32_16x16x32_bf16 v[100:103], v[172:175], v[44:47], v[100:103]
    ds_read2_b64 v[164:167], v2 offset0:196 offset1:192
    v_mfma_f32_16x16x32_bf16 v[108:111], v[172:175], v[48:51], v[108:111]
    buffer_load_dwordx4 a[204:207], v252, s[60:63], s27 offen offset:3072 sc1
    v_mfma_f32_16x16x32_bf16 v[116:119], v[172:175], v[52:55], v[116:119]
    v_mfma_f32_16x16x32_bf16 v[124:127], v[172:175], v[56:59], v[124:127]
    s_waitcnt lgkmcnt(1)
    v_mfma_f32_16x16x32_bf16 v[96:99], v[176:179], v[40:43], v[96:99]
    ds_read2_b64 v[168:171], v2 offset0:212 offset1:208
    v_mfma_f32_16x16x32_bf16 v[104:107], v[176:179], v[44:47], v[104:107]
    s_add_u32 s27, s27, 4096
    buffer_load_dwordx4 a[208:211], v252, s[60:63], s27 offen offset:0 sc1
    v_mfma_f32_16x16x32_bf16 v[112:115], v[176:179], v[48:51], v[112:115]
    v_mfma_f32_16x16x32_bf16 v[120:123], v[176:179], v[52:55], v[120:123]
    v_mfma_f32_16x16x32_bf16 v[128:131], v[176:179], v[56:59], v[128:131]
    s_waitcnt lgkmcnt(1)
    v_mfma_f32_16x16x32_bf16 v[100:103], v[164:167], v[40:43], v[100:103]
    ds_read2_b64 v[172:175], v2 offset0:228 offset1:224
    buffer_load_dwordx4 a[212:215], v252, s[60:63], s27 offen offset:1024 sc1
    v_mfma_f32_16x16x32_bf16 v[108:111], v[164:167], v[44:47], v[108:111]
    v_mfma_f32_16x16x32_bf16 v[116:119], v[164:167], v[48:51], v[116:119]
    v_mfma_f32_16x16x32_bf16 v[124:127], v[164:167], v[52:55], v[124:127]
    buffer_load_dwordx4 a[216:219], v252, s[60:63], s27 offen offset:2048 sc1
    s_waitcnt lgkmcnt(1)
    v_mfma_f32_16x16x32_bf16 v[96:99], v[168:171], v[36:39], v[96:99]
    ds_read2_b64 v[176:179], v2 offset0:244 offset1:240
    v_mfma_f32_16x16x32_bf16 v[104:107], v[168:171], v[40:43], v[104:107]
    v_mfma_f32_16x16x32_bf16 v[112:115], v[168:171], v[44:47], v[112:115]
    v_mfma_f32_16x16x32_bf16 v[120:123], v[168:171], v[48:51], v[120:123]
    buffer_load_dwordx4 a[220:223], v252, s[60:63], s27 offen offset:3072 sc1
    v_mfma_f32_16x16x32_bf16 v[128:131], v[168:171], v[52:55], v[128:131]
    s_waitcnt lgkmcnt(1)
    v_mfma_f32_16x16x32_bf16 v[100:103], v[172:175], v[36:39], v[100:103]
    ds_read2_b64 v[164:167], v3 offset0:4 offset1:0
    v_mfma_f32_16x16x32_bf16 v[108:111], v[172:175], v[40:43], v[108:111]
    v_mfma_f32_16x16x32_bf16 v[116:119], v[172:175], v[44:47], v[116:119]
    s_add_u32 s27, s27, 4096
    buffer_load_dwordx4 a[224:227], v252, s[60:63], s27 offen offset:0 sc1
    v_mfma_f32_16x16x32_bf16 v[124:127], v[172:175], v[48:51], v[124:127]
    s_waitcnt lgkmcnt(1)
    v_mfma_f32_16x16x32_bf16 v[96:99], v[176:179], v[32:35], v[96:99]
    ds_read2_b64 v[168:171], v3 offset0:20 offset1:16
    v_mfma_f32_16x16x32_bf16 v[104:107], v[176:179], v[36:39], v[104:107]
    buffer_load_dwordx4 a[228:231], v252, s[60:63], s27 offen offset:1024 sc1
    v_mfma_f32_16x16x32_bf16 v[112:115], v[176:179], v[40:43], v[112:115]
    v_mfma_f32_16x16x32_bf16 v[120:123], v[176:179], v[44:47], v[120:123]
    v_mfma_f32_16x16x32_bf16 v[128:131], v[176:179], v[48:51], v[128:131]
    s_waitcnt lgkmcnt(1)
    v_mfma_f32_16x16x32_bf16 v[100:103], v[164:167], v[32:35], v[100:103]
    ds_read2_b64 v[172:175], v3 offset0:36 offset1:32
    buffer_load_dwordx4 a[232:235], v252, s[60:63], s27 offen offset:2048 sc1
    v_mfma_f32_16x16x32_bf16 v[108:111], v[164:167], v[36:39], v[108:111]
    v_mfma_f32_16x16x32_bf16 v[116:119], v[164:167], v[40:43], v[116:119]
    v_mfma_f32_16x16x32_bf16 v[124:127], v[164:167], v[44:47], v[124:127]
    s_waitcnt lgkmcnt(1)
    v_mfma_f32_16x16x32_bf16 v[96:99], v[168:171], v[28:31], v[96:99]
    ds_read2_b64 v[176:179], v3 offset0:52 offset1:48
    buffer_load_dwordx4 a[236:239], v252, s[60:63], s27 offen offset:3072 sc1
    v_mfma_f32_16x16x32_bf16 v[104:107], v[168:171], v[32:35], v[104:107]
    v_mfma_f32_16x16x32_bf16 v[112:115], v[168:171], v[36:39], v[112:115]
    v_mfma_f32_16x16x32_bf16 v[120:123], v[168:171], v[40:43], v[120:123]
    s_add_u32 s27, s27, 4096
    s_cmp_eq_u32 s68, 12
    s_cselect_b32 s27, s74, s27
    buffer_load_dwordx4 a[240:243], v252, s[60:63], s27 offen offset:0 sc1
    v_mfma_f32_16x16x32_bf16 v[128:131], v[168:171], v[44:47], v[128:131]
    s_waitcnt lgkmcnt(1)
    v_mfma_f32_16x16x32_bf16 v[100:103], v[172:175], v[28:31], v[100:103]
    ds_read2_b64 v[164:167], v3 offset0:68 offset1:64
    v_mfma_f32_16x16x32_bf16 v[108:111], v[172:175], v[32:35], v[108:111]
    v_mfma_f32_16x16x32_bf16 v[116:119], v[172:175], v[36:39], v[116:119]
    buffer_load_dwordx4 a[244:247], v252, s[60:63], s27 offen offset:1024 sc1
    v_mfma_f32_16x16x32_bf16 v[124:127], v[172:175], v[40:43], v[124:127]
    s_waitcnt lgkmcnt(1)
    v_mfma_f32_16x16x32_bf16 v[96:99], v[176:179], v[24:27], v[96:99]
    ds_read2_b64 v[168:171], v3 offset0:84 offset1:80
    v_mfma_f32_16x16x32_bf16 v[104:107], v[176:179], v[28:31], v[104:107]
    v_mfma_f32_16x16x32_bf16 v[112:115], v[176:179], v[32:35], v[112:115]
    buffer_load_dwordx4 a[248:251], v252, s[60:63], s27 offen offset:2048 sc1
    v_mfma_f32_16x16x32_bf16 v[120:123], v[176:179], v[36:39], v[120:123]
    v_mfma_f32_16x16x32_bf16 v[128:131], v[176:179], v[40:43], v[128:131]
    s_waitcnt lgkmcnt(1)
    v_mfma_f32_16x16x32_bf16 v[100:103], v[164:167], v[24:27], v[100:103]
    ds_read2_b64 v[172:175], v3 offset0:100 offset1:96
    v_mfma_f32_16x16x32_bf16 v[108:111], v[164:167], v[28:31], v[108:111]
    buffer_load_dwordx4 a[252:255], v252, s[60:63], s27 offen offset:3072 sc1
    s_cmp_lg_u32 s5, 0
    s_cbranch_scc1 Lz_16
    v_mov_b32 v253, 0
    s_mov_b64 exec, 1
    buffer_atomic_add v253, v255, s[60:63], s81 offen sc0 sc1
    s_mov_b64 exec, -1
Lz_16:
    s_nop 0
    v_mfma_f32_16x16x32_bf16 v[116:119], v[164:167], v[32:35], v[116:119]
    v_mfma_f32_16x16x32_bf16 v[124:127], v[164:167], v[36:39], v[124:127]
    s_waitcnt lgkmcnt(1)
    v_mfma_f32_16x16x32_bf16 v[96:99], v[168:171], v[20:23], v[96:99]
    ds_read2_b64 v[176:179], v3 offset0:116 offset1:112
    s_add_u32 s27, s27, 4096
    buffer_load_dwordx4 v[188:191], v252, s[60:63], s27 offen offset:0 sc1
    v_mfma_f32_16x16x32_bf16 v[104:107], v[168:171], v[24:27], v[104:107]
    v_mfma_f32_16x16x32_bf16 v[112:115], v[168:171], v[28:31], v[112:115]
    v_mfma_f32_16x16x32_bf16 v[120:123], v[168:171], v[32:35], v[120:123]
    v_mfma_f32_16x16x32_bf16 v[128:131], v[168:171], v[36:39], v[128:131]
    buffer_load_dwordx4 v[192:195], v252, s[60:63], s27 offen offset:1024 sc1
    s_waitcnt lgkmcnt(1)
    v_mfma_f32_16x16x32_bf16 v[100:103], v[172:175], v[20:23], v[100:103]
    ds_read2_b64 v[164:167], v3 offset0:132 offset1:128
    v_mfma_f32_16x16x32_bf16 v[108:111], v[172:175], v[24:27], v[108:111]
    v_mfma_f32_16x16x32_bf16 v[116:119], v[172:175], v[28:31], v[116:119]
    v_mfma_f32_16x16x32_bf16 v[124:127], v[172:175], v[32:35], v[124:127]
    buffer_load_dwordx4 v[196:199], v252, s[60:63], s27 offen offset:2048 sc1
    s_waitcnt lgkmcnt(1)
    v_mfma_f32_16x16x32_bf16 v[96:99], v[176:179], v[16:19], v[96:99]
    ds_read2_b64 v[168:171], v3 offset0:148 offset1:144
    v_mfma_f32_16x16x32_bf16 v[104:107], v[176:179], v[20:23], v[104:107]
    v_mfma_f32_16x16x32_bf16 v[112:115], v[176:179], v[24:27], v[112:115]
    buffer_load_dwordx4 v[200:203], v252, s[60:63], s27 offen offset:3072 sc1
    v_mfma_f32_16x16x32_bf16 v[120:123], v[176:179], v[28:31], v[120:123]
    s_nop 2
    v_add_f32_dpp v133, v99, v98 wave_shr:1 row_mask:0xf bank_mask:0xf bound_ctrl:0
    v_mfma_f32_16x16x32_bf16 v[128:131], v[176:179], v[32:35], v[128:131]
    s_nop 0
    v_add_f32_dpp v135, v133, v97 wave_shr:1 row_mask:0xf bank_mask:0xf bound_ctrl:0
    s_waitcnt lgkmcnt(1)
    v_mfma_f32_16x16x32_bf16 v[100:103], v[164:167], v[16:19], v[100:103]
    ds_read2_b64 v[172:175], v3 offset0:164 offset1:160
    v_mfma_f32_16x16x32_bf16 v[108:111], v[164:167], v[20:23], v[108:111]
    s_add_u32 s27, s27, 4096
    buffer_load_dwordx4 v[204:207], v252, s[60:63], s27 offen offset:0 sc1
    v_mfma_f32_16x16x32_bf16 v[116:119], v[164:167], v[24:27], v[116:119]
    v_mfma_f32_16x16x32_bf16 v[124:127], v[164:167], v[28:31], v[124:127]
    s_nop 1
    v_add_f32_dpp v132, v99, v102 wave_ror:1 row_mask:0xf bank_mask:0xf
    s_waitcnt lgkmcnt(1)
    v_mfma_f32_16x16x32_bf16 v[104:107], v[168:171], v[16:19], v[104:107]
    ds_read2_b64 v[176:179], v3 offset0:180 offset1:176
    v_add_f32_dpp v134, v133, v101 wave_ror:1 row_mask:0xf bank_mask:0xf
    v_mfma_f32_16x16x32_bf16 v[112:115], v[168:171], v[20:23], v[112:115]
    buffer_load_dwordx4 v[208:211], v252, s[60:63], s27 offen offset:1024 sc1
    v_add_f32_dpp v136, v135, v100 wave_ror:1 row_mask:0xf bank_mask:0xf
    v_mfma_f32_16x16x32_bf16 v[120:123], v[168:171], v[24:27], v[120:123]
    v_add_f32_dpp v132, v103, v102 wave_shr:1 row_mask:0xf bank_mask:0xf
    v_mfma_f32_16x16x32_bf16 v[128:131], v[168:171], v[28:31], v[128:131]
    s_nop 0
    v_add_f32_dpp v134, v132, v101 wave_shr:1 row_mask:0xf bank_mask:0xf
    s_waitcnt lgkmcnt(1)
    v_mfma_f32_16x16x32_bf16 v[108:111], v[172:175], v[16:19], v[108:111]
    ds_read2_b64 v[164:167], v3 offset0:196 offset1:192
    v_add_f32_dpp v136, v134, v100 wave_shr:1 row_mask:0xf bank_mask:0xf
    v_add_f32_dpp v133, v103, v106 wave_ror:1 row_mask:0xf bank_mask:0xf
    v_mfma_f32_16x16x32_bf16 v[116:119], v[172:175], v[20:23], v[116:119]
    s_cmp_lg_u32 s5, 0
    s_cbranch_scc1 Lok_17
    s_mov_b32 s82, 0
    s_waitcnt vmcnt(6)
Lspin_18:
    v_cmp_gt_u32 vcc, 14, v253
    s_add_u32 s82, s82, 1
    s_cmp_ge_u32 s82, 200000
    s_cbranch_scc1 Lok_17
    s_and_b32 s83, vcc_lo, 1
    s_cbranch_scc0 Lok_17
    s_sleep 2
    v_mov_b32 v253, 0
    s_mov_b64 exec, 1
    buffer_atomic_add v253, v255, s[60:63], s81 offen sc0 sc1
    s_mov_b64 exec, -1
    s_waitcnt vmcnt(0)
    s_branch Lspin_18
Lok_17:
    s_barrier
    v_add_f32_dpp v135, v132, v105 wave_ror:1 row_mask:0xf bank_mask:0xf
    v_add_f32_dpp v137, v134, v104 wave_ror:1 row_mask:0xf bank_mask:0xf
    v_mfma_f32_16x16x32_bf16 v[124:127], v[172:175], v[24:27], v[124:127]
    buffer_load_dwordx4 v[32:35], v8, s[60:63], s17 offen sc1
    v_add_f32_dpp v133, v107, v106 wave_shr:1 row_mask:0xf bank_mask:0xf
    s_nop 1
    v_add_f32_dpp v135, v133, v105 wave_shr:1 row_mask:0xf bank_mask:0xf
    s_waitcnt lgkmcnt(1)
    v_mfma_f32_16x16x32_bf16 v[112:115], v[176:179], v[16:19], v[112:115]
    ds_read2_b64 v[168:171], v3 offset0:212 offset1:208
    buffer_load_dwordx4 v[36:39], v9, s[60:63], s17 offen sc1
    v_add_f32_dpp v137, v135, v104 wave_shr:1 row_mask:0xf bank_mask:0xf
    v_cvt_pk_bf16_f32 v144, v136, v137
    v_mfma_f32_16x16x32_bf16 v[120:123], v[176:179], v[20:23], v[120:123]
    buffer_load_dwordx4 v[40:43], v10, s[60:63], s17 offen sc1
    v_add_f32_dpp v132, v107, v110 wave_ror:1 row_mask:0xf bank_mask:0xf
    v_add_f32_dpp v134, v133, v109 wave_ror:1 row_mask:0xf bank_mask:0xf
    v_mfma_f32_16x16x32_bf16 v[128:131], v[176:179], v[24:27], v[128:131]
    buffer_load_dwordx4 v[44:47], v11, s[60:63], s17 offen sc1
    v_add_f32_dpp v136, v135, v108 wave_ror:1 row_mask:0xf bank_mask:0xf
    v_add_f32_dpp v132, v111, v110 wave_shr:1 row_mask:0xf bank_mask:0xf
    s_waitcnt lgkmcnt(1)
    v_mfma_f32_16x16x32_bf16 v[116:119], v[164:167], v[16:19], v[116:119]
    ds_read2_b64 v[172:175], v3 offset0:228 offset1:224
    s_add_u32 s20, s20, 4096
    buffer_load_dwordx4 v[48:51], v8, s[60:63], s20 offen sc1
    v_add_f32_dpp v134, v132, v109 wave_shr:1 row_mask:0xf bank_mask:0xf
    s_nop 1
    v_add_f32_dpp v136, v134, v108 wave_shr:1 row_mask:0xf bank_mask:0xf
    v_mfma_f32_16x16x32_bf16 v[124:127], v[164:167], v[20:23], v[124:127]
    buffer_load_dwordx4 v[52:55], v9, s[60:63], s20 offen sc1
    v_add_f32_dpp v133, v111, v114 wave_ror:1 row_mask:0xf bank_mask:0xf
    v_add_f32_dpp v135, v132, v113 wave_ror:1 row_mask:0xf bank_mask:0xf
    s_waitcnt lgkmcnt(1)
    v_mfma_f32_16x16x32_bf16 v[120:123], v[168:171], v[16:19], v[120:123]
    ds_read2_b64 v[176:179], v3 offset0:244 offset1:240
    buffer_load_dwordx4 v[56:59], v10, s[60:63], s20 offen sc1
    v_add_f32_dpp v137, v134, v112 wave_ror:1 row_mask:0xf bank_mask:0xf
    v_add_f32_dpp v133, v115, v114 wave_shr:1 row_mask:0xf bank_mask:0xf
    v_mfma_f32_16x16x32_bf16 v[128:131], v[168:171], v[20:23], v[128:131]
    buffer_load_dwordx4 v[60:63], v11, s[60:63], s20 offen sc1
    v_add_f32_dpp v135, v133, v113 wave_shr:1 row_mask:0xf bank_mask:0xf
    s_nop 1
    v_add_f32_dpp v137, v135, v112 wave_shr:1 row_mask:0xf bank_mask:0xf
    s_waitcnt lgkmcnt(1)
    v_mfma_f32_16x16x32_bf16 v[124:127], v[172:175], v[16:19], v[124:127]
    s_add_u32 s20, s20, 4096
    v_cvt_pk_bf16_f32 v145, v136, v137
    v_add_f32_dpp v132, v115, v118 wave_ror:1 row_mask:0xf bank_mask:0xf
    s_waitcnt lgkmcnt(0)
    v_mfma_f32_16x16x32_bf16 v[128:131], v[176:179], v[16:19], v[128:131]
    v_add_f32_dpp v134, v133, v117 wave_ror:1 row_mask:0xf bank_mask:0xf
    v_add_f32_dpp v136, v135, v116 wave_ror:1 row_mask:0xf bank_mask:0xf
    v_add_f32_dpp v132, v119, v118 wave_shr:1 row_mask:0xf bank_mask:0xf
    s_nop 1
    v_add_f32_dpp v134, v132, v117 wave_shr:1 row_mask:0xf bank_mask:0xf
    s_nop 1
    v_add_f32_dpp v136, v134, v116 wave_shr:1 row_mask:0xf bank_mask:0xf
    v_add_f32_dpp v133, v119, v122 wave_ror:1 row_mask:0xf bank_mask:0xf
    v_add_f32_dpp v135, v132, v121 wave_ror:1 row_mask:0xf bank_mask:0xf
    v_add_f32_dpp v137, v134, v120 wave_ror:1 row_mask:0xf bank_mask:0xf
    v_add_f32_dpp v133, v123, v122 wave_shr:1 row_mask:0xf bank_mask:0xf
    s_nop 1
    v_add_f32_dpp v135, v133, v121 wave_shr:1 row_mask:0xf bank_mask:0xf
    s_nop 1
    v_add_f32_dpp v137, v135, v120 wave_shr:1 row_mask:0xf bank_mask:0xf
    v_cvt_pk_bf16_f32 v146, v136, v137
    v_add_f32_dpp v132, v123, v126 wave_ror:1 row_mask:0xf bank_mask:0xf
    v_add_f32_dpp v134, v133, v125 wave_ror:1 row_mask:0xf bank_mask:0xf
    v_add_f32_dpp v136, v135, v124 wave_ror:1 row_mask:0xf bank_mask:0xf
    v_add_f32_dpp v132, v127, v126 wave_shr:1 row_mask:0xf bank_mask:0xf
    s_nop 1
    v_add_f32_dpp v134, v132, v125 wave_shr:1 row_mask:0xf bank_mask:0xf
    s_nop 1
    v_add_f32_dpp v136, v134, v124 wave_shr:1 row_mask:0xf bank_mask:0xf
    v_add_f32_dpp v133, v127, v130 wave_ror:1 row_mask:0xf bank_mask:0xf
    v_add_f32_dpp v135, v132, v129 wave_ror:1 row_mask:0xf bank_mask:0xf
    v_add_f32_dpp v137, v134, v128 wave_ror:1 row_mask:0xf bank_mask:0xf
    v_add_f32_dpp v133, v131, v130 wave_shr:1 row_mask:0xf bank_mask:0xf
    s_nop 1
    v_add_f32_dpp v135, v133, v129 wave_shr:1 row_mask:0xf bank_mask:0xf
    s_nop 1
    v_add_f32_dpp v137, v135, v128 wave_shr:1 row_mask:0xf bank_mask:0xf
    v_cvt_pk_bf16_f32 v147, v136, v137
    s_add_u32 s6, s13, 1966080
    buffer_store_dwordx4 v[144:147], v5, s[60:63], s6 offen sc1
    s_branch LconvE_12
LconvB_11:
    v_mfma_f32_16x16x32_bf16 v[68:71], v[164:167], v[32:35], 0
    ds_read2_b64 v[172:175], v2 offset0:36 offset1:32
    v_mfma_f32_16x16x32_bf16 v[76:79], v[164:167], v[36:39], 0
    v_mfma_f32_16x16x32_bf16 v[84:87], v[164:167], v[40:43], 0
    v_mfma_f32_16x16x32_bf16 v[92:95], v[164:167], v[44:47], 0
    v_mfma_f32_16x16x32_bf16 v[100:103], v[164:167], v[48:51], 0
    v_mfma_f32_16x16x32_bf16 v[108:111], v[164:167], v[52:55], 0
    s_add_u32 m0, s21, 0
    s_add_u32 s79, s7, 0
    buffer_load_dwordx4 v12, s[36:39], s79 offen lds
    v_mfma_f32_16x16x32_bf16 v[116:119], v[164:167], v[56:59], 0
    v_mfma_f32_16x16x32_bf16 v[124:127], v[164:167], v[60:63], 0
    v_mfma_f32_16x16x32_bf16 v[64:67], v[168:171], v[28:31], 0
    ds_read2_b64 v[176:179], v2 offset0:52 offset1:48
    s_add_u32 m0, s21, 1088
    s_add_u32 s79, s7, 327680
    buffer_load_dwordx4 v12, s[36:39], s79 offen lds
    v_mfma_f32_16x16x32_bf16 v[72:75], v[168:171], v[32:35], 0
    v_mfma_f32_16x16x32_bf16 v[80:83], v[168:171], v[36:39], 0
    s_add_u32 m0, s21, 2176
    s_add_u32 s79, s7, 1280
    buffer_load_dwordx4 v12, s[36:39], s79 offen lds
    v_mfma_f32_16x16x32_bf16 v[88:91], v[168:171], v[40:43], 0
    v_mfma_f32_16x16x32_bf16 v[96:99], v[168:171], v[44:47], 0
    s_add_u32 m0, s21, 3264
    s_add_u32 s79, s7, 328960
    buffer_load_dwordx4 v12, s[36:39], s79 offen lds
    v_mfma_f32_16x16x32_bf16 v[104:107], v[168:171], v[48:51], 0
    v_mfma_f32_16x16x32_bf16 v[112:115], v[168:171], v[52:55], 0
    s_mul_i32 s79, s12, 160
    v_min_u32 v14, 39, v1
    v_mfma_f32_16x16x32_bf16 v[120:123], v[168:171], v[56:59], 0
    v_mfma_f32_16x16x32_bf16 v[128:131], v[168:171], v[60:63], 0
    s_waitcnt lgkmcnt(1)
    v_mfma_f32_16x16x32_bf16 v[68:71], v[172:175], v[28:31], v[68:71]
    ds_read2_b64 v[164:167], v2 offset0:68 offset1:64
    v_lshl_add_u32 v14, v14, 2, s79
    v_mfma_f32_16x16x32_bf16 v[76:79], v[172:175], v[32:35], v[76:79]
    v_mfma_f32_16x16x32_bf16 v[84:87], v[172:175], v[36:39], v[84:87]
    s_add_u32 m0, s21, 4352
    s_nop 0
    global_load_lds_dword v14, s[28:29]
    v_mfma_f32_16x16x32_bf16 v[92:95], v[172:175], v[40:43], v[92:95]
    v_mfma_f32_16x16x32_bf16 v[100:103], v[172:175], v[44:47], v[100:103]
    v_lshrrev_b32 v15, 4, v1
    v_mfma_f32_16x16x32_bf16 v[108:111], v[172:175], v[48:51], v[108:111]
    v_mfma_f32_16x16x32_bf16 v[116:119], v[172:175], v[52:55], v[116:119]
    v_lshl_add_u32 v15, v15, 3, s21
    v_mfma_f32_16x16x32_bf16 v[124:127], v[172:175], v[56:59], v[124:127]
    s_waitcnt lgkmcnt(1)
    v_mfma_f32_16x16x32_bf16 v[64:67], v[176:179], v[24:27], v[64:67]
    ds_read2_b64 v[168:171], v2 offset0:84 offset1:80
    s_cmp_eq_u32 s68, 8
    s_cselect_b32 s27, s74, s27
    buffer_load_dwordx4 a[160:163], v252, s[60:63], s27 offen offset:0 sc1
    v_mfma_f32_16x16x32_bf16 v[72:75], v[176:179], v[28:31], v[72:75]
    v_mfma_f32_16x16x32_bf16 v[80:83], v[176:179], v[32:35], v[80:83]
    v_mfma_f32_16x16x32_bf16 v[88:91], v[176:179], v[36:39], v[88:91]
    v_mfma_f32_16x16x32_bf16 v[96:99], v[176:179], v[40:43], v[96:99]
    buffer_load_dwordx4 a[164:167], v252, s[60:63], s27 offen offset:1024 sc1
    v_mfma_f32_16x16x32_bf16 v[104:107], v[176:179], v[44:47], v[104:107]
    v_mfma_f32_16x16x32_bf16 v[112:115], v[176:179], v[48:51], v[112:115]
    v_mfma_f32_16x16x32_bf16 v[120:123], v[176:179], v[52:55], v[120:123]
    buffer_load_dwordx4 a[168:171], v252, s[60:63], s27 offen offset:2048 sc1
    v_mfma_f32_16x16x32_bf16 v[128:131], v[176:179], v[56:59], v[128:131]
    s_waitcnt lgkmcnt(1)
    v_mfma_f32_16x16x32_bf16 v[68:71], v[164:167], v[24:27], v[68:71]
    ds_read2_b64 v[172:175], v2 offset0:100 offset1:96
    v_mfma_f32_16x16x32_bf16 v[76:79], v[164:167], v[28:31], v[76:79]
    v_mfma_f32_16x16x32_bf16 v[84:87], v[164:167], v[32:35], v[84:87]
    buffer_load_dwordx4 a[172:175], v252, s[60:63], s27 offen offset:3072 sc1
    v_mfma_f32_16x16x32_bf16 v[92:95], v[164:167], v[36:39], v[92:95]
    v_mfma_f32_16x16x32_bf16 v[100:103], v[164:167], v[40:43], v[100:103]
    v_mfma_f32_16x16x32_bf16 v[108:111], v[164:167], v[44:47], v[108:111]
    s_add_u32 s27, s27, 4096
    buffer_load_dwordx4 a[176:179], v252, s[60:63], s27 offen offset:0 sc1
    v_mfma_f32_16x16x32_bf16 v[116:119], v[164:167], v[48:51], v[116:119]
    v_mfma_f32_16x16x32_bf16 v[124:127], v[164:167], v[52:55], v[124:127]
    s_waitcnt lgkmcnt(1)
    v_mfma_f32_16x16x32_bf16 v[64:67], v[168:171], v[20:23], v[64:67]
    ds_read2_b64 v[176:179], v2 offset0:116 offset1:112
    v_mfma_f32_16x16x32_bf16 v[72:75], v[168:171], v[24:27], v[72:75]
    buffer_load_dwordx4 a[180:183], v252, s[60:63], s27 offen offset:1024 sc1
    s_cmp_eq_u32 s85, 0
    s_cbranch_scc1 Lh_19
    s_waitcnt vmcnt(11)
    v_mov_b32 v6, 1
    v_mov_b32 v7, 148992
    s_mov_b64 exec, 1
    ds_add_rtn_u32 v7, v7, v6
    s_mov_b64 exec, -1
Lh_19:
    s_nop 0
    v_mfma_f32_16x16x32_bf16 v[80:83], v[168:171], v[28:31], v[80:83]
    v_mfma_f32_16x16x32_bf16 v[88:91], v[168:171], v[32:35], v[88:91]
    v_mfma_f32_16x16x32_bf16 v[96:99], v[168:171], v[36:39], v[96:99]
    buffer_load_dwordx4 a[184:187], v252, s[60:63], s27 offen offset:2048 sc1
    v_mfma_f32_16x16x32_bf16 v[104:107], v[168:171], v[40:43], v[104:107]
    v_mfma_f32_16x16x32_bf16 v[112:115], v[168:171], v[44:47], v[112:115]
    v_mfma_f32_16x16x32_bf16 v[120:123], v[168:171], v[48:51], v[120:123]
    v_mfma_f32_16x16x32_bf16 v[128:131], v[168:171], v[52:55], v[128:131]
    buffer_load_dwordx4 a[188:191], v252, s[60:63], s27 offen offset:3072 sc1
    s_waitcnt lgkmcnt(1)
    v_mfma_f32_16x16x32_bf16 v[68:71], v[172:175], v[20:23], v[68:71]
    ds_read2_b64 v[164:167], v2 offset0:132 offset1:128
    s_cmp_eq_u32 s85, 0
    s_cbranch_scc1 Lh_20
    s_lshl_b32 s6, s72, 7
    s_add_u32 s6, s6, 2048
    s_waitcnt lgkmcnt(1)
    v_readfirstlane_b32 s83, v7
    s_nop 1
    s_cmp_lg_u32 s83, 3
    s_cbranch_scc1 Lsig_21
    s_mov_b64 exec, 1
    buffer_atomic_add v6, v255, s[60:63], s6 offen sc1
    s_mov_b64 exec, -1
Lsig_21:
Lh_20:
    s_nop 0
    v_mfma_f32_16x16x32_bf16 v[76:79], v[172:175], v[24:27], v[76:79]
    v_mfma_f32_16x16x32_bf16 v[84:87], v[172:175], v[28:31], v[84:87]
    s_add_u32 s27, s27, 4096
    buffer_load_dwordx4 a[192:195], v252, s[60:63], s27 offen offset:0 sc1
    v_mfma_f32_16x16x32_bf16 v[92:95], v[172:175], v[32:35], v[92:95]
    v_mfma_f32_16x16x32_bf16 v[100:103], v[172:175], v[36:39], v[100:103]
    v_mfma_f32_16x16x32_bf16 v[108:111], v[172:175], v[40:43], v[108:111]
    buffer_load_dwordx4 a[196:199], v252, s[60:63], s27 offen offset:1024 sc1
    v_mfma_f32_16x16x32_bf16 v[116:119], v[172:175], v[44:47], v[116:119]
    v_mfma_f32_16x16x32_bf16 v[124:127], v[172:175], v[48:51], v[124:127]
    s_waitcnt lgkmcnt(1)
    v_mfma_f32_16x16x32_bf16 v[64:67], v[176:179], v[16:19], v[64:67]
    ds_read2_b64 v[168:171], v2 offset0:148 offset1:144
    v_mfma_f32_16x16x32_bf16 v[72:75], v[176:179], v[20:23], v[72:75]
    buffer_load_dwordx4 a[200:203], v252, s[60:63], s27 offen offset:2048 sc1
    v_mfma_f32_16x16x32_bf16 v[80:83], v[176:179], v[24:27], v[80:83]
    v_mfma_f32_16x16x32_bf16 v[88:91], v[176:179], v[28:31], v[88:91]
    s_nop 2
    v_add_f32_dpp v133, v67, v66 wave_shr:1 row_mask:0xf bank_mask:0xf bound_ctrl:0
    v_mfma_f32_16x16x32_bf16 v[96:99], v[176:179], v[32:35], v[96:99]
    buffer_load_dwordx4 a[204:207], v252, s[60:63], s27 offen offset:3072 sc1
    v_add_f32_dpp v135, v133, v65 wave_shr:1 row_mask:0xf bank_mask:0xf bound_ctrl:0
    v_mfma_f32_16x16x32_bf16 v[104:107], v[176:179], v[36:39], v[104:107]
    v_mfma_f32_16x16x32_bf16 v[112:115], v[176:179], v[40:43], v[112:115]
    v_mfma_f32_16x16x32_bf16 v[120:123], v[176:179], v[44:47], v[120:123]
    v_mfma_f32_16x16x32_bf16 v[128:131], v[176:179], v[48:51], v[128:131]
    s_add_u32 s27, s27, 4096
    buffer_load_dwordx4 a[208:211], v252, s[60:63], s27 offen offset:0 sc1
    s_waitcnt lgkmcnt(1)
    v_mfma_f32_16x16x32_bf16 v[68:71], v[164:167], v[16:19], v[68:71]
    ds_read2_b64 v[172:175], v2 offset0:164 offset1:160
    v_mfma_f32_16x16x32_bf16 v[76:79], v[164:167], v[20:23], v[76:79]
    v_mfma_f32_16x16x32_bf16 v[84:87], v[164:167], v[24:27], v[84:87]
    buffer_load_dwordx4 a[212:215], v252, s[60:63], s27 offen offset:1024 sc1
    v_mfma_f32_16x16x32_bf16 v[92:95], v[164:167], v[28:31], v[92:95]
    s_nop 2
    v_add_f32_dpp v132, v67, v70 wave_ror:1 row_mask:0xf bank_mask:0xf
    v_mfma_f32_16x16x32_bf16 v[100:103], v[164:167], v[32:35], v[100:103]
    v_add_f32_dpp v134, v133, v69 wave_ror:1 row_mask:0xf bank_mask:0xf
    v_mfma_f32_16x16x32_bf16 v[108:111], v[164:167], v[36:39], v[108:111]
    v_add_f32_dpp v136, v135, v68 wave_ror:1 row_mask:0xf bank_mask:0xf
    v_mfma_f32_16x16x32_bf16 v[116:119], v[164:167], v[40:43], v[116:119]
    buffer_load_dwordx4 a[216:219], v252, s[60:63], s27 offen offset:2048 sc1
    v_add_f32_dpp v132, v71, v70 wave_shr:1 row_mask:0xf bank_mask:0xf
    v_mfma_f32_16x16x32_bf16 v[124:127], v[164:167], v[44:47], v[124:127]
    s_nop 0
    v_add_f32_dpp v134, v132, v69 wave_shr:1 row_mask:0xf bank_mask:0xf
    s_waitcnt lgkmcnt(1)
    v_mfma_f32_16x16x32_bf16 v[72:75], v[168:171], v[16:19], v[72:75]
    ds_read2_b64 v[176:179], v2 offset0:180 offset1:176
    v_add_f32_dpp v136, v134, v68 wave_shr:1 row_mask:0xf bank_mask:0xf
    v_mfma_f32_16x16x32_bf16 v[80:83], v[168:171], v[20:23], v[80:83]
    buffer_load_dwordx4 a[220:223], v252, s[60:63], s27 offen offset:3072 sc1
    v_mfma_f32_16x16x32_bf16 v[88:91], v[168:171], v[24:27], v[88:91]
    v_mfma_f32_16x16x32_bf16 v[96:99], v[168:171], v[28:31], v[96:99]
    s_nop 1
    v_add_f32_dpp v133, v71, v74 wave_ror:1 row_mask:0xf bank_mask:0xf
    v_mfma_f32_16x16x32_bf16 v[104:107], v[168:171], v[32:35], v[104:107]
    s_add_u32 s27, s27, 4096
    buffer_load_dwordx4 a[224:227], v252, s[60:63], s27 offen offset:0 sc1
    v_add_f32_dpp v135, v132, v73 wave_ror:1 row_mask:0xf bank_mask:0xf
    v_mfma_f32_16x16x32_bf16 v[112:115], v[168:171], v[36:39], v[112:115]
    v_add_f32_dpp v137, v134, v72 wave_ror:1 row_mask:0xf bank_mask:0xf
    v_mfma_f32_16x16x32_bf16 v[120:123], v[168:171], v[40:43], v[120:123]
    v_add_f32_dpp v133, v75, v74 wave_shr:1 row_mask:0xf bank_mask:0xf
    v_mfma_f32_16x16x32_bf16 v[128:131], v[168:171], v[44:47], v[128:131]
    s_nop 0
    v_add_f32_dpp v135, v133, v73 wave_shr:1 row_mask:0xf bank_mask:0xf
    s_waitcnt lgkmcnt(1)
    v_mfma_f32_16x16x32_bf16 v[76:79], v[172:175], v[16:19], v[76:79]
    ds_read2_b64 v[164:167], v2 offset0:196 offset1:192
    buffer_load_dwordx4 a[228:231], v252, s[60:63], s27 offen offset:1024 sc1
    v_add_f32_dpp v137, v135, v72 wave_shr:1 row_mask:0xf bank_mask:0xf
    v_mfma_f32_16x16x32_bf16 v[84:87], v[172:175], v[20:23], v[84:87]
    v_cvt_pk_bf16_f32 v144, v136, v137
    v_mfma_f32_16x16x32_bf16 v[92:95], v[172:175], v[24:27], v[92:95]
    v_mfma_f32_16x16x32_bf16 v[100:103], v[172:175], v[28:31], v[100:103]
    buffer_load_dwordx4 a[232:235], v252, s[60:63], s27 offen offset:2048 sc1
    v_add_f32_dpp v132, v75, v78 wave_ror:1 row_mask:0xf bank_mask:0xf
    v_mfma_f32_16x16x32_bf16 v[108:111], v[172:175], v[32:35], v[108:111]
    v_add_f32_dpp v134, v133, v77 wave_ror:1 row_mask:0xf bank_mask:0xf
    v_mfma_f32_16x16x32_bf16 v[116:119], v[172:175], v[36:39], v[116:119]
    v_add_f32_dpp v136, v135, v76 wave_ror:1 row_mask:0xf bank_mask:0xf
    v_mfma_f32_16x16x32_bf16 v[124:127], v[172:175], v[40:43], v[124:127]
    v_add_f32_dpp v132, v79, v78 wave_shr:1 row_mask:0xf bank_mask:0xf
    s_waitcnt lgkmcnt(1)
    v_mfma_f32_16x16x32_bf16 v[80:83], v[176:179], v[16:19], v[80:83]
    ds_read2_b64 v[168:171], v2 offset0:212 offset1:208
    buffer_load_dwordx4 a[236:239], v252, s[60:63], s27 offen offset:3072 sc1
    v_add_f32_dpp v134, v132, v77 wave_shr:1 row_mask:0xf bank_mask:0xf
    v_mfma_f32_16x16x32_bf16 v[88:91], v[176:179], v[20:23], v[88:91]
    s_nop 0
    v_add_f32_dpp v136, v134, v76 wave_shr:1 row_mask:0xf bank_mask:0xf
    v_mfma_f32_16x16x32_bf16 v[96:99], v[176:179], v[24:27], v[96:99]
    v_mfma_f32_16x16x32_bf16 v[104:107], v[176:179], v[28:31], v[104:107]
    s_add_u32 s27, s27, 4096
    s_cmp_eq_u32 s68, 12
    s_cselect_b32 s27, s74, s27
    buffer_load_dwordx4 a[240:243], v252, s[60:63], s27 offen offset:0 sc1
    v_add_f32_dpp v133, v79, v82 wave_ror:1 row_mask:0xf bank_mask:0xf
    v_mfma_f32_16x16x32_bf16 v[112:115], v[176:179], v[32:35], v[112:115]
    v_add_f32_dpp v135, v132, v81 wave_ror:1 row_mask:0xf bank_mask:0xf
    v_mfma_f32_16x16x32_bf16 v[120:123], v[176:179], v[36:39], v[120:123]
    v_add_f32_dpp v137, v134, v80 wave_ror:1 row_mask:0xf bank_mask:0xf
    v_mfma_f32_16x16x32_bf16 v[128:131], v[176:179], v[40:43], v[128:131]
    v_add_f32_dpp v133, v83, v82 wave_shr:1 row_mask:0xf bank_mask:0xf
    s_waitcnt lgkmcnt(1)
    v_mfma_f32_16x16x32_bf16 v[84:87], v[164:167], v[16:19], v[84:87]
    ds_read2_b64 v[172:175], v2 offset0:228 offset1:224
    buffer_load_dwordx4 a[244:247], v252, s[60:63], s27 offen offset:1024 sc1
    v_add_f32_dpp v135, v133, v81 wave_shr:1 row_mask:0xf bank_mask:0xf
    v_mfma_f32_16x16x32_bf16 v[92:95], v[164:167], v[20:23], v[92:95]
    s_nop 0
    v_add_f32_dpp v137, v135, v80 wave_shr:1 row_mask:0xf bank_mask:0xf
    v_mfma_f32_16x16x32_bf16 v[100:103], v[164:167], v[24:27], v[100:103]
    v_cvt_pk_bf16_f32 v145, v136, v137
    v_mfma_f32_16x16x32_bf16 v[108:111], v[164:167], v[28:31], v[108:111]
    buffer_load_dwordx4 a[248:251], v252, s[60:63], s27 offen offset:2048 sc1
    v_add_f32_dpp v132, v83, v86 wave_ror:1 row_mask:0xf bank_mask:0xf
    v_mfma_f32_16x16x32_bf16 v[116:119], v[164:167], v[32:35], v[116:119]
    v_add_f32_dpp v134, v133, v85 wave_ror:1 row_mask:0xf bank_mask:0xf
    v_mfma_f32_16x16x32_bf16 v[124:127], v[164:167], v[36:39], v[124:127]
    v_add_f32_dpp v136, v135, v84 wave_ror:1 row_mask:0xf bank_mask:0xf
    s_waitcnt lgkmcnt(1)
    v_mfma_f32_16x16x32_bf16 v[88:91], v[168:171], v[16:19], v[88:91]
    ds_read2_b64 v[176:179], v2 offset0:244 offset1:240
    buffer_load_dwordx4 a[252:255], v252, s[60:63], s27 offen offset:3072 sc1
    v_add_f32_dpp v132, v87, v86 wave_shr:1 row_mask:0xf bank_mask:0xf
    v_mfma_f32_16x16x32_bf16 v[96:99], v[168:171], v[20:23], v[96:99]
    s_nop 0
    v_add_f32_dpp v134, v132, v85 wave_shr:1 row_mask:0xf bank_mask:0xf
    v_mfma_f32_16x16x32_bf16 v[104:107], v[168:171], v[24:27], v[104:107]
    s_nop 0
    v_add_f32_dpp v136, v134, v84 wave_shr:1 row_mask:0xf bank_mask:0xf
    v_mfma_f32_16x16x32_bf16 v[112:115], v[168:171], v[28:31], v[112:115]
    v_add_f32_dpp v133, v87, v90 wave_ror:1 row_mask:0xf bank_mask:0xf
    v_mfma_f32_16x16x32_bf16 v[120:123], v[168:171], v[32:35], v[120:123]
    s_add_u32 s27, s27, 4096
    buffer_load_dwordx4 v[188:191], v252, s[60:63], s27 offen offset:0 sc1
    v_add_f32_dpp v135, v132, v89 wave_ror:1 row_mask:0xf bank_mask:0xf
    v_mfma_f32_16x16x32_bf16 v[128:131], v[168:171], v[36:39], v[128:131]
    v_add_f32_dpp v137, v134, v88 wave_ror:1 row_mask:0xf bank_mask:0xf
    s_waitcnt lgkmcnt(1)
    v_mfma_f32_16x16x32_bf16 v[92:95], v[172:175], v[16:19], v[92:95]
    ds_read2_b64 v[164:167], v3 offset0:4 offset1:0
    v_add_f32_dpp v133, v91, v90 wave_shr:1 row_mask:0xf bank_mask:0xf
    v_mfma_f32_16x16x32_bf16 v[100:103], v[172:175], v[20:23], v[100:103]
    buffer_load_dwordx4 v[192:195], v252, s[60:63], s27 offen offset:1024 sc1
    v_add_f32_dpp v135, v133, v89 wave_shr:1 row_mask:0xf bank_mask:0xf
    v_mfma_f32_16x16x32_bf16 v[108:111], v[172:175], v[24:27], v[108:111]
    s_nop 0
    v_add_f32_dpp v137, v135, v88 wave_shr:1 row_mask:0xf bank_mask:0xf
    v_mfma_f32_16x16x32_bf16 v[116:119], v[172:175], v[28:31], v[116:119]
    v_cvt_pk_bf16_f32 v146, v136, v137
    v_mfma_f32_16x16x32_bf16 v[124:127], v[172:175], v[32:35], v[124:127]
    v_add_f32_dpp v132, v91, v94 wave_ror:1 row_mask:0xf bank_mask:0xf
    s_waitcnt lgkmcnt(1)
    v_mfma_f32_16x16x32_bf16 v[96:99], v[176:179], v[16:19], v[96:99]
    ds_read2_b64 v[168:171], v3 offset0:20 offset1:16
    buffer_load_dwordx4 v[196:199], v252, s[60:63], s27 offen offset:2048 sc1
    v_add_f32_dpp v134, v133, v93 wave_ror:1 row_mask:0xf bank_mask:0xf
    v_mfma_f32_16x16x32_bf16 v[104:107], v[176:179], v[20:23], v[104:107]
    v_add_f32_dpp v136, v135, v92 wave_ror:1 row_mask:0xf bank_mask:0xf
    v_mfma_f32_16x16x32_bf16 v[112:115], v[176:179], v[24:27], v[112:115]
    v_add_f32_dpp v132, v95, v94 wave_shr:1 row_mask:0xf bank_mask:0xf
    v_mfma_f32_16x16x32_bf16 v[120:123], v[176:179], v[28:31], v[120:123]
    buffer_load_dwordx4 v[200:203], v252, s[60:63], s27 offen offset:3072 sc1
    v_add_f32_dpp v134, v132, v93 wave_shr:1 row_mask:0xf bank_mask:0xf
    v_mfma_f32_16x16x32_bf16 v[128:131], v[176:179], v[32:35], v[128:131]
    s_nop 0
    v_add_f32_dpp v136, v134, v92 wave_shr:1 row_mask:0xf bank_mask:0xf
    s_waitcnt lgkmcnt(1)
    v_mfma_f32_16x16x32_bf16 v[100:103], v[164:167], v[16:19], v[100:103]
    ds_read2_b64 v[172:175], v3 offset0:36 offset1:32
    v_add_f32_dpp v133, v95, v98 wave_ror:1 row_mask:0xf bank_mask:0xf
    v_mfma_f32_16x16x32_bf16 v[108:111], v[164:167], v[20:23], v[108:111]
    v_add_f32_dpp v135, v132, v97 wave_ror:1 row_mask:0xf bank_mask:0xf
    v_mfma_f32_16x16x32_bf16 v[116:119], v[164:167], v[24:27], v[116:119]
    s_add_u32 s27, s27, 4096
    buffer_load_dwordx4 v[204:207], v252, s[60:63], s27 offen offset:0 sc1
    v_add_f32_dpp v137, v134, v96 wave_ror:1 row_mask:0xf bank_mask:0xf
    v_mfma_f32_16x16x32_bf16 v[124:127], v[164:167], v[28:31], v[124:127]
    v_add_f32_dpp v133, v99, v98 wave_shr:1 row_mask:0xf bank_mask:0xf
    s_waitcnt lgkmcnt(1)
    v_mfma_f32_16x16x32_bf16 v[104:107], v[168:171], v[16:19], v[104:107]
    ds_read2_b64 v[176:179], v3 offset0:52 offset1:48
    v_add_f32_dpp v135, v133, v97 wave_shr:1 row_mask:0xf bank_mask:0xf
    s_nop 1
    v_add_f32_dpp v137, v135, v96 wave_shr:1 row_mask:0xf bank_mask:0xf
    v_mfma_f32_16x16x32_bf16 v[112:115], v[168:171], v[20:23], v[112:115]
    buffer_load_dwordx4 v[208:211], v252, s[60:63], s27 offen offset:1024 sc1
    v_cvt_pk_bf16_f32 v147, v136, v137
    s_add_u32 s6, s13, 655360
    v_mfma_f32_16x16x32_bf16 v[120:123], v[168:171], v[24:27], v[120:123]
    buffer_store_dwordx4 v[144:147], v5, s[60:63], s6 offen sc1
    v_add_f32_dpp v132, v99, v102 wave_ror:1 row_mask:0xf bank_mask:0xf
    v_mfma_f32_16x16x32_bf16 v[128:131], v[168:171], v[28:31], v[128:131]
    v_add_f32_dpp v134, v133, v101 wave_ror:1 row_mask:0xf bank_mask:0xf
    s_waitcnt lgkmcnt(1)
    v_mfma_f32_16x16x32_bf16 v[108:111], v[172:175], v[16:19], v[108:111]
    ds_read2_b64 v[164:167], v3 offset0:68 offset1:64
    v_add_f32_dpp v136, v135, v100 wave_ror:1 row_mask:0xf bank_mask:0xf
    v_add_f32_dpp v132, v103, v102 wave_shr:1 row_mask:0xf bank_mask:0xf
    v_mfma_f32_16x16x32_bf16 v[116:119], v[172:175], v[20:23], v[116:119]
    s_barrier
    v_add_f32_dpp v134, v132, v101 wave_shr:1 row_mask:0xf bank_mask:0xf
    s_nop 1
    v_add_f32_dpp v136, v134, v100 wave_shr:1 row_mask:0xf bank_mask:0xf
    v_mfma_f32_16x16x32_bf16 v[124:127], v[172:175], v[24:27], v[124:127]
    buffer_load_dwordx4 v[32:35], v8, s[60:63], s17 offen sc1
    v_add_f32_dpp v133, v103, v106 wave_ror:1 row_mask:0xf bank_mask:0xf
    v_add_f32_dpp v135, v132, v105 wave_ror:1 row_mask:0xf bank_mask:0xf
    s_waitcnt lgkmcnt(1)
    v_mfma_f32_16x16x32_bf16 v[112:115], v[176:179], v[16:19], v[112:115]
    ds_read2_b64 v[168:171], v3 offset0:84 offset1:80
    buffer_load_dwordx4 v[36:39], v9, s[60:63], s17 offen sc1
    v_add_f32_dpp v137, v134, v104 wave_ror:1 row_mask:0xf bank_mask:0xf
    v_add_f32_dpp v133, v107, v106 wave_shr:1 row_mask:0xf bank_mask:0xf
    v_mfma_f32_16x16x32_bf16 v[120:123], v[176:179], v[20:23], v[120:123]
    buffer_load_dwordx4 v[40:43], v10, s[60:63], s17 offen sc1
    v_add_f32_dpp v135, v133, v105 wave_shr:1 row_mask:0xf bank_mask:0xf
    s_nop 1
    v_add_f32_dpp v137, v135, v104 wave_shr:1 row_mask:0xf bank_mask:0xf
    v_mfma_f32_16x16x32_bf16 v[128:131], v[176:179], v[24:27], v[128:131]
    buffer_load_dwordx4 v[44:47], v11, s[60:63], s17 offen sc1
    v_cvt_pk_bf16_f32 v140, v136, v137
    v_add_f32_dpp v132, v107, v110 wave_ror:1 row_mask:0xf bank_mask:0xf
    s_waitcnt lgkmcnt(1)
    v_mfma_f32_16x16x32_bf16 v[116:119], v[164:167], v[16:19], v[116:119]
    ds_read2_b64 v[172:175], v3 offset0:100 offset1:96
    s_add_u32 s20, s20, 4096
    buffer_load_dwordx4 v[48:51], v8, s[60:63], s20 offen sc1
    v_add_f32_dpp v134, v133, v109 wave_ror:1 row_mask:0xf bank_mask:0xf
    v_add_f32_dpp v136, v135, v108 wave_ror:1 row_mask:0xf bank_mask:0xf
    v_mfma_f32_16x16x32_bf16 v[124:127], v[164:167], v[20:23], v[124:127]
    buffer_load_dwordx4 v[52:55], v9, s[60:63], s20 offen sc1
    v_add_f32_dpp v132, v111, v110 wave_shr:1 row_mask:0xf bank_mask:0xf
    s_nop 1
    v_add_f32_dpp v134, v132, v109 wave_shr:1 row_mask:0xf bank_mask:0xf
    s_waitcnt lgkmcnt(1)
    v_mfma_f32_16x16x32_bf16 v[120:123], v[168:171], v[16:19], v[120:123]
    ds_read2_b64 v[176:179], v3 offset0:116 offset1:112
    buffer_load_dwordx4 v[56:59], v10, s[60:63], s20 offen sc1
    v_add_f32_dpp v136, v134, v108 wave_shr:1 row_mask:0xf bank_mask:0xf
    v_add_f32_dpp v133, v111, v114 wave_ror:1 row_mask:0xf bank_mask:0xf
    v_mfma_f32_16x16x32_bf16 v[128:131], v[168:171], v[20:23], v[128:131]
    buffer_load_dwordx4 v[60:63], v11, s[60:63], s20 offen sc1
    v_add_f32_dpp v135, v132, v113 wave_ror:1 row_mask:0xf bank_mask:0xf
    v_add_f32_dpp v137, v134, v112 wave_ror:1 row_mask:0xf bank_mask:0xf
    s_waitcnt lgkmcnt(1)
    v_mfma_f32_16x16x32_bf16 v[124:127], v[172:175], v[16:19], v[124:127]
    s_add_u32 s20, s20, 4096
    v_add_f32_dpp v133, v115, v114 wave_shr:1 row_mask:0xf bank_mask:0xf
    s_nop 1
    v_add_f32_dpp v135, v133, v113 wave_shr:1 row_mask:0xf bank_mask:0xf
    s_waitcnt lgkmcnt(0)
    v_mfma_f32_16x16x32_bf16 v[128:131], v[176:179], v[16:19], v[128:131]
    v_add_f32_dpp v137, v135, v112 wave_shr:1 row_mask:0xf bank_mask:0xf
    v_cvt_pk_bf16_f32 v141, v136, v137
    v_add_f32_dpp v132, v115, v118 wave_ror:1 row_mask:0xf bank_mask:0xf
    v_add_f32_dpp v134, v133, v117 wave_ror:1 row_mask:0xf bank_mask:0xf
    v_add_f32_dpp v136, v135, v116 wave_ror:1 row_mask:0xf bank_mask:0xf
    v_add_f32_dpp v132, v119, v118 wave_shr:1 row_mask:0xf bank_mask:0xf
    s_nop 1
    v_add_f32_dpp v134, v132, v117 wave_shr:1 row_mask:0xf bank_mask:0xf
    s_nop 1
    v_add_f32_dpp v136, v134, v116 wave_shr:1 row_mask:0xf bank_mask:0xf
    v_add_f32_dpp v133, v119, v122 wave_ror:1 row_mask:0xf bank_mask:0xf
    v_add_f32_dpp v135, v132, v121 wave_ror:1 row_mask:0xf bank_mask:0xf
    v_add_f32_dpp v137, v134, v120 wave_ror:1 row_mask:0xf bank_mask:0xf
    v_add_f32_dpp v133, v123, v122 wave_shr:1 row_mask:0xf bank_mask:0xf
    s_nop 1
    v_add_f32_dpp v135, v133, v121 wave_shr:1 row_mask:0xf bank_mask:0xf
    s_nop 1
    v_add_f32_dpp v137, v135, v120 wave_shr:1 row_mask:0xf bank_mask:0xf
    v_cvt_pk_bf16_f32 v142, v136, v137
    v_add_f32_dpp v132, v123, v126 wave_ror:1 row_mask:0xf bank_mask:0xf
    v_add_f32_dpp v134, v133, v125 wave_ror:1 row_mask:0xf bank_mask:0xf
    v_add_f32_dpp v136, v135, v124 wave_ror:1 row_mask:0xf bank_mask:0xf
    v_add_f32_dpp v132, v127, v126 wave_shr:1 row_mask:0xf bank_mask:0xf
    s_nop 1
    v_add_f32_dpp v134, v132, v125 wave_shr:1 row_mask:0xf bank_mask:0xf
    s_nop 1
    v_add_f32_dpp v136, v134, v124 wave_shr:1 row_mask:0xf bank_mask:0xf
    v_add_f32_dpp v133, v127, v130 wave_ror:1 row_mask:0xf bank_mask:0xf
    v_add_f32_dpp v135, v132, v129 wave_ror:1 row_mask:0xf bank_mask:0xf
    v_add_f32_dpp v137, v134, v128 wave_ror:1 row_mask:0xf bank_mask:0xf
    v_add_f32_dpp v133, v131, v130 wave_shr:1 row_mask:0xf bank_mask:0xf
    s_nop 1
    v_add_f32_dpp v135, v133, v129 wave_shr:1 row_mask:0xf bank_mask:0xf
    s_nop 1
    v_add_f32_dpp v137, v135, v128 wave_shr:1 row_mask:0xf bank_mask:0xf
    v_cvt_pk_bf16_f32 v143, v136, v137
    s_add_u32 s6, s13, 1310720
    buffer_store_dwordx4 v[140:143], v5, s[60:63], s6 offen sc1
LconvE_12:
    s_waitcnt vmcnt(8)
    ds_read_b64 v[160:161], v13 offset:0
    ds_read_b64 v[170:171], v15 offset:4352
    ds_read_b64 v[162:163], v13 offset:32
    ds_read_b64 v[172:173], v15 offset:4384
    ds_read_b64 v[164:165], v13 offset:64
    ds_read_b64 v[174:175], v15 offset:4416
    ds_read_b64 v[166:167], v13 offset:96
    ds_read_b64 v[176:177], v15 offset:4448
    ds_read_b64 v[168:169], v13 offset:128
    ds_read_b64 v[178:179], v15 offset:4480
    buffer_load_dwordx4 v[16:19], v8, s[60:63], s20 offen sc1
    buffer_load_dwordx4 v[20:23], v9, s[60:63], s20 offen sc1
    buffer_load_dwordx4 v[24:27], v10, s[60:63], s20 offen sc1
    buffer_load_dwordx4 v[28:31], v11, s[60:63], s20 offen sc1
    s_add_u32 s20, s20, 4096
    buffer_load_dwordx4 v[124:127], v8, s[60:63], s20 offen sc1
    buffer_load_dwordx4 v[128:131], v9, s[60:63], s20 offen sc1
    buffer_load_dwordx4 v[132:135], v10, s[60:63], s20 offen sc1
    buffer_load_dwordx4 v[136:139], v11, s[60:63], s20 offen sc1
    s_add_u32 s20, s20, 4096
    v_mfma_f32_16x16x32_bf16 v[64:67], a[0:3], v[32:35], 0
    s_cmp_eq_u32 s68, 4
    s_cselect_b32 s20, s14, s20
    s_cselect_b32 s17, s15, s20
    v_mfma_f32_16x16x32_bf16 v[68:71], a[4:7], v[32:35], 0
    buffer_load_dwordx4 v[140:143], v8, s[60:63], s17 offen sc1
    s_waitcnt lgkmcnt(9)
    v_lshlrev_b32 v212, 16, v160
    v_and_b32 v213, 0xffff0000, v160
    s_waitcnt lgkmcnt(8)
    v_lshlrev_b32 v232, 16, v170
    v_mfma_f32_16x16x32_bf16 v[72:75], a[8:11], v[32:35], 0
    v_and_b32 v233, 0xffff0000, v170
    v_add_f32 v232, v232, v212
    v_mfma_f32_16x16x32_bf16 v[76:79], a[12:15], v[32:35], 0
    v_add_f32 v233, v233, v213
    v_lshlrev_b32 v214, 16, v161
    v_mfma_f32_16x16x32_bf16 v[80:83], a[16:19], v[32:35], 0
    v_and_b32 v215, 0xffff0000, v161
    v_lshlrev_b32 v234, 16, v171
    s_waitcnt vmcnt(16)
    v_mfma_f32_16x16x32_bf16 v[84:87], a[0:3], v[36:39], 0
    buffer_load_dwordx4 v[144:147], v9, s[60:63], s17 offen sc1
    v_and_b32 v235, 0xffff0000, v171
    v_add_f32 v234, v234, v214
    v_mfma_f32_16x16x32_bf16 v[88:91], a[4:7], v[36:39], 0
    v_add_f32 v235, v235, v215
    s_waitcnt lgkmcnt(7)
    v_lshlrev_b32 v216, 16, v162
    v_mfma_f32_16x16x32_bf16 v[92:95], a[8:11], v[36:39], 0
    v_and_b32 v217, 0xffff0000, v162
    s_waitcnt lgkmcnt(6)
    v_lshlrev_b32 v236, 16, v172
    v_mfma_f32_16x16x32_bf16 v[96:99], a[12:15], v[36:39], 0
    v_and_b32 v237, 0xffff0000, v172
    v_add_f32 v236, v236, v216
    v_add_f32 v237, v237, v217
    v_mfma_f32_16x16x32_bf16 v[100:103], a[16:19], v[36:39], 0
    buffer_load_dwordx4 v[148:151], v10, s[60:63], s17 offen sc1
    v_lshlrev_b32 v218, 16, v163
    v_and_b32 v219, 0xffff0000, v163
    s_waitcnt vmcnt(17)
    v_mfma_f32_16x16x32_bf16 v[104:107], a[0:3], v[40:43], 0
    v_lshlrev_b32 v238, 16, v173
    v_and_b32 v239, 0xffff0000, v173
    v_mfma_f32_16x16x32_bf16 v[108:111], a[4:7], v[40:43], 0
    v_add_f32 v238, v238, v218
    v_add_f32 v239, v239, v219
    v_mfma_f32_16x16x32_bf16 v[112:115], a[8:11], v[40:43], 0
    s_waitcnt lgkmcnt(5)
    v_lshlrev_b32 v220, 16, v164
    v_and_b32 v221, 0xffff0000, v164
    v_mfma_f32_16x16x32_bf16 v[116:119], a[12:15], v[40:43], 0
    buffer_load_dwordx4 v[152:155], v11, s[60:63], s17 offen sc1
    s_waitcnt lgkmcnt(4)
    v_lshlrev_b32 v240, 16, v174
    v_and_b32 v241, 0xffff0000, v174
    v_mfma_f32_16x16x32_bf16 v[120:123], a[16:19], v[40:43], 0
    s_add_u32 s20, s20, 4096
    v_add_f32 v240, v240, v220
    v_add_f32 v241, v241, v221
    s_waitcnt vmcnt(16)
    v_mfma_f32_16x16x32_bf16 v[64:67], a[20:23], v[48:51], v[64:67]
    v_lshlrev_b32 v222, 16, v165
    v_and_b32 v223, 0xffff0000, v165
    v_lshlrev_b32 v242, 16, v175
    v_mfma_f32_16x16x32_bf16 v[68:71], a[24:27], v[48:51], v[68:71]
    buffer_load_dwordx4 v[156:159], v8, s[60:63], s20 offen sc1
    v_and_b32 v243, 0xffff0000, v175
    v_add_f32 v242, v242, v222
    v_mfma_f32_16x16x32_bf16 v[72:75], a[28:31], v[48:51], v[72:75]
    v_add_f32 v243, v243, v223
    s_waitcnt lgkmcnt(3)
    v_lshlrev_b32 v224, 16, v166
    v_mfma_f32_16x16x32_bf16 v[76:79], a[32:35], v[48:51], v[76:79]
    v_and_b32 v225, 0xffff0000, v166
    s_waitcnt lgkmcnt(2)
    v_lshlrev_b32 v244, 16, v176
    v_mfma_f32_16x16x32_bf16 v[80:83], a[36:39], v[48:51], v[80:83]
    v_and_b32 v245, 0xffff0000, v176
    v_add_f32 v244, v244, v224
    s_waitcnt vmcnt(16)
    v_mfma_f32_16x16x32_bf16 v[84:87], a[20:23], v[52:55], v[84:87]
    buffer_load_dwordx4 v[160:163], v9, s[60:63], s20 offen sc1
    v_add_f32 v245, v245, v225
    v_lshlrev_b32 v226, 16, v167
    v_mfma_f32_16x16x32_bf16 v[88:91], a[24:27], v[52:55], v[88:91]
    v_and_b32 v227, 0xffff0000, v167
    v_lshlrev_b32 v246, 16, v177
    v_mfma_f32_16x16x32_bf16 v[92:95], a[28:31], v[52:55], v[92:95]
    v_and_b32 v247, 0xffff0000, v177
    v_add_f32 v246, v246, v226
    v_add_f32 v247, v247, v227
    v_mfma_f32_16x16x32_bf16 v[96:99], a[32:35], v[52:55], v[96:99]
    s_waitcnt lgkmcnt(1)
    v_lshlrev_b32 v228, 16, v168
    v_and_b32 v229, 0xffff0000, v168
    v_mfma_f32_16x16x32_bf16 v[100:103], a[36:39], v[52:55], v[100:103]
    buffer_load_dwordx4 v[164:167], v10, s[60:63], s20 offen sc1
    s_waitcnt lgkmcnt(0)
    v_lshlrev_b32 v248, 16, v178
    v_and_b32 v249, 0xffff0000, v178
    s_waitcnt vmcnt(17)
    v_mfma_f32_16x16x32_bf16 v[104:107], a[20:23], v[56:59], v[104:107]
    v_add_f32 v248, v248, v228
    v_add_f32 v249, v249, v229
    v_mfma_f32_16x16x32_bf16 v[108:111], a[24:27], v[56:59], v[108:111]
    v_lshlrev_b32 v230, 16, v169
    v_and_b32 v231, 0xffff0000, v169
    v_mfma_f32_16x16x32_bf16 v[112:115], a[28:31], v[56:59], v[112:115]
    v_lshlrev_b32 v250, 16, v179
    v_and_b32 v251, 0xffff0000, v179
    v_mfma_f32_16x16x32_bf16 v[116:119], a[32:35], v[56:59], v[116:119]
    buffer_load_dwordx4 v[168:171], v11, s[60:63], s20 offen sc1
    v_add_f32 v250, v250, v230
    v_add_f32 v251, v251, v231
    v_mfma_f32_16x16x32_bf16 v[120:123], a[36:39], v[56:59], v[120:123]
    s_add_u32 s20, s20, 4096
    v_mfma_f32_16x16x32_bf16 v[232:235], a[0:3], v[44:47], v[232:235]
    s_lshl1_add_u32 s79, s10, s11
    s_lshl2_add_u32 s78, s79, s5
    v_mfma_f32_16x16x32_bf16 v[236:239], a[4:7], v[44:47], v[236:239]
    s_lshl_b32 s78, s78, 7
    s_add_u32 s78, s78, 98304
    v_mfma_f32_16x16x32_bf16 v[240:243], a[8:11], v[44:47], v[240:243]
    v_and_b32 v14, 15, v1
    v_mfma_f32_16x16x32_bf16 v[244:247], a[12:15], v[44:47], v[244:247]
    v_lshlrev_b32 v14, 3, v14
    buffer_load_dwordx2 v[4:5], v14, s[60:63], s78 offen sc1
    v_mfma_f32_16x16x32_bf16 v[248:251], a[16:19], v[44:47], v[248:251]
    s_lshl3_add_u32 s79, s79, s12
    s_mul_i32 s79, s79, 10240
    s_waitcnt vmcnt(18)
    v_mfma_f32_16x16x32_bf16 v[232:235], a[20:23], v[60:63], v[232:235]
    s_add_u32 s13, s79, 4194304
    s_cmp_eq_u32 s12, 5
    s_cselect_b32 s79, 30, 14
    v_mfma_f32_16x16x32_bf16 v[236:239], a[24:27], v[60:63], v[236:239]
    s_cmp_lt_u32 s12, 5
    s_cselect_b32 s16, 40, s79
    v_mfma_f32_16x16x32_bf16 v[240:243], a[28:31], v[60:63], v[240:243]
    s_lshl_b32 s81, s12, 7
    s_add_u32 s81, s81, 7168
    v_mfma_f32_16x16x32_bf16 v[244:247], a[32:35], v[60:63], v[244:247]
    v_mfma_f32_16x16x32_bf16 v[248:251], a[36:39], v[60:63], v[248:251]
    s_waitcnt vmcnt(17)
    s_barrier
    s_cmp_lg_u32 s5, 0
    s_cbranch_scc1 Lsig_22
    v_mov_b32 v6, 1
    s_mov_b64 exec, 1
    buffer_atomic_add v6, v255, s[60:63], s34 offen sc1
    buffer_atomic_add v6, v255, s[60:63], s30 offen sc1
    s_mov_b64 exec, -1
Lsig_22:
    s_waitcnt vmcnt(16)
    v_mfma_f32_16x16x32_bf16 v[64:67], a[40:43], v[16:19], v[64:67]
    v_mfma_f32_16x16x32_bf16 v[68:71], a[44:47], v[16:19], v[68:71]
    buffer_load_dwordx4 v[32:35], v8, s[60:63], s20 offen sc1
    v_mfma_f32_16x16x32_bf16 v[72:75], a[48:51], v[16:19], v[72:75]
    v_mfma_f32_16x16x32_bf16 v[76:79], a[52:55], v[16:19], v[76:79]
    v_mfma_f32_16x16x32_bf16 v[80:83], a[56:59], v[16:19], v[80:83]
    s_waitcnt vmcnt(16)
    v_mfma_f32_16x16x32_bf16 v[84:87], a[40:43], v[20:23], v[84:87]
    buffer_load_dwordx4 v[36:39], v9, s[60:63], s20 offen sc1
    v_mfma_f32_16x16x32_bf16 v[88:91], a[44:47], v[20:23], v[88:91]
    v_mfma_f32_16x16x32_bf16 v[92:95], a[48:51], v[20:23], v[92:95]
    v_mfma_f32_16x16x32_bf16 v[96:99], a[52:55], v[20:23], v[96:99]
    v_mfma_f32_16x16x32_bf16 v[100:103], a[56:59], v[20:23], v[100:103]
    s_waitcnt vmcnt(16)
    v_mfma_f32_16x16x32_bf16 v[104:107], a[40:43], v[24:27], v[104:107]
    buffer_load_dwordx4 v[40:43], v10, s[60:63], s20 offen sc1
    v_mfma_f32_16x16x32_bf16 v[108:111], a[44:47], v[24:27], v[108:111]
    v_mfma_f32_16x16x32_bf16 v[112:115], a[48:51], v[24:27], v[112:115]
    v_mfma_f32_16x16x32_bf16 v[116:119], a[52:55], v[24:27], v[116:119]
    v_mfma_f32_16x16x32_bf16 v[120:123], a[56:59], v[24:27], v[120:123]
    s_waitcnt vmcnt(16)
    v_mfma_f32_16x16x32_bf16 v[232:235], a[40:43], v[28:31], v[232:235]
    buffer_load_dwordx4 v[44:47], v11, s[60:63], s20 offen sc1
    v_mfma_f32_16x16x32_bf16 v[236:239], a[44:47], v[28:31], v[236:239]
    v_mfma_f32_16x16x32_bf16 v[240:243], a[48:51], v[28:31], v[240:243]
    v_mfma_f32_16x16x32_bf16 v[244:247], a[52:55], v[28:31], v[244:247]
    v_mfma_f32_16x16x32_bf16 v[248:251], a[56:59], v[28:31], v[248:251]
    s_add_u32 s20, s20, 4096
    s_waitcnt vmcnt(16)
    v_mfma_f32_16x16x32_bf16 v[64:67], a[60:63], v[124:127], v[64:67]
    v_lshlrev_b32 v6, 4, v0
    v_mfma_f32_16x16x32_bf16 v[68:71], a[64:67], v[124:127], v[68:71]
    buffer_load_dwordx4 v[48:51], v8, s[60:63], s20 offen sc1
    s_cmp_ge_u32 s5, 2
    s_cselect_b32 s78, 1073741824, 8192
    v_mfma_f32_16x16x32_bf16 v[72:75], a[68:71], v[124:127], v[72:75]
    v_add_u32 v7, s78, v6
    v_mfma_f32_16x16x32_bf16 v[76:79], a[72:75], v[124:127], v[76:79]
    v_mfma_f32_16x16x32_bf16 v[80:83], a[76:79], v[124:127], v[80:83]
    v_lshrrev_b32 v2, 3, v0
    s_waitcnt vmcnt(16)
    v_mfma_f32_16x16x32_bf16 v[84:87], a[60:63], v[128:131], v[84:87]
    buffer_load_dwordx4 v[52:55], v9, s[60:63], s20 offen sc1
    v_mul_u32_u24 v2, 144, v2
    v_mfma_f32_16x16x32_bf16 v[88:91], a[64:67], v[128:131], v[88:91]
    v_mfma_f32_16x16x32_bf16 v[92:95], a[68:71], v[128:131], v[92:95]
    v_and_b32 v3, 7, v0
    v_mfma_f32_16x16x32_bf16 v[96:99], a[72:75], v[128:131], v[96:99]
    v_lshl_add_u32 v2, v3, 4, v2
    v_mfma_f32_16x16x32_bf16 v[100:103], a[76:79], v[128:131], v[100:103]
    s_waitcnt vmcnt(16)
    v_mfma_f32_16x16x32_bf16 v[104:107], a[60:63], v[132:135], v[104:107]
    buffer_load_dwordx4 v[56:59], v10, s[60:63], s20 offen sc1
    v_lshrrev_b32 v15, 2, v1
    v_mfma_f32_16x16x32_bf16 v[108:111], a[64:67], v[132:135], v[108:111]
    v_mul_u32_u24 v15, 144, v15
    v_mfma_f32_16x16x32_bf16 v[112:115], a[68:71], v[132:135], v[112:115]
    v_mfma_f32_16x16x32_bf16 v[116:119], a[72:75], v[132:135], v[116:119]
    v_and_b32 v3, 3, v1
    v_mfma_f32_16x16x32_bf16 v[120:123], a[76:79], v[132:135], v[120:123]
    v_lshl_add_u32 v15, v3, 3, v15
    s_waitcnt vmcnt(16)
    v_mfma_f32_16x16x32_bf16 v[232:235], a[60:63], v[136:139], v[232:235]
    buffer_load_dwordx4 v[60:63], v11, s[60:63], s20 offen sc1
    v_mfma_f32_16x16x32_bf16 v[236:239], a[64:67], v[136:139], v[236:239]
    s_lshl_b32 s78, s5, 5
    v_mfma_f32_16x16x32_bf16 v[240:243], a[68:71], v[136:139], v[240:243]
    v_add_u32 v15, s78, v15
    v_mfma_f32_16x16x32_bf16 v[244:247], a[72:75], v[136:139], v[244:247]
    v_mfma_f32_16x16x32_bf16 v[248:251], a[76:79], v[136:139], v[248:251]
    s_add_u32 s20, s20, 4096
    s_waitcnt vmcnt(16)
    v_mfma_f32_16x16x32_bf16 v[64:67], a[80:83], v[140:143], v[64:67]
    s_cmp_eq_u32 s68, 8
    s_cselect_b32 s20, s14, s20
    s_cselect_b32 s17, s15, s20
    v_mfma_f32_16x16x32_bf16 v[68:71], a[84:87], v[140:143], v[68:71]
    buffer_load_dwordx4 v[16:19], v8, s[60:63], s17 offen sc1
    v_mfma_f32_16x16x32_bf16 v[72:75], a[88:91], v[140:143], v[72:75]
    v_mfma_f32_16x16x32_bf16 v[76:79], a[92:95], v[140:143], v[76:79]
    v_mfma_f32_16x16x32_bf16 v[80:83], a[96:99], v[140:143], v[80:83]
    s_waitcnt vmcnt(16)
    v_mfma_f32_16x16x32_bf16 v[84:87], a[80:83], v[144:147], v[84:87]
    buffer_load_dwordx4 v[20:23], v9, s[60:63], s17 offen sc1
    v_mfma_f32_16x16x32_bf16 v[88:91], a[84:87], v[144:147], v[88:91]
    v_mfma_f32_16x16x32_bf16 v[92:95], a[88:91], v[144:147], v[92:95]
    v_mfma_f32_16x16x32_bf16 v[96:99], a[92:95], v[144:147], v[96:99]
    v_mfma_f32_16x16x32_bf16 v[100:103], a[96:99], v[144:147], v[100:103]
    s_waitcnt vmcnt(16)
    v_mfma_f32_16x16x32_bf16 v[104:107], a[80:83], v[148:151], v[104:107]
    buffer_load_dwordx4 v[24:27], v10, s[60:63], s17 offen sc1
    v_mfma_f32_16x16x32_bf16 v[108:111], a[84:87], v[148:151], v[108:111]
    v_mfma_f32_16x16x32_bf16 v[112:115], a[88:91], v[148:151], v[112:115]
    v_mfma_f32_16x16x32_bf16 v[116:119], a[92:95], v[148:151], v[116:119]
    v_mfma_f32_16x16x32_bf16 v[120:123], a[96:99], v[148:151], v[120:123]
    s_waitcnt vmcnt(16)
    v_mfma_f32_16x16x32_bf16 v[232:235], a[80:83], v[152:155], v[232:235]
    buffer_load_dwordx4 v[28:31], v11, s[60:63], s17 offen sc1
    v_mfma_f32_16x16x32_bf16 v[236:239], a[84:87], v[152:155], v[236:239]
    v_mfma_f32_16x16x32_bf16 v[240:243], a[88:91], v[152:155], v[240:243]
    v_mfma_f32_16x16x32_bf16 v[244:247], a[92:95], v[152:155], v[244:247]
    v_mfma_f32_16x16x32_bf16 v[248:251], a[96:99], v[152:155], v[248:251]
    s_add_u32 s20, s20, 4096
    s_waitcnt vmcnt(16)
    v_mfma_f32_16x16x32_bf16 v[64:67], a[100:103], v[156:159], v[64:67]
    s_waitcnt vmcnt(12)
    v_mul_f32 v4, v4, v5
    v_fma_f32 v212, v212, v5, -v4
    v_mfma_f32_16x16x32_bf16 v[68:71], a[104:107], v[156:159], v[68:71]
    buffer_load_dwordx4 v[124:127], v8, s[60:63], s20 offen sc1
    v_fma_f32 v213, v213, v5, -v4
    v_mfma_f32_16x16x32_bf16 v[72:75], a[108:111], v[156:159], v[72:75]
    v_fma_f32 v214, v214, v5, -v4
    v_mfma_f32_16x16x32_bf16 v[76:79], a[112:115], v[156:159], v[76:79]
    v_fma_f32 v215, v215, v5, -v4
    v_mfma_f32_16x16x32_bf16 v[80:83], a[116:119], v[156:159], v[80:83]
    v_fma_f32 v216, v216, v5, -v4
    v_mfma_f32_16x16x32_bf16 v[84:87], a[100:103], v[160:163], v[84:87]
    buffer_load_dwordx4 v[128:131], v9, s[60:63], s20 offen sc1
    v_fma_f32 v217, v217, v5, -v4
    v_mfma_f32_16x16x32_bf16 v[88:91], a[104:107], v[160:163], v[88:91]
    v_fma_f32 v218, v218, v5, -v4
    v_mfma_f32_16x16x32_bf16 v[92:95], a[108:111], v[160:163], v[92:95]
    v_fma_f32 v219, v219, v5, -v4
    v_mfma_f32_16x16x32_bf16 v[96:99], a[112:115], v[160:163], v[96:99]
    v_fma_f32 v220, v220, v5, -v4
    v_mfma_f32_16x16x32_bf16 v[100:103], a[116:119], v[160:163], v[100:103]
    v_fma_f32 v221, v221, v5, -v4
    v_fma_f32 v222, v222, v5, -v4
    v_mfma_f32_16x16x32_bf16 v[104:107], a[100:103], v[164:167], v[104:107]
    buffer_load_dwordx4 v[132:135], v10, s[60:63], s20 offen sc1
    v_fma_f32 v223, v223, v5, -v4
    v_mfma_f32_16x16x32_bf16 v[108:111], a[104:107], v[164:167], v[108:111]
    v_fma_f32 v224, v224, v5, -v4
    v_mfma_f32_16x16x32_bf16 v[112:115], a[108:111], v[164:167], v[112:115]
    v_fma_f32 v225, v225, v5, -v4
    v_mfma_f32_16x16x32_bf16 v[116:119], a[112:115], v[164:167], v[116:119]
    v_fma_f32 v226, v226, v5, -v4
    v_mfma_f32_16x16x32_bf16 v[120:123], a[116:119], v[164:167], v[120:123]
    v_fma_f32 v227, v227, v5, -v4
    v_mfma_f32_16x16x32_bf16 v[232:235], a[100:103], v[168:171], v[232:235]
    buffer_load_dwordx4 v[136:139], v11, s[60:63], s20 offen sc1
    v_fma_f32 v228, v228, v5, -v4
    v_mfma_f32_16x16x32_bf16 v[236:239], a[104:107], v[168:171], v[236:239]
    v_fma_f32 v229, v229, v5, -v4
    v_mfma_f32_16x16x32_bf16 v[240:243], a[108:111], v[168:171], v[240:243]
    v_fma_f32 v230, v230, v5, -v4
    v_mfma_f32_16x16x32_bf16 v[244:247], a[112:115], v[168:171], v[244:247]
    v_fma_f32 v231, v231, v5, -v4
    v_mfma_f32_16x16x32_bf16 v[248:251], a[116:119], v[168:171], v[248:251]
    s_add_u32 s20, s20, 4096
    s_waitcnt vmcnt(15)
    v_mfma_f32_16x16x32_bf16 v[64:67], a[120:123], v[32:35], v[64:67]
    s_add_u32 s78, s5, 1
    v_mfma_f32_16x16x32_bf16 v[68:71], a[124:127], v[32:35], v[68:71]
    buffer_load_dwordx4 v[140:143], v8, s[60:63], s20 offen sc1
    s_and_b32 s78, s78, 3
    v_mfma_f32_16x16x32_bf16 v[72:75], a[128:131], v[32:35], v[72:75]
    s_mul_i32 s78, s78, 15360
    v_mfma_f32_16x16x32_bf16 v[76:79], a[132:135], v[32:35], v[76:79]
    s_add_u32 s78, s78, 16384
    v_mfma_f32_16x16x32_bf16 v[80:83], a[136:139], v[32:35], v[80:83]
    v_add_u32 v3, s78, v252
    s_waitcnt vmcnt(15)
    v_mfma_f32_16x16x32_bf16 v[84:87], a[120:123], v[36:39], v[84:87]
    buffer_load_dwordx4 v[144:147], v9, s[60:63], s20 offen sc1
    s_add_u32 s78, s5, 2
    v_mfma_f32_16x16x32_bf16 v[88:91], a[124:127], v[36:39], v[88:91]
    s_and_b32 s78, s78, 3
    v_mfma_f32_16x16x32_bf16 v[92:95], a[128:131], v[36:39], v[92:95]
    s_mul_i32 s78, s78, 15360
    v_mfma_f32_16x16x32_bf16 v[96:99], a[132:135], v[36:39], v[96:99]
    s_add_u32 s78, s78, 21504
    v_mfma_f32_16x16x32_bf16 v[100:103], a[136:139], v[36:39], v[100:103]
    v_add_u32 v4, s78, v252
    s_waitcnt vmcnt(15)
    v_mfma_f32_16x16x32_bf16 v[104:107], a[120:123], v[40:43], v[104:107]
    buffer_load_dwordx4 v[148:151], v10, s[60:63], s20 offen sc1
    s_add_u32 s78, s5, 3
    v_mfma_f32_16x16x32_bf16 v[108:111], a[124:127], v[40:43], v[108:111]
    s_and_b32 s78, s78, 3
    v_mfma_f32_16x16x32_bf16 v[112:115], a[128:131], v[40:43], v[112:115]
    s_mul_i32 s78, s78, 15360
    v_mfma_f32_16x16x32_bf16 v[116:119], a[132:135], v[40:43], v[116:119]
    s_add_u32 s78, s78, 26624
    v_mfma_f32_16x16x32_bf16 v[120:123], a[136:139], v[40:43], v[120:123]
    v_add_u32 v5, s78, v252
    s_waitcnt vmcnt(15)
    v_mfma_f32_16x16x32_bf16 v[232:235], a[120:123], v[44:47], v[232:235]
    buffer_load_dwordx4 v[152:155], v11, s[60:63], s20 offen sc1
    s_mul_i32 s78, s5, 15360
    v_mfma_f32_16x16x32_bf16 v[236:239], a[124:127], v[44:47], v[236:239]
    s_add_u32 s78, s78, 16384
    v_mfma_f32_16x16x32_bf16 v[240:243], a[128:131], v[44:47], v[240:243]
    v_add_u32 v14, s78, v252
    v_mfma_f32_16x16x32_bf16 v[244:247], a[132:135], v[44:47], v[244:247]
    s_cmp_lg_u32 s5, 0
    s_cbranch_scc1 Lz_23
    v_mov_b32 v253, 0
    s_mov_b64 exec, 1
    buffer_atomic_add v253, v255, s[60:63], s81 offen sc0 sc1
    s_mov_b64 exec, -1
Lz_23:
    s_nop 0
    v_mfma_f32_16x16x32_bf16 v[248:251], a[136:139], v[44:47], v[248:251]
    s_add_u32 s20, s20, 4096
    s_waitcnt vmcnt(15)
    v_mfma_f32_16x16x32_bf16 v[64:67], a[140:143], v[48:51], v[64:67]
    v_mfma_f32_16x16x32_bf16 v[68:71], a[144:147], v[48:51], v[68:71]
    buffer_load_dwordx4 v[156:159], v8, s[60:63], s20 offen sc1
    v_mfma_f32_16x16x32_bf16 v[72:75], a[148:151], v[48:51], v[72:75]
    v_mfma_f32_16x16x32_bf16 v[76:79], a[152:155], v[48:51], v[76:79]
    v_mfma_f32_16x16x32_bf16 v[80:83], a[156:159], v[48:51], v[80:83]
    s_waitcnt vmcnt(15)
    v_mfma_f32_16x16x32_bf16 v[84:87], a[140:143], v[52:55], v[84:87]
    buffer_load_dwordx4 v[160:163], v9, s[60:63], s20 offen sc1
    v_mfma_f32_16x16x32_bf16 v[88:91], a[144:147], v[52:55], v[88:91]
    v_mfma_f32_16x16x32_bf16 v[92:95], a[148:151], v[52:55], v[92:95]
    v_mfma_f32_16x16x32_bf16 v[96:99], a[152:155], v[52:55], v[96:99]
    v_mfma_f32_16x16x32_bf16 v[100:103], a[156:159], v[52:55], v[100:103]
    s_waitcnt vmcnt(15)
    v_mfma_f32_16x16x32_bf16 v[104:107], a[140:143], v[56:59], v[104:107]
    buffer_load_dwordx4 v[164:167], v10, s[60:63], s20 offen sc1
    v_mfma_f32_16x16x32_bf16 v[108:111], a[144:147], v[56:59], v[108:111]
    v_mfma_f32_16x16x32_bf16 v[112:115], a[148:151], v[56:59], v[112:115]
    v_mfma_f32_16x16x32_bf16 v[116:119], a[152:155], v[56:59], v[116:119]
    v_mfma_f32_16x16x32_bf16 v[120:123], a[156:159], v[56:59], v[120:123]
    s_waitcnt vmcnt(15)
    v_mfma_f32_16x16x32_bf16 v[232:235], a[140:143], v[60:63], v[232:235]
    buffer_load_dwordx4 v[168:171], v11, s[60:63], s20 offen sc1
    v_mfma_f32_16x16x32_bf16 v[236:239], a[144:147], v[60:63], v[236:239]
    v_mfma_f32_16x16x32_bf16 v[240:243], a[148:151], v[60:63], v[240:243]
    v_mfma_f32_16x16x32_bf16 v[244:247], a[152:155], v[60:63], v[244:247]
    v_mfma_f32_16x16x32_bf16 v[248:251], a[156:159], v[60:63], v[248:251]
    s_add_u32 s20, s20, 4096
    s_waitcnt vmcnt(15)
    v_mfma_f32_16x16x32_bf16 v[64:67], a[160:163], v[16:19], v[64:67]
    s_cmp_eq_u32 s68, 12
    s_cselect_b32 s20, s14, s20
    s_cselect_b32 s17, s15, s20
    v_mfma_f32_16x16x32_bf16 v[68:71], a[164:167], v[16:19], v[68:71]
    buffer_load_dwordx4 v[32:35], v8, s[60:63], s17 offen sc1
    v_mfma_f32_16x16x32_bf16 v[72:75], a[168:171], v[16:19], v[72:75]
    v_mfma_f32_16x16x32_bf16 v[76:79], a[172:175], v[16:19], v[76:79]
    v_mfma_f32_16x16x32_bf16 v[80:83], a[176:179], v[16:19], v[80:83]
    s_waitcnt vmcnt(15)
    v_mfma_f32_16x16x32_bf16 v[84:87], a[160:163], v[20:23], v[84:87]
    buffer_load_dwordx4 v[36:39], v9, s[60:63], s17 offen sc1
    v_mfma_f32_16x16x32_bf16 v[88:91], a[164:167], v[20:23], v[88:91]
    v_mfma_f32_16x16x32_bf16 v[92:95], a[168:171], v[20:23], v[92:95]
    v_mfma_f32_16x16x32_bf16 v[96:99], a[172:175], v[20:23], v[96:99]
    v_mfma_f32_16x16x32_bf16 v[100:103], a[176:179], v[20:23], v[100:103]
    s_waitcnt vmcnt(15)
    v_mfma_f32_16x16x32_bf16 v[104:107], a[160:163], v[24:27], v[104:107]
    buffer_load_dwordx4 v[40:43], v10, s[60:63], s17 offen sc1
    v_mfma_f32_16x16x32_bf16 v[108:111], a[164:167], v[24:27], v[108:111]
    v_mfma_f32_16x16x32_bf16 v[112:115], a[168:171], v[24:27], v[112:115]
    v_mfma_f32_16x16x32_bf16 v[116:119], a[172:175], v[24:27], v[116:119]
    v_mfma_f32_16x16x32_bf16 v[120:123], a[176:179], v[24:27], v[120:123]
    s_waitcnt vmcnt(15)
    v_mfma_f32_16x16x32_bf16 v[232:235], a[160:163], v[28:31], v[232:235]
    buffer_load_dwordx4 v[44:47], v11, s[60:63], s17 offen sc1
    v_mfma_f32_16x16x32_bf16 v[236:239], a[164:167], v[28:31], v[236:239]
    v_mfma_f32_16x16x32_bf16 v[240:243], a[168:171], v[28:31], v[240:243]
    v_mfma_f32_16x16x32_bf16 v[244:247], a[172:175], v[28:31], v[244:247]
    v_mfma_f32_16x16x32_bf16 v[248:251], a[176:179], v[28:31], v[248:251]
    s_add_u32 s20, s20, 4096
    s_cmp_lg_u32 s5, 0
    s_cbranch_scc1 Lok_24
    s_mov_b32 s82, 0
    s_waitcnt vmcnt(8)
Lspin_25:
    v_cmp_gt_u32 vcc, s16, v253
    s_add_u32 s82, s82, 1
    s_cmp_ge_u32 s82, 200000
    s_cbranch_scc1 Lok_24
    s_and_b32 s83, vcc_lo, 1
    s_cbranch_scc0 Lok_24
    s_sleep 8
    v_mov_b32 v253, 0
    s_mov_b64 exec, 1
    buffer_atomic_add v253, v255, s[60:63], s81 offen sc0 sc1
    s_mov_b64 exec, -1
    s_waitcnt vmcnt(0)
    s_branch Lspin_25
Lok_24:
    s_barrier
    s_waitcnt vmcnt(15)
    v_mfma_f32_16x16x32_bf16 v[64:67], a[180:183], v[124:127], v[64:67]
    s_add_u32 s79, s13, 4096
    v_mfma_f32_16x16x32_bf16 v[68:71], a[184:187], v[124:127], v[68:71]
    buffer_load_dwordx4 v[172:175], v6, s[60:63], s13 offen sc1
    v_mfma_f32_16x16x32_bf16 v[72:75], a[188:191], v[124:127], v[72:75]
    v_mfma_f32_16x16x32_bf16 v[76:79], a[192:195], v[124:127], v[76:79]
    buffer_load_dwordx4 v[176:179], v6, s[60:63], s79 offen sc1
    v_mfma_f32_16x16x32_bf16 v[80:83], a[196:199], v[124:127], v[80:83]
    s_waitcnt vmcnt(16)
    v_mfma_f32_16x16x32_bf16 v[84:87], a[180:183], v[128:131], v[84:87]
    v_mfma_f32_16x16x32_bf16 v[88:91], a[184:187], v[128:131], v[88:91]
    buffer_load_dwordx4 v[180:183], v7, s[60:63], s13 offen sc1
    v_mfma_f32_16x16x32_bf16 v[92:95], a[188:191], v[128:131], v[92:95]
    v_mfma_f32_16x16x32_bf16 v[96:99], a[192:195], v[128:131], v[96:99]
    v_mfma_f32_16x16x32_bf16 v[100:103], a[196:199], v[128:131], v[100:103]
    buffer_load_dwordx4 v[48:51], v8, s[60:63], s20 offen sc1
    s_waitcnt vmcnt(17)
    v_mfma_f32_16x16x32_bf16 v[104:107], a[180:183], v[132:135], v[104:107]
    v_mfma_f32_16x16x32_bf16 v[108:111], a[184:187], v[132:135], v[108:111]
    buffer_load_dwordx4 v[52:55], v9, s[60:63], s20 offen sc1
    v_mfma_f32_16x16x32_bf16 v[112:115], a[188:191], v[132:135], v[112:115]
    v_mfma_f32_16x16x32_bf16 v[116:119], a[192:195], v[132:135], v[116:119]
    v_mfma_f32_16x16x32_bf16 v[120:123], a[196:199], v[132:135], v[120:123]
    buffer_load_dwordx4 v[56:59], v10, s[60:63], s20 offen sc1
    s_waitcnt vmcnt(18)
    v_mfma_f32_16x16x32_bf16 v[232:235], a[180:183], v[136:139], v[232:235]
    v_mfma_f32_16x16x32_bf16 v[236:239], a[184:187], v[136:139], v[236:239]
    v_mfma_f32_16x16x32_bf16 v[240:243], a[188:191], v[136:139], v[240:243]
    buffer_load_dwordx4 v[60:63], v11, s[60:63], s20 offen sc1
    v_mfma_f32_16x16x32_bf16 v[244:247], a[192:195], v[136:139], v[244:247]
    v_mfma_f32_16x16x32_bf16 v[248:251], a[196:199], v[136:139], v[248:251]
    s_waitcnt vmcnt(18)
    v_mfma_f32_16x16x32_bf16 v[64:67], a[200:203], v[140:143], v[64:67]
    v_mfma_f32_16x16x32_bf16 v[68:71], a[204:207], v[140:143], v[68:71]
    v_mfma_f32_16x16x32_bf16 v[72:75], a[208:211], v[140:143], v[72:75]
    v_mfma_f32_16x16x32_bf16 v[76:79], a[212:215], v[140:143], v[76:79]
    v_mfma_f32_16x16x32_bf16 v[80:83], a[216:219], v[140:143], v[80:83]
    s_waitcnt vmcnt(17)
    v_mfma_f32_16x16x32_bf16 v[84:87], a[200:203], v[144:147], v[84:87]
    v_mfma_f32_16x16x32_bf16 v[88:91], a[204:207], v[144:147], v[88:91]
    v_mfma_f32_16x16x32_bf16 v[92:95], a[208:211], v[144:147], v[92:95]
    v_mfma_f32_16x16x32_bf16 v[96:99], a[212:215], v[144:147], v[96:99]
    v_mfma_f32_16x16x32_bf16 v[100:103], a[216:219], v[144:147], v[100:103]
    s_waitcnt vmcnt(16)
    v_mfma_f32_16x16x32_bf16 v[104:107], a[200:203], v[148:151], v[104:107]
    v_mfma_f32_16x16x32_bf16 v[108:111], a[204:207], v[148:151], v[108:111]
    v_mfma_f32_16x16x32_bf16 v[112:115], a[208:211], v[148:151], v[112:115]
    v_mfma_f32_16x16x32_bf16 v[116:119], a[212:215], v[148:151], v[116:119]
    v_mfma_f32_16x16x32_bf16 v[120:123], a[216:219], v[148:151], v[120:123]
    s_waitcnt vmcnt(15)
    v_mfma_f32_16x16x32_bf16 v[232:235], a[200:203], v[152:155], v[232:235]
    v_mfma_f32_16x16x32_bf16 v[236:239], a[204:207], v[152:155], v[236:239]
    v_mfma_f32_16x16x32_bf16 v[240:243], a[208:211], v[152:155], v[240:243]
    v_mfma_f32_16x16x32_bf16 v[244:247], a[212:215], v[152:155], v[244:247]
    v_mfma_f32_16x16x32_bf16 v[248:251], a[216:219], v[152:155], v[248:251]
    s_waitcnt vmcnt(6)
    ds_write_b128 v2, v[172:175] offset:0
    s_waitcnt vmcnt(5)
    ds_write_b128 v2, v[176:179] offset:4608
    s_waitcnt vmcnt(4)
    ds_write_b128 v2, v[180:183] offset:9216
    v_mfma_f32_16x16x32_bf16 v[64:67], a[220:223], v[156:159], v[64:67]
    v_mfma_f32_16x16x32_bf16 v[64:67], a[240:243], v[32:35], v[64:67]
    s_waitcnt vmcnt(3)
    v_mfma_f32_16x16x32_bf16 v[64:67], v[192:195], v[48:51], v[64:67]
    v_mfma_f32_16x16x32_bf16 v[68:71], a[224:227], v[156:159], v[68:71]
    v_mfma_f32_16x16x32_bf16 v[68:71], a[244:247], v[32:35], v[68:71]
    v_mfma_f32_16x16x32_bf16 v[68:71], v[196:199], v[48:51], v[68:71]
    s_waitcnt lgkmcnt(0)
    s_barrier
    v_mfma_f32_16x16x32_bf16 v[72:75], a[228:231], v[156:159], v[72:75]
    ds_read_b64_tr_b16 v[172:173], v15 offset:0
    v_mfma_f32_16x16x32_bf16 v[72:75], a[248:251], v[32:35], v[72:75]
    ds_read_b64_tr_b16 v[174:175], v15 offset:2304
    v_mfma_f32_16x16x32_bf16 v[72:75], v[200:203], v[48:51], v[72:75]
    ds_read_b64_tr_b16 v[176:177], v15 offset:4608
    v_mfma_f32_16x16x32_bf16 v[76:79], a[232:235], v[156:159], v[76:79]
    ds_read_b64_tr_b16 v[178:179], v15 offset:6912
    v_mfma_f32_16x16x32_bf16 v[76:79], a[252:255], v[32:35], v[76:79]
    ds_read_b64_tr_b16 v[180:181], v15 offset:9216
    v_mfma_f32_16x16x32_bf16 v[76:79], v[204:207], v[48:51], v[76:79]
    v_mfma_f32_16x16x32_bf16 v[80:83], a[236:239], v[156:159], v[80:83]
    v_mfma_f32_16x16x32_bf16 v[80:83], v[188:191], v[32:35], v[80:83]
    v_mfma_f32_16x16x32_bf16 v[80:83], v[208:211], v[48:51], v[80:83]
    v_mfma_f32_16x16x32_bf16 v[84:87], a[220:223], v[160:163], v[84:87]
    s_waitcnt lgkmcnt(4)
    v_lshlrev_b32 v6, 16, v172
    v_and_b32 v7, 0xffff0000, v172
    v_mfma_f32_16x16x32_bf16 v[84:87], a[240:243], v[36:39], v[84:87]
    v_mul_f32 v212, v212, v6
    s_waitcnt vmcnt(2)
    v_mfma_f32_16x16x32_bf16 v[84:87], v[192:195], v[52:55], v[84:87]
    ds_write_b128 v3, v[64:67] offset:0
    v_mul_f32 v213, v213, v7
    v_mfma_f32_16x16x32_bf16 v[88:91], a[224:227], v[160:163], v[88:91]
    v_lshlrev_b32 v6, 16, v173
    v_and_b32 v7, 0xffff0000, v173
    v_mfma_f32_16x16x32_bf16 v[88:91], a[244:247], v[36:39], v[88:91]
    v_mul_f32 v214, v214, v6
    v_mfma_f32_16x16x32_bf16 v[88:91], v[196:199], v[52:55], v[88:91]
    ds_write_b128 v3, v[68:71] offset:1024
    v_mul_f32 v215, v215, v7
    v_mfma_f32_16x16x32_bf16 v[92:95], a[228:231], v[160:163], v[92:95]
    s_waitcnt lgkmcnt(5)
    v_lshlrev_b32 v6, 16, v174
    v_and_b32 v7, 0xffff0000, v174
    v_mfma_f32_16x16x32_bf16 v[92:95], a[248:251], v[36:39], v[92:95]
    v_mul_f32 v216, v216, v6
    v_mfma_f32_16x16x32_bf16 v[92:95], v[200:203], v[52:55], v[92:95]
    ds_write_b128 v3, v[72:75] offset:2048
    v_mul_f32 v217, v217, v7
    v_mfma_f32_16x16x32_bf16 v[96:99], a[232:235], v[160:163], v[96:99]
    v_lshlrev_b32 v6, 16, v175
    v_and_b32 v7, 0xffff0000, v175
    v_mfma_f32_16x16x32_bf16 v[96:99], a[252:255], v[36:39], v[96:99]
    v_mul_f32 v218, v218, v6
    v_mfma_f32_16x16x32_bf16 v[96:99], v[204:207], v[52:55], v[96:99]
    ds_write_b128 v3, v[76:79] offset:3072
    v_mul_f32 v219, v219, v7
    v_mfma_f32_16x16x32_bf16 v[100:103], a[236:239], v[160:163], v[100:103]
    s_waitcnt lgkmcnt(6)
    v_lshlrev_b32 v6, 16, v176
    v_and_b32 v7, 0xffff0000, v176
    v_mfma_f32_16x16x32_bf16 v[100:103], v[188:191], v[36:39], v[100:103]
    v_mul_f32 v220, v220, v6
    v_mfma_f32_16x16x32_bf16 v[100:103], v[208:211], v[52:55], v[100:103]
    ds_write_b128 v3, v[80:83] offset:4096
    v_mul_f32 v221, v221, v7
    v_mfma_f32_16x16x32_bf16 v[104:107], a[220:223], v[164:167], v[104:107]
    v_lshlrev_b32 v6, 16, v177
    v_and_b32 v7, 0xffff0000, v177
    v_mfma_f32_16x16x32_bf16 v[104:107], a[240:243], v[40:43], v[104:107]
    v_mul_f32 v222, v222, v6
    s_waitcnt vmcnt(1)
    v_mfma_f32_16x16x32_bf16 v[104:107], v[192:195], v[56:59], v[104:107]
    ds_write_b128 v4, v[84:87] offset:0
    v_mul_f32 v223, v223, v7
    v_mfma_f32_16x16x32_bf16 v[108:111], a[224:227], v[164:167], v[108:111]
    s_waitcnt lgkmcnt(7)
    v_lshlrev_b32 v6, 16, v178
    v_and_b32 v7, 0xffff0000, v178
    v_mfma_f32_16x16x32_bf16 v[108:111], a[244:247], v[40:43], v[108:111]
    v_mul_f32 v224, v224, v6
    v_mfma_f32_16x16x32_bf16 v[108:111], v[196:199], v[56:59], v[108:111]
    ds_write_b128 v4, v[88:91] offset:1024
    v_mul_f32 v225, v225, v7
    v_mfma_f32_16x16x32_bf16 v[112:115], a[228:231], v[164:167], v[112:115]
    v_lshlrev_b32 v6, 16, v179
    v_and_b32 v7, 0xffff0000, v179
    v_mfma_f32_16x16x32_bf16 v[112:115], a[248:251], v[40:43], v[112:115]
    v_mul_f32 v226, v226, v6
    v_mfma_f32_16x16x32_bf16 v[112:115], v[200:203], v[56:59], v[112:115]
    ds_write_b128 v4, v[92:95] offset:2048
    v_mul_f32 v227, v227, v7
    v_mfma_f32_16x16x32_bf16 v[116:119], a[232:235], v[164:167], v[116:119]
    s_waitcnt lgkmcnt(8)
    v_lshlrev_b32 v6, 16, v180
    v_and_b32 v7, 0xffff0000, v180
    v_mfma_f32_16x16x32_bf16 v[116:119], a[252:255], v[40:43], v[116:119]
    v_mul_f32 v228, v228, v6
    v_mfma_f32_16x16x32_bf16 v[116:119], v[204:207], v[56:59], v[116:119]
    ds_write_b128 v4, v[96:99] offset:3072
    v_mul_f32 v229, v229, v7
    v_mfma_f32_16x16x32_bf16 v[120:123], a[236:239], v[164:167], v[120:123]
    v_lshlrev_b32 v6, 16, v181
    v_and_b32 v7, 0xffff0000, v181
    v_mfma_f32_16x16x32_bf16 v[120:123], v[188:191], v[40:43], v[120:123]
    v_mul_f32 v230, v230, v6
    v_mfma_f32_16x16x32_bf16 v[120:123], v[208:211], v[56:59], v[120:123]
    ds_write_b128 v4, v[100:103] offset:4096
    v_mul_f32 v231, v231, v7
    v_mfma_f32_16x16x32_bf16 v[232:235], a[220:223], v[168:171], v[232:235]
    v_mfma_f32_16x16x32_bf16 v[232:235], a[240:243], v[44:47], v[232:235]
    ds_write_b128 v5, v[104:107] offset:0
    s_waitcnt vmcnt(0)
    v_mfma_f32_16x16x32_bf16 v[232:235], v[192:195], v[60:63], v[232:235]
    ds_write_b128 v5, v[108:111] offset:1024
    v_mfma_f32_16x16x32_bf16 v[236:239], a[224:227], v[168:171], v[236:239]
    ds_write_b128 v5, v[112:115] offset:2048
    v_mfma_f32_16x16x32_bf16 v[236:239], a[244:247], v[44:47], v[236:239]
    ds_write_b128 v5, v[116:119] offset:3072
    v_mfma_f32_16x16x32_bf16 v[236:239], v[196:199], v[60:63], v[236:239]
    ds_write_b128 v5, v[120:123] offset:4096
    v_mfma_f32_16x16x32_bf16 v[240:243], a[228:231], v[168:171], v[240:243]
    v_mfma_f32_16x16x32_bf16 v[240:243], a[248:251], v[44:47], v[240:243]
    v_add_u32 v6, s21, v252
    s_waitcnt lgkmcnt(0)
    s_barrier
    v_mfma_f32_16x16x32_bf16 v[240:243], v[200:203], v[60:63], v[240:243]
    ds_read_b128 v[64:67], v14 offset:0
    ds_read_b128 v[68:71], v14 offset:5120
    ds_read_b128 v[72:75], v14 offset:10240
    v_mfma_f32_16x16x32_bf16 v[244:247], a[232:235], v[168:171], v[244:247]
    ds_read_b128 v[76:79], v14 offset:1024
    ds_read_b128 v[80:83], v14 offset:6144
    v_mfma_f32_16x16x32_bf16 v[244:247], a[252:255], v[44:47], v[244:247]
    ds_read_b128 v[84:87], v14 offset:11264
    ds_read_b128 v[88:91], v14 offset:2048
    v_mfma_f32_16x16x32_bf16 v[244:247], v[204:207], v[60:63], v[244:247]
    ds_read_b128 v[92:95], v14 offset:7168
    ds_read_b128 v[96:99], v14 offset:12288
    v_mfma_f32_16x16x32_bf16 v[248:251], a[236:239], v[168:171], v[248:251]
    ds_read_b128 v[100:103], v14 offset:3072
    ds_read_b128 v[104:107], v14 offset:8192
    ds_read_b128 v[108:111], v14 offset:13312
    v_mfma_f32_16x16x32_bf16 v[248:251], v[188:191], v[44:47], v[248:251]
    ds_read_b128 v[112:115], v14 offset:4096
    ds_read_b128 v[116:119], v14 offset:9216
    v_mfma_f32_16x16x32_bf16 v[248:251], v[208:211], v[60:63], v[248:251]
    ds_read_b128 v[120:123], v14 offset:14336
    s_waitcnt lgkmcnt(14)
    v_pk_add_f32 v[212:213], v[212:213], v[64:65]
    v_pk_add_f32 v[214:215], v[214:215], v[66:67]
    s_waitcnt lgkmcnt(11)
    v_pk_add_f32 v[216:217], v[216:217], v[76:77]
    v_pk_add_f32 v[218:219], v[218:219], v[78:79]
    s_waitcnt lgkmcnt(8)
    v_pk_add_f32 v[220:221], v[220:221], v[88:89]
    v_pk_add_f32 v[222:223], v[222:223], v[90:91]
    s_waitcnt lgkmcnt(5)
    v_pk_add_f32 v[224:225], v[224:225], v[100:101]
    v_pk_add_f32 v[226:227], v[226:227], v[102:103]
    s_waitcnt lgkmcnt(2)
    v_pk_add_f32 v[228:229], v[228:229], v[112:113]
    v_pk_add_f32 v[230:231], v[230:231], v[114:115]
    v_pk_add_f32 v[68:69], v[68:69], v[72:73]
    v_pk_add_f32 v[212:213], v[212:213], v[232:233]
    v_pk_add_f32 v[70:71], v[70:71], v[74:75]
    v_pk_add_f32 v[214:215], v[214:215], v[234:235]
    v_pk_add_f32 v[80:81], v[80:81], v[84:85]
    v_pk_add_f32 v[216:217], v[216:217], v[236:237]
    v_pk_add_f32 v[82:83], v[82:83], v[86:87]
    v_pk_add_f32 v[218:219], v[218:219], v[238:239]
    v_pk_add_f32 v[92:93], v[92:93], v[96:97]
    v_pk_add_f32 v[220:221], v[220:221], v[240:241]
    v_pk_add_f32 v[94:95], v[94:95], v[98:99]
    v_pk_add_f32 v[222:223], v[222:223], v[242:243]
    v_pk_add_f32 v[104:105], v[104:105], v[108:109]
    v_pk_add_f32 v[224:225], v[224:225], v[244:245]
    v_pk_add_f32 v[106:107], v[106:107], v[110:111]
    v_pk_add_f32 v[226:227], v[226:227], v[246:247]
    s_waitcnt lgkmcnt(0)
    v_pk_add_f32 v[116:117], v[116:117], v[120:121]
    v_pk_add_f32 v[228:229], v[228:229], v[248:249]
    v_pk_add_f32 v[118:119], v[118:119], v[122:123]
    v_pk_add_f32 v[230:231], v[230:231], v[250:251]
    v_pk_add_f32 v[212:213], v[212:213], v[68:69]
    v_pk_add_f32 v[214:215], v[214:215], v[70:71]
    v_cvt_pk_bf16_f32 v16, v212, v213
    v_cvt_pk_bf16_f32 v17, v214, v215
    ds_write_b64 v13, v[16:17] offset:0
    v_pk_add_f32 v[216:217], v[216:217], v[80:81]
    v_pk_add_f32 v[218:219], v[218:219], v[82:83]
    v_cvt_pk_bf16_f32 v18, v216, v217
    v_cvt_pk_bf16_f32 v19, v218, v219
    ds_write_b64 v13, v[18:19] offset:32
    v_pk_add_f32 v[220:221], v[220:221], v[92:93]
    v_pk_add_f32 v[222:223], v[222:223], v[94:95]
    v_cvt_pk_bf16_f32 v20, v220, v221
    v_cvt_pk_bf16_f32 v21, v222, v223
    ds_write_b64 v13, v[20:21] offset:64
    v_pk_add_f32 v[224:225], v[224:225], v[104:105]
    v_pk_add_f32 v[226:227], v[226:227], v[106:107]
    v_cvt_pk_bf16_f32 v22, v224, v225
    v_cvt_pk_bf16_f32 v23, v226, v227
    ds_write_b64 v13, v[22:23] offset:96
    v_pk_add_f32 v[228:229], v[228:229], v[116:117]
    v_pk_add_f32 v[230:231], v[230:231], v[118:119]
    v_cvt_pk_bf16_f32 v24, v228, v229
    v_cvt_pk_bf16_f32 v25, v230, v231
    ds_write_b64 v13, v[24:25] offset:128
    ds_read_b128 v[128:131], v6 offset:0
    ds_read_b128 v[132:135], v6 offset:1088
    ds_read_b128 v[136:139], v6 offset:2176
    ds_read_b128 v[140:143], v6 offset:3264
    s_add_u32 s79, s7, 0
    s_waitcnt lgkmcnt(3)
    buffer_store_dwordx4 v[128:131], v12, s[64:67], s79 offen
    s_add_u32 s79, s7, 327680
    s_waitcnt lgkmcnt(2)
    buffer_store_dwordx4 v[132:135], v12, s[64:67], s79 offen
    s_add_u32 s79, s7, 1280
    s_waitcnt lgkmcnt(1)
    buffer_store_dwordx4 v[136:139], v12, s[64:67], s79 offen
    s_add_u32 s79, s7, 328960
    s_waitcnt lgkmcnt(0)
    buffer_store_dwordx4 v[140:143], v12, s[64:67], s79 offen
L_end:
    s_endpgm
L_roleS:
    s_mul_i32 s6, s81, 3
    s_add_u32 s6, s6, 224
    s_and_b32 s76, s6, 31
    s_lshr_b32 s77, s6, 5
    s_mul_i32 s78, s76, 81920
    s_lshl_b32 s79, s77, 7
    s_add_u32 s78, s78, s79
    s_sub_u32 s80, s78, 10240
    s_cmp_eq_u32 s76, 0
    s_cselect_b32 s80, 2621440, s80
    s_mul_i32 s79, s5, 20480
    s_add_u32 s78, s78, s79
    s_add_u32 s79, s78, 10240
    s_lshl2_add_u32 s16, s77, s5
    s_lshl_b32 s16, s16, 7
    v_add_u32 v6, s16, v3
    s_lshl_b32 s16, s5, 11
    s_waitcnt lgkmcnt(0)
    s_mov_b64 s[40:41], s[38:39]
    s_mov_b64 s[14:15], s[46:47]
    s_mov_b64 s[46:47], s[30:31]
    s_mov_b64 s[32:33], s[66:67]
    s_mov_b64 s[66:67], s[30:31]
    s_cmp_lg_u32 s2, 56
    s_cbranch_scc1 Lnoz_26
    s_cmp_lg_u32 s5, 0
    s_cbranch_scc1 Lnoz_26
    v_lshlrev_b32 v7, 7, v1
    buffer_store_dword v255, v7, s[60:63], 0 offen sc1
    v_mov_b32 v7, 1
    s_waitcnt vmcnt(0)
    s_mov_b64 exec, 1
    global_store_dword v255, v7, s[32:33] sc1
    s_mov_b64 exec, -1
Lnoz_26:
    s_add_u32 m0, s16, 54272
    s_nop 0
    buffer_load_dwordx4 v5, s[40:43], s78 offen nt lds
    s_add_u32 m0, s16, 55296
    global_load_dwordx2 v[20:21], v6, s[14:15]
    buffer_load_dwordx4 v4, s[40:43], s79 offen nt lds
    s_add_u32 m0, s16, 62464
    s_nop 0
    buffer_load_dwordx4 v4, s[44:47], s78 offen nt lds
    s_add_u32 m0, s16, 63488
    s_nop 0
    buffer_load_dwordx4 v5, s[44:47], s79 offen nt lds
    s_mov_b32 m0, 53248
    s_nop 0
    buffer_load_dwordx4 v4, s[40:43], s80 offen nt lds
    s_mul_i32 s6, s81, 3
    s_add_u32 s6, s6, 225
    s_and_b32 s76, s6, 31
    s_lshr_b32 s77, s6, 5
    s_mul_i32 s78, s76, 81920
    s_lshl_b32 s79, s77, 7
    s_add_u32 s78, s78, s79
    s_sub_u32 s80, s78, 10240
    s_cmp_eq_u32 s76, 0
    s_cselect_b32 s80, 2621440, s80
    s_mul_i32 s79, s5, 20480
    s_add_u32 s78, s78, s79
    s_add_u32 s79, s78, 10240
    s_lshl2_add_u32 s16, s77, s5
    s_lshl_b32 s16, s16, 7
    v_add_u32 v6, s16, v3
    s_lshl_b32 s16, s5, 11
    s_add_u32 m0, s16, 71680
    s_nop 0
    buffer_load_dwordx4 v5, s[40:43], s78 offen nt lds
    s_add_u32 m0, s16, 72704
    global_load_dwordx2 v[22:23], v6, s[14:15]
    buffer_load_dwordx4 v4, s[40:43], s79 offen nt lds
    s_add_u32 m0, s16, 79872
    s_nop 0
    buffer_load_dwordx4 v4, s[44:47], s78 offen nt lds
    s_add_u32 m0, s16, 80896
    s_nop 0
    buffer_load_dwordx4 v5, s[44:47], s79 offen nt lds
    s_mov_b32 m0, 70656
    s_nop 0
    buffer_load_dwordx4 v4, s[40:43], s80 offen nt lds
    v_and_b32 v6, 3, v1
    v_lshlrev_b32 v6, 2, v6
    v_bfe_u32 v7, v1, 2, 2
    v_add_u32 v6, v6, v7
    v_bfe_u32 v7, v1, 4, 1
    v_lshl_add_u32 v7, s5, 1, v7
    v_lshrrev_b32 v8, 5, v1
    v_add_u32 v9, 424, v6
    v_sub_u32 v9, v9, v8
    v_bfe_u32 v14, v9, 2, 2
    v_lshlrev_b32 v14, 1, v14
    v_xor_b32 v14, v14, v7
    v_lshlrev_b32 v14, 4, v14
    v_lshl_add_u32 v192, v9, 7, v14
    v_add_u32 v9, 422, v6
    v_sub_u32 v9, v9, v8
    v_bfe_u32 v14, v9, 2, 2
    v_lshlrev_b32 v14, 1, v14
    v_xor_b32 v14, v14, v7
    v_lshlrev_b32 v14, 4, v14
    v_lshl_add_u32 v193, v9, 7, v14
    v_add_u32 v9, 488, v6
    v_bfe_u32 v14, v6, 2, 2
    v_lshlrev_b32 v14, 1, v14
    v_xor_b32 v14, v14, v7
    v_lshlrev_b32 v14, 4, v14
    v_lshl_add_u32 v194, v9, 7, v14
    v_bfe_u32 v6, v1, 3, 1
    v_bfe_u32 v7, v1, 4, 1
    v_bfe_u32 v9, v1, 1, 2
    v_cmp_eq_u32 vcc, v6, v7
    v_lshlrev_b32 v195, 4, v8
    v_and_b32 v196, 1, v1
    v_cndmask_b32 v9, 7, v9, vcc
    v_lshlrev_b32 v196, 4, v196
    v_mov_b32 v6, 0xffff
    v_lshlrev_b32 v6, v196, v6
    v_sub_u32 v8, 1, v8
    v_mul_u32_u24 v8, 0x3f80, v8
    v_lshl_or_b32 v8, v8, 16, v8
    v_cmp_eq_u32 vcc, 0, v9
    v_and_b32 v14, 15, v1
    s_nop 0
    v_cndmask_b32 v212, 0, v6, vcc
    v_cmp_eq_u32 vcc, 1, v9
    v_and_b32 v200, v8, v212
    s_nop 0
    v_cndmask_b32 v213, 0, v6, vcc
    v_cmp_eq_u32 vcc, 2, v9
    v_and_b32 v201, v8, v213
    s_nop 0
    v_cndmask_b32 v214, 0, v6, vcc
    v_cmp_eq_u32 vcc, 3, v9
    v_and_b32 v202, v8, v214
    s_nop 0
    v_cndmask_b32 v215, 0, v6, vcc
    v_and_b32 v203, v8, v215
    s_lshl_b32 s6, s5, 11
    s_add_u32 s6, s6, 0
    v_lshlrev_b32 v14, 6, v14
    v_lshrrev_b32 v7, 4, v1
    v_lshl_add_u32 v14, v7, 4, v14
    v_add_u32 v224, s6, v14
    v_add_u32 v225, s6, v252
    v_lshrrev_b32 v14, 2, v1
    v_lshlrev_b32 v14, 12, v14
    v_and_b32 v7, 3, v1
    v_lshl_add_u32 v197, v7, 4, v14
    s_mul_i32 s6, s81, 3
    s_add_u32 s6, s6, 226
    s_and_b32 s76, s6, 31
    s_lshr_b32 s77, s6, 5
    s_mul_i32 s78, s76, 81920
    s_lshl_b32 s79, s77, 7
    s_add_u32 s78, s78, s79
    s_sub_u32 s80, s78, 10240
    s_cmp_eq_u32 s76, 0
    s_cselect_b32 s80, 2621440, s80
    s_mul_i32 s79, s5, 20480
    s_add_u32 s78, s78, s79
    s_add_u32 s79, s78, 10240
    s_lshl2_add_u32 s16, s77, s5
    s_lshl_b32 s16, s16, 7
    v_add_u32 v6, s16, v3
    s_lshl_b32 s16, s5, 11
    s_add_u32 m0, s16, 89088
    s_nop 0
    buffer_load_dwordx4 v5, s[40:43], s78 offen nt lds
    s_add_u32 m0, s16, 90112
    global_load_dwordx2 v[24:25], v6, s[14:15]
    buffer_load_dwordx4 v4, s[40:43], s79 offen nt lds
    s_add_u32 m0, s16, 97280
    s_nop 0
    buffer_load_dwordx4 v4, s[44:47], s78 offen nt lds
    s_add_u32 m0, s16, 98304
    s_nop 0
    buffer_load_dwordx4 v5, s[44:47], s79 offen nt lds
    s_mov_b32 m0, 88064
    s_nop 0
    buffer_load_dwordx4 v4, s[40:43], s80 offen nt lds
    s_mov_b64 s[38:39], s[30:31]
    s_mov_b64 s[18:19], s[58:59]
    s_mov_b64 s[58:59], s[30:31]
    s_mov_b64 s[28:29], s[54:55]
    s_waitcnt vmcnt(16)
    v_lshrrev_b32 v6, v195, v20
    v_and_b32 v6, 0xffff, v6
    v_lshl_or_b32 v6, v6, 16, v6
    v_and_b32 v204, v6, v212
    v_and_b32 v205, v6, v213
    v_and_b32 v206, v6, v214
    v_and_b32 v207, v6, v215
    v_lshrrev_b32 v6, v195, v21
    v_and_b32 v6, 0xffff, v6
    v_lshl_or_b32 v6, v6, 16, v6
    v_and_b32 v208, v6, v212
    v_and_b32 v209, v6, v213
    v_and_b32 v210, v6, v214
    v_and_b32 v211, v6, v215
    s_waitcnt vmcnt(12)
    s_barrier
    s_mul_i32 s6, s81, 3
    s_add_u32 s6, s6, 224
    s_and_b32 s76, s6, 31
    s_lshr_b32 s77, s6, 5
    ds_read_b128 v[148:151], v192 offset:0
    ds_read_b128 v[152:155], v193 offset:0
    ds_read_b128 v[156:159], v194 offset:0
    ds_read_b128 v[160:163], v192 offset:2048
    ds_read_b128 v[164:167], v193 offset:2048
    ds_read_b128 v[168:171], v194 offset:2048
    s_lshl2_add_u32 s16, s77, s5
    s_lshl_b32 s16, s16, 9
    s_add_u32 s16, s16, s76
    s_lshl_b32 s16, s16, 7
    s_add_u32 s16, s16, 1048576
    buffer_load_dwordx2 v[128:129], v2, s[36:39], s89 offen offset:0
    buffer_load_dwordx2 v[130:131], v2, s[36:39], s89 offen offset:256
    buffer_load_dwordx2 v[132:133], v2, s[36:39], s89 offen offset:512
    buffer_load_dwordx2 v[134:135], v2, s[36:39], s89 offen offset:768
    buffer_load_dwordx2 v[136:137], v2, s[36:39], s89 offen offset:1024
    s_waitcnt lgkmcnt(5)
    v_mfma_f32_16x16x32_bf16 v[172:175], v[148:151], v[204:207], 0
    s_waitcnt lgkmcnt(3)
    v_mfma_f32_16x16x32_bf16 v[180:183], v[156:159], v[200:203], 0
    v_mfma_f32_16x16x32_bf16 v[172:175], v[152:155], v[208:211], v[172:175]
    s_waitcnt lgkmcnt(2)
    v_mfma_f32_16x16x32_bf16 v[176:179], v[160:163], v[204:207], 0
    s_waitcnt lgkmcnt(0)
    v_mfma_f32_16x16x32_bf16 v[184:187], v[168:171], v[200:203], 0
    v_mfma_f32_16x16x32_bf16 v[176:179], v[164:167], v[208:211], v[176:179]
    ds_read_b128 v[148:151], v192 offset:4096
    ds_read_b128 v[152:155], v193 offset:4096
    ds_read_b128 v[156:159], v194 offset:4096
    ds_read_b128 v[160:163], v192 offset:6144
    ds_read_b128 v[164:167], v193 offset:6144
    ds_read_b128 v[168:171], v194 offset:6144
    v_mul_f32 v172, v172, v180
    v_mul_f32 v173, v173, v181
    v_mul_f32 v174, v174, v182
    v_mul_f32 v175, v175, v183
    v_cvt_pk_bf16_f32 v216, v172, v173
    v_cvt_pk_bf16_f32 v217, v174, v175
    v_mul_f32 v176, v176, v184
    v_mul_f32 v177, v177, v185
    v_mul_f32 v178, v178, v186
    v_mul_f32 v179, v179, v187
    v_cvt_pk_bf16_f32 v218, v176, v177
    v_cvt_pk_bf16_f32 v219, v178, v179
    ds_write_b128 v224, v[216:219] offset:0
    ds_read_b128 v[216:219], v225 offset:0
    s_waitcnt lgkmcnt(7)
    v_mfma_f32_16x16x32_bf16 v[172:175], v[148:151], v[204:207], 0
    s_waitcnt lgkmcnt(5)
    v_mfma_f32_16x16x32_bf16 v[180:183], v[156:159], v[200:203], 0
    v_mfma_f32_16x16x32_bf16 v[172:175], v[152:155], v[208:211], v[172:175]
    s_waitcnt lgkmcnt(4)
    v_mfma_f32_16x16x32_bf16 v[176:179], v[160:163], v[204:207], 0
    s_waitcnt lgkmcnt(2)
    v_mfma_f32_16x16x32_bf16 v[184:187], v[168:171], v[200:203], 0
    v_mfma_f32_16x16x32_bf16 v[176:179], v[164:167], v[208:211], v[176:179]
    s_nop 2
    v_mul_f32 v172, v172, v180
    v_mul_f32 v173, v173, v181
    v_mul_f32 v174, v174, v182
    v_mul_f32 v175, v175, v183
    v_cvt_pk_bf16_f32 v220, v172, v173
    v_cvt_pk_bf16_f32 v221, v174, v175
    s_waitcnt lgkmcnt(0)
    buffer_store_dwordx4 v[216:219], v197, s[60:63], s16 offen offset:0 sc1
    v_mul_f32 v176, v176, v184
    v_mul_f32 v177, v177, v185
    v_mul_f32 v178, v178, v186
    v_mul_f32 v179, v179, v187
    v_cvt_pk_bf16_f32 v222, v176, v177
    v_cvt_pk_bf16_f32 v223, v178, v179
    ds_write_b128 v224, v[220:223] offset:1024
    ds_read_b128 v[220:223], v225 offset:1024
    s_waitcnt lgkmcnt(0)
    buffer_store_dwordx4 v[220:223], v197, s[60:63], s16 offen offset:64 sc1
    s_lshl_b32 s96, s77, 7
    s_add_u32 s96, s96, 4096
    s_waitcnt vmcnt(17)
    v_lshrrev_b32 v6, v195, v22
    v_and_b32 v6, 0xffff, v6
    v_lshl_or_b32 v6, v6, 16, v6
    v_and_b32 v204, v6, v212
    v_and_b32 v205, v6, v213
    v_and_b32 v206, v6, v214
    v_and_b32 v207, v6, v215
    v_lshrrev_b32 v6, v195, v23
    v_and_b32 v6, 0xffff, v6
    v_lshl_or_b32 v6, v6, 16, v6
    v_and_b32 v208, v6, v212
    v_and_b32 v209, v6, v213
    v_and_b32 v210, v6, v214
    v_and_b32 v211, v6, v215
    s_waitcnt vmcnt(13)
    s_barrier
    s_mul_i32 s6, s81, 3
    s_add_u32 s6, s6, 225
    s_and_b32 s76, s6, 31
    s_lshr_b32 s77, s6, 5
    ds_read_b128 v[148:151], v192 offset:17408
    ds_read_b128 v[152:155], v193 offset:17408
    ds_read_b128 v[156:159], v194 offset:17408
    ds_read_b128 v[160:163], v192 offset:19456
    ds_read_b128 v[164:167], v193 offset:19456
    ds_read_b128 v[168:171], v194 offset:19456
    s_lshl2_add_u32 s16, s77, s5
    s_lshl_b32 s16, s16, 9
    s_add_u32 s16, s16, s76
    s_lshl_b32 s16, s16, 7
    s_add_u32 s16, s16, 1048576
    s_cmp_lg_u32 s5, 0
    s_cbranch_scc1 Lz_27
    global_load_dword v30, v255, s[32:33] sc1
Lz_27:
    s_waitcnt lgkmcnt(5)
    v_mfma_f32_16x16x32_bf16 v[172:175], v[148:151], v[204:207], 0
    s_waitcnt lgkmcnt(3)
    v_mfma_f32_16x16x32_bf16 v[180:183], v[156:159], v[200:203], 0
    v_mfma_f32_16x16x32_bf16 v[172:175], v[152:155], v[208:211], v[172:175]
    s_waitcnt lgkmcnt(2)
    v_mfma_f32_16x16x32_bf16 v[176:179], v[160:163], v[204:207], 0
    s_waitcnt lgkmcnt(0)
    v_mfma_f32_16x16x32_bf16 v[184:187], v[168:171], v[200:203], 0
    v_mfma_f32_16x16x32_bf16 v[176:179], v[164:167], v[208:211], v[176:179]
    ds_read_b128 v[148:151], v192 offset:21504
    ds_read_b128 v[152:155], v193 offset:21504
    ds_read_b128 v[156:159], v194 offset:21504
    ds_read_b128 v[160:163], v192 offset:23552
    ds_read_b128 v[164:167], v193 offset:23552
    ds_read_b128 v[168:171], v194 offset:23552
    v_mul_f32 v172, v172, v180
    v_mul_f32 v173, v173, v181
    v_mul_f32 v174, v174, v182
    v_mul_f32 v175, v175, v183
    v_cvt_pk_bf16_f32 v216, v172, v173
    v_cvt_pk_bf16_f32 v217, v174, v175
    v_mul_f32 v176, v176, v184
    v_mul_f32 v177, v177, v185
    v_mul_f32 v178, v178, v186
    v_mul_f32 v179, v179, v187
    v_cvt_pk_bf16_f32 v218, v176, v177
    v_cvt_pk_bf16_f32 v219, v178, v179
    ds_write_b128 v224, v[216:219] offset:0
    ds_read_b128 v[216:219], v225 offset:0
    s_waitcnt lgkmcnt(7)
    v_mfma_f32_16x16x32_bf16 v[172:175], v[148:151], v[204:207], 0
    s_waitcnt lgkmcnt(5)
    v_mfma_f32_16x16x32_bf16 v[180:183], v[156:159], v[200:203], 0
    v_mfma_f32_16x16x32_bf16 v[172:175], v[152:155], v[208:211], v[172:175]
    s_waitcnt lgkmcnt(4)
    v_mfma_f32_16x16x32_bf16 v[176:179], v[160:163], v[204:207], 0
    s_waitcnt lgkmcnt(2)
    v_mfma_f32_16x16x32_bf16 v[184:187], v[168:171], v[200:203], 0
    v_mfma_f32_16x16x32_bf16 v[176:179], v[164:167], v[208:211], v[176:179]
    s_nop 2
    v_mul_f32 v172, v172, v180
    v_mul_f32 v173, v173, v181
    v_mul_f32 v174, v174, v182
    v_mul_f32 v175, v175, v183
    v_cvt_pk_bf16_f32 v220, v172, v173
    v_cvt_pk_bf16_f32 v221, v174, v175
    s_waitcnt lgkmcnt(0)
    buffer_store_dwordx4 v[216:219], v197, s[60:63], s16 offen offset:0 sc1
    v_mul_f32 v176, v176, v184
    v_mul_f32 v177, v177, v185
    v_mul_f32 v178, v178, v186
    v_mul_f32 v179, v179, v187
    v_cvt_pk_bf16_f32 v222, v176, v177
    v_cvt_pk_bf16_f32 v223, v178, v179
    ds_write_b128 v224, v[220:223] offset:1024
    ds_read_b128 v[220:223], v225 offset:1024
    s_waitcnt lgkmcnt(0)
    buffer_store_dwordx4 v[220:223], v197, s[60:63], s16 offen offset:64 sc1
    s_lshl_b32 s97, s77, 7
    s_add_u32 s97, s97, 4096
    s_waitcnt vmcnt(13)
    v_lshrrev_b32 v6, v195, v24
    v_and_b32 v6, 0xffff, v6
    v_lshl_or_b32 v6, v6, 16, v6
    v_and_b32 v204, v6, v212
    v_and_b32 v205, v6, v213
    v_and_b32 v206, v6, v214
    v_and_b32 v207, v6, v215
    v_lshrrev_b32 v6, v195, v25
    v_and_b32 v6, 0xffff, v6
    v_lshl_or_b32 v6, v6, 16, v6
    v_and_b32 v208, v6, v212
    v_and_b32 v209, v6, v213
    v_and_b32 v210, v6, v214
    v_and_b32 v211, v6, v215
    s_waitcnt vmcnt(9)
    s_barrier
    s_mul_i32 s6, s81, 3
    s_add_u32 s6, s6, 226
    s_and_b32 s76, s6, 31
    s_lshr_b32 s77, s6, 5
    ds_read_b128 v[148:151], v192 offset:34816
    ds_read_b128 v[152:155], v193 offset:34816
    ds_read_b128 v[156:159], v194 offset:34816
    ds_read_b128 v[160:163], v192 offset:36864
    ds_read_b128 v[164:167], v193 offset:36864
    ds_read_b128 v[168:171], v194 offset:36864
    s_lshl2_add_u32 s16, s77, s5
    s_lshl_b32 s16, s16, 9
    s_add_u32 s16, s16, s76
    s_lshl_b32 s16, s16, 7
    s_add_u32 s16, s16, 1048576
    s_waitcnt lgkmcnt(5)
    v_mfma_f32_16x16x32_bf16 v[172:175], v[148:151], v[204:207], 0
    s_waitcnt lgkmcnt(3)
    v_mfma_f32_16x16x32_bf16 v[180:183], v[156:159], v[200:203], 0
    v_mfma_f32_16x16x32_bf16 v[172:175], v[152:155], v[208:211], v[172:175]
    s_waitcnt lgkmcnt(2)
    v_mfma_f32_16x16x32_bf16 v[176:179], v[160:163], v[204:207], 0
    s_waitcnt lgkmcnt(0)
    v_mfma_f32_16x16x32_bf16 v[184:187], v[168:171], v[200:203], 0
    v_mfma_f32_16x16x32_bf16 v[176:179], v[164:167], v[208:211], v[176:179]
    ds_read_b128 v[148:151], v192 offset:38912
    ds_read_b128 v[152:155], v193 offset:38912
    ds_read_b128 v[156:159], v194 offset:38912
    ds_read_b128 v[160:163], v192 offset:40960
    ds_read_b128 v[164:167], v193 offset:40960
    ds_read_b128 v[168:171], v194 offset:40960
    v_mul_f32 v172, v172, v180
    v_mul_f32 v173, v173, v181
    v_mul_f32 v174, v174, v182
    v_mul_f32 v175, v175, v183
    v_cvt_pk_bf16_f32 v216, v172, v173
    v_cvt_pk_bf16_f32 v217, v174, v175
    v_mul_f32 v176, v176, v184
    v_mul_f32 v177, v177, v185
    v_mul_f32 v178, v178, v186
    v_mul_f32 v179, v179, v187
    v_cvt_pk_bf16_f32 v218, v176, v177
    v_cvt_pk_bf16_f32 v219, v178, v179
    ds_write_b128 v224, v[216:219] offset:0
    ds_read_b128 v[216:219], v225 offset:0
    s_waitcnt lgkmcnt(7)
    v_mfma_f32_16x16x32_bf16 v[172:175], v[148:151], v[204:207], 0
    s_waitcnt lgkmcnt(5)
    v_mfma_f32_16x16x32_bf16 v[180:183], v[156:159], v[200:203], 0
    v_mfma_f32_16x16x32_bf16 v[172:175], v[152:155], v[208:211], v[172:175]
    s_waitcnt lgkmcnt(4)
    v_mfma_f32_16x16x32_bf16 v[176:179], v[160:163], v[204:207], 0
    s_waitcnt lgkmcnt(2)
    v_mfma_f32_16x16x32_bf16 v[184:187], v[168:171], v[200:203], 0
    v_mfma_f32_16x16x32_bf16 v[176:179], v[164:167], v[208:211], v[176:179]
    s_nop 2
    v_mul_f32 v172, v172, v180
    v_mul_f32 v173, v173, v181
    v_mul_f32 v174, v174, v182
    v_mul_f32 v175, v175, v183
    v_cvt_pk_bf16_f32 v220, v172, v173
    v_cvt_pk_bf16_f32 v221, v174, v175
    s_waitcnt lgkmcnt(0)
    buffer_store_dwordx4 v[216:219], v197, s[60:63], s16 offen offset:0 sc1
    v_mul_f32 v176, v176, v184
    v_mul_f32 v177, v177, v185
    v_mul_f32 v178, v178, v186
    v_mul_f32 v179, v179, v187
    v_cvt_pk_bf16_f32 v222, v176, v177
    v_cvt_pk_bf16_f32 v223, v178, v179
    ds_write_b128 v224, v[220:223] offset:1024
    ds_read_b128 v[220:223], v225 offset:1024
    s_waitcnt lgkmcnt(0)
    buffer_store_dwordx4 v[220:223], v197, s[60:63], s16 offen offset:64 sc1
    s_lshl_b32 s98, s77, 7
    s_add_u32 s98, s98, 4096
    s_mov_b32 s10, s72
    s_bfe_u32 s11, s4, 0x10002
    s_and_b32 s12, s4, 3
    s_lshl_b32 s6, s69, 2
    s_add_u32 s12, s12, s6
    s_mul_i32 s101, s5, 13
    s_cmp_lg_u32 s5, 0
    s_addc_u32 s101, s101, 0
    s_bfe_u32 s6, s4, 0x20002
    s_lshl_b32 s6, s6, 2
    s_sub_u32 s68, 16, s6
    s_sub_u32 s6, s6, 2
    s_max_i32 s31, s6, 0
    s_mul_i32 s74, s12, 54
    s_add_u32 s74, s74, s101
    s_mul_i32 s74, s74, 5120
    s_add_u32 s74, s74, 7340032
    s_mul_i32 s100, s31, 5120
    s_add_u32 s100, s100, s74
    s_mov_b32 s27, s100
    s_mul_i32 s86, s81, 6
    s_add_u32 s86, s86, 448
    s_mul_i32 s34, s86, 820
    s_lshr_b32 s34, s34, 16
    s_add_u32 s30, s86, 5
    s_mul_i32 s30, s30, 820
    s_lshr_b32 s30, s30, 16
    s_lshl_b32 s34, s34, 7
    s_add_u32 s34, s34, 7168
    s_lshl_b32 s30, s30, 7
    s_add_u32 s30, s30, 7168
    s_cmp_eq_u32 s34, s30
    s_cselect_b32 s30, 17825792, s30
    s_lshr_b32 s78, s86, 6
    s_lshl_b32 s78, s78, 7
    s_add_u32 s78, s78, 4096
    v_mov_b32 v241, s78
    s_add_u32 s78, s86, 5
    s_lshr_b32 s78, s78, 6
    s_lshl_b32 s78, s78, 7
    s_add_u32 s78, s78, 4096
    v_writelane_b32 v241, s78, 1
    v_mov_b32 v242, 32
    s_lshr_b32 s9, s12, 1
    s_lshl_b32 s9, s9, 7
    s_add_u32 s9, s9, 6144
    s_lshr_b32 s6, s5, 1
    s_add_u32 s86, s86, s6
    s_mul_i32 s87, s6, 8704
    s_add_u32 s88, s87, 4352
    s_and_b32 s6, s5, 1
    s_lshl_b32 s79, s6, 11
    s_add_u32 s99, s79, s87
    s_add_u32 s99, s99, 32
    s_lshl_b32 s95, s86, 12
    s_add_u32 s35, s95, s79
    s_add_u32 s95, s35, 1048576
    s_lshl_b32 s78, s86, 1
    v_mov_b32 v55, s78
    v_lshl_add_u32 v56, v1, 2, s88
    v_and_b32 v57, 7, v1
    v_lshl_add_u32 v57, v57, 2, s87
    s_mul_i32 s78, s6, 4160
    s_add_u32 s78, s78, s87
    v_mov_b32 v58, s78
    v_lshrrev_b32 v59, 2, v1
    v_lshlrev_b32 v59, 6, v59
    v_and_b32 v6, 3, v1
    v_lshl_add_u32 v59, v6, 3, v59
    s_add_u32 s79, s79, s88
    s_add_u32 s79, s79, 256
    v_add_u32 v59, s79, v59
    v_mov_b32 v138, 0
    v_mov_b32 v139, 0
    v_mov_b32 v140, 0x3f803f80
    s_waitcnt vmcnt(10)
    v_dot2c_f32_bf16 v138, v128, v140
    v_dot2c_f32_bf16 v138, v129, v140
    s_waitcnt vmcnt(9)
    v_dot2c_f32_bf16 v138, v130, v140
    v_dot2c_f32_bf16 v138, v131, v140
    s_waitcnt vmcnt(8)
    v_dot2c_f32_bf16 v138, v132, v140
    v_dot2c_f32_bf16 v138, v133, v140
    s_waitcnt vmcnt(7)
    v_dot2c_f32_bf16 v138, v134, v140
    v_dot2c_f32_bf16 v138, v135, v140
    s_waitcnt vmcnt(6)
    v_dot2c_f32_bf16 v138, v136, v140
    v_dot2c_f32_bf16 v138, v137, v140
    v_dot2c_f32_bf16 v139, v128, v128
    v_dot2c_f32_bf16 v139, v129, v129
    v_dot2c_f32_bf16 v139, v130, v130
    v_dot2c_f32_bf16 v139, v131, v131
    v_dot2c_f32_bf16 v139, v132, v132
    v_dot2c_f32_bf16 v139, v133, v133
    v_dot2c_f32_bf16 v139, v134, v134
    v_dot2c_f32_bf16 v139, v135, v135
    v_dot2c_f32_bf16 v139, v136, v136
    v_dot2c_f32_bf16 v139, v137, v137
    s_cmp_lg_u32 s5, 0
    s_cbranch_scc1 Lz_28
    s_waitcnt vmcnt(4)
    v_readfirstlane_b32 s83, v30
    s_mov_b32 s82, 0
    s_nop 0
    s_cmp_ge_u32 s83, 1
    s_cbranch_scc1 Lok_29
Lspin_30:
    global_load_dword v30, v255, s[32:33] sc1
    s_waitcnt vmcnt(0)
    v_readfirstlane_b32 s83, v30
    s_add_u32 s82, s82, 1
    s_cmp_ge_u32 s82, 200000
    s_waitcnt lgkmcnt(0)
    s_cbranch_scc1 Lok_29
    s_cmp_lt_u32 s83, 1
    s_cbranch_scc1 Lspin_30
Lok_29:
Lz_28:
    s_waitcnt vmcnt(0) lgkmcnt(0)
    s_barrier
    s_cmp_lg_u32 s5, 0
    s_cbranch_scc1 Lsig_31
    v_mov_b32 v6, 1
    s_mov_b64 exec, 1
    buffer_atomic_add v6, v255, s[60:63], s96 offen sc1
    buffer_atomic_add v6, v255, s[60:63], s97 offen sc1
    buffer_atomic_add v6, v255, s[60:63], s98 offen sc1
    s_mov_b64 exec, -1
Lsig_31:
    s_lshl_b32 s78, s72, 4
    s_add_u32 s78, s78, s73
    v_add_f32_dpp v138, v138, v138 quad_perm:[1,0,3,2] row_mask:0xf bank_mask:0xf
    v_add_f32_dpp v139, v139, v139 quad_perm:[1,0,3,2] row_mask:0xf bank_mask:0xf
    s_nop 0
    v_add_f32_dpp v138, v138, v138 quad_perm:[2,3,0,1] row_mask:0xf bank_mask:0xf
    v_add_f32_dpp v139, v139, v139 quad_perm:[2,3,0,1] row_mask:0xf bank_mask:0xf
    s_nop 0
    v_add_f32_dpp v138, v138, v138 row_half_mirror row_mask:0xf bank_mask:0xf
    v_add_f32_dpp v139, v139, v139 row_half_mirror row_mask:0xf bank_mask:0xf
    s_nop 0
    v_add_f32_dpp v138, v138, v138 row_mirror row_mask:0xf bank_mask:0xf
    v_add_f32_dpp v139, v139, v139 row_mirror row_mask:0xf bank_mask:0xf
    v_mov_b32 v140, v138
    v_mov_b32 v141, v139
    s_lshl_b32 s79, s78, 7
    s_add_u32 s79, s79, 32768
    v_permlane16_swap_b32 v138, v140
    v_permlane16_swap_b32 v139, v141
    v_add_f32 v138, v138, v140
    v_add_f32 v139, v139, v141
    v_mul_f32 v128, 0x3acccccd, v138
    v_mul_f32 v139, 0x3acccccd, v139
    v_fma_f32 v139, -v128, v128, v139
    v_cvt_pk_bf16_f32 v132, -v128, -v128
    v_max_f32 v139, 0, v139
    v_add_f32 v139, 0x3727c5ac, v139
    v_and_b32 v140, 0xffff0000, v132
    v_rsq_f32 v129, v139
    v_sub_f32 v140, -v128, v140
    v_lshrrev_b32 v141, 5, v0
    v_mul_f32 v146, v139, v129
    v_mul_f32 v144, 0xc0135761, v129
    v_cvt_pk_bf16_f32 v133, v140, v146
    v_mul_f32 v145, v129, v129
    v_and_b32 v140, 0xffff0000, v133
    v_mul_f32 v145, 0x3d372713, v145
    v_sub_f32 v140, v146, v140
    v_mul_f32 v145, v145, v144
    v_cvt_pk_bf16_f32 v134, v140, 0
    v_mov_b32 v135, 0
    v_mov_b32 v147, v129
    v_lshlrev_b32 v140, 4, v141
    v_lshlrev_b32 v141, 3, v141
    s_add_u32 s80, s79, 32768
    s_lshl_b32 s78, s78, 6
    s_add_u32 s78, s78, 98304
    s_mov_b32 exec_lo, 1
    s_mov_b32 exec_hi, 1
    buffer_store_dwordx4 v[132:135], v140, s[60:63], s79 offen sc1
    buffer_store_dwordx4 v[144:147], v140, s[60:63], s80 offen sc1
    buffer_store_dwordx2 v[128:129], v141, s[60:63], s78 offen sc1
    s_mov_b64 exec, -1
    s_mov_b32 m0, s99
    global_load_ushort v228, v55, s[18:19]
    buffer_load_dwordx4 v252, s[56:59], s35 offen offset:0 nt lds
    buffer_load_dwordx4 v252, s[56:59], s35 offen offset:1024 nt lds
    ds_write_b32 v56, v255 offset:0
    ds_write_b32 v57, v255 offset:0
    s_add_u32 s99, s99, 17408
    s_add_u32 s35, s35, 8192
    v_add_u32 v55, 4, v55
    s_mov_b32 m0, s99
    global_load_ushort v229, v55, s[18:19]
    buffer_load_dwordx4 v252, s[56:59], s35 offen offset:0 nt lds
    buffer_load_dwordx4 v252, s[56:59], s35 offen offset:1024 nt lds
    ds_write_b32 v56, v255 offset:17408
    ds_write_b32 v57, v255 offset:17408
    s_add_u32 s99, s99, 17408
    s_add_u32 s35, s35, 8192
    v_add_u32 v55, 4, v55
    s_mov_b32 m0, s99
    global_load_ushort v230, v55, s[18:19]
    buffer_load_dwordx4 v252, s[56:59], s35 offen offset:0 nt lds
    buffer_load_dwordx4 v252, s[56:59], s35 offen offset:1024 nt lds
    ds_write_b32 v56, v255 offset:34816
    ds_write_b32 v57, v255 offset:34816
    v_bfe_u32 v2, v1, 2, 2
    v_lshrrev_b32 v6, 4, v1
    v_lshlrev_b32 v7, 1, v6
    v_sub_u32 v3, v2, v7
    v_lshlrev_b32 v3, 5, v3
    v_and_b32 v7, 3, v1
    v_sub_u32 v4, v7, v2
    v_lshl_add_u32 v2, v7, 3, v3
    s_add_u32 s6, s88, 224
    v_add_u32 v2, s6, v2
    v_add_u32 v3, 2048, v2
    v_lshlrev_b32 v4, 3, v4
    v_lshl_add_u32 v4, v6, 6, v4
    s_add_u32 s6, s87, 32
    v_add_u32 v4, s6, v4
    v_lshlrev_b32 v13, 3, v6
    v_lshrrev_b32 v6, 3, v1
    v_mul_u32_u24 v6, 81920, v6
    v_and_b32 v7, 7, v1
    v_lshl_add_u32 v5, v7, 4, v6
    v_lshrrev_b32 v6, 4, v1
    v_mul_u32_u24 v6, 81920, v6
    v_and_b32 v7, 15, v1
    v_lshl_add_u32 v6, v7, 4, v6
    v_cmp_gt_u32 vcc, 10, v7
    v_mov_b32 v7, 1073741824
    s_nop 0
    v_cndmask_b32 v12, v7, v6, vcc
    v_bfe_u32 v6, v1, 2, 2
    v_mul_u32_u24 v6, 1088, v6
    v_and_b32 v7, 3, v1
    v_lshl_add_u32 v6, v7, 8, v6
    s_mul_i32 s21, s5, 4608
    s_add_u32 s21, s21, 106496
    v_add3_u32 v13, v13, v6, s21
    s_lshr_b32 s7, s10, 2
    s_lshl_b32 s7, s7, 9
    s_and_b32 s6, s10, 3
    s_lshl_b32 s6, s6, 4
    s_add_u32 s7, s7, s6
    s_lshl_b32 s6, s11, 3
    s_add_u32 s7, s7, s6
    s_lshl_b32 s6, s5, 1
    s_add_u32 s7, s7, s6
    s_mul_i32 s7, s7, 1280
    s_mul_i32 s6, s12, 160
    s_add_u32 s7, s7, s6
    s_add_u32 s6, s5, 1
    s_and_b32 s6, s6, 3
    s_lshl_b32 s6, s6, 10
    v_add_u32 v8, s6, v252
    s_add_u32 s6, s5, 2
    s_and_b32 s6, s6, 3
    s_lshl_b32 s6, s6, 10
    v_add_u32 v9, s6, v252
    s_add_u32 s6, s5, 3
    s_and_b32 s6, s6, 3
    s_lshl_b32 s6, s6, 10
    v_add_u32 v10, s6, v252
    s_add_u32 s6, s5, 4
    s_and_b32 s6, s6, 3
    s_lshl_b32 s6, s6, 10
    v_add_u32 v11, s6, v252
    s_lshl_b32 s6, s10, 1
    s_add_u32 s6, s6, s11
    s_mul_i32 s6, s6, 54
    s_add_u32 s6, s6, s101
    s_lshl_b32 s6, s6, 12
    s_add_u32 s14, s6, 10485760
    s_lshl_b32 s20, s31, 12
    s_add_u32 s20, s20, s14
    s_cmp_ge_u32 s5, 2
    s_cselect_b32 s15, 17825792, s14
    s_cmp_eq_u32 s31, 0
    s_cselect_b32 s17, s15, s20
    s_getpc_b64 s[78:79]
Lpc_32:
    v_lshrrev_b32 v6, 3, v0
    v_lshl_add_u32 v6, s70, 5, v6
    v_lshlrev_b32 v6, 7, v6
    v_min_u32 v6, L_end-L_conv, v6
    v_add_u32 v6, L_conv-Lpc_32, v6
    v_ashrrev_i32 v7, 31, v6
    v_mov_b32 v247, s79
    v_add_co_u32 v246, vcc, s78, v6
    s_nop 1
    v_addc_co_u32 v247, vcc, v247, v7, vcc
    s_waitcnt vmcnt(9)
    s_barrier
    s_lshl_b32 s78, s72, 7
    s_cmp_lg_u32 s5, 0
    s_cbranch_scc1 Lsig_33
    v_mov_b32 v6, 1
    s_mov_b64 exec, 1
    buffer_atomic_add v6, v255, s[60:63], s78 offen sc1
    s_mov_b64 exec, -1
Lsig_33:
    s_cmp_lg_u32 s5, 0
    s_cbranch_scc1 Lz_34
    v_mov_b32 v243, 0
    s_mov_b64 exec, 3
    buffer_atomic_add v243, v241, s[60:63], 0 offen sc0 sc1
    s_mov_b64 exec, -1
Lz_34:
    s_waitcnt vmcnt(0)
    ds_read_u16 v15, v58 offset:32
    v_lshlrev_b32 v6, 16, v228
    s_waitcnt lgkmcnt(0)
    v_lshlrev_b32 v15, 16, v15
    v_add_f32 v15, v15, v6
    v_cvt_pk_bf16_f32 v15, v15, v15
    ds_write_b16 v58, v15 offset:32
    ds_read_u16 v15, v58 offset:17440
    v_lshlrev_b32 v6, 16, v229
    s_waitcnt lgkmcnt(0)
    v_lshlrev_b32 v15, 16, v15
    v_add_f32 v15, v15, v6
    v_cvt_pk_bf16_f32 v15, v15, v15
    ds_write_b16 v58, v15 offset:17440
    ds_read_u16 v15, v58 offset:34848
    v_lshlrev_b32 v6, 16, v230
    s_waitcnt lgkmcnt(0)
    v_lshlrev_b32 v15, 16, v15
    v_add_f32 v15, v15, v6
    v_cvt_pk_bf16_f32 v15, v15, v15
    ds_write_b16 v58, v15 offset:34848
    s_waitcnt lgkmcnt(0)
    s_cmp_lg_u32 s5, 0
    s_cbranch_scc1 Lok_35
    s_mov_b32 s82, 0
    s_waitcnt vmcnt(0)
Lspin_36:
    v_cmp_gt_u32 vcc, 32, v243
    s_add_u32 s82, s82, 1
    s_cmp_ge_u32 s82, 200000
    s_cbranch_scc1 Lok_35
    s_and_b32 s83, vcc_lo, 3
    s_cbranch_scc0 Lok_35
    s_sleep 8
    v_mov_b32 v243, 0
    s_mov_b64 exec, 3
    buffer_atomic_add v243, v241, s[60:63], 0 offen sc0 sc1
    s_mov_b64 exec, -1
    s_waitcnt vmcnt(0)
    s_branch Lspin_36
Lok_35:
    s_barrier
    buffer_load_dwordx4 v[64:67], v252, s[60:63], s95 offen offset:0 sc1
    buffer_load_dwordx4 v[68:71], v252, s[60:63], s95 offen offset:1024 sc1
    s_add_u32 s95, s95, 8192
    v_add_u32 v88, 0, v59
    buffer_load_dwordx4 v[72:75], v252, s[60:63], s95 offen offset:0 sc1
    buffer_load_dwordx4 v[76:79], v252, s[60:63], s95 offen offset:1024 sc1
    s_add_u32 s95, s95, 8192
    v_add_u32 v89, 17408, v59
    buffer_load_dwordx4 v[80:83], v252, s[60:63], s95 offen offset:0 sc1
    buffer_load_dwordx4 v[84:87], v252, s[60:63], s95 offen offset:1024 sc1
    s_add_u32 s95, s95, 8192
    v_add_u32 v90, 34816, v59
    s_mul_i32 s78, s3, 229376
    s_lshl2_add_u32 s79, s70, s5
    s_mul_i32 s79, s79, 14336
    s_add_u32 s78, s78, s79
    v_lshlrev_b32 v6, 7, v1
    buffer_load_dword v232, v6, s[56:59], s78 offen
    s_add_u32 s78, s78, 6144
    buffer_load_dword v233, v6, s[56:59], s78 offen
    ds_read_b64_tr_b16 v[16:17], v4 offset:0
    ds_read_b64_tr_b16 v[18:19], v4 offset:32
    ds_read_b64_tr_b16 v[20:21], v4 offset:256
    ds_read_b64_tr_b16 v[22:23], v4 offset:288
    ds_read_b64_tr_b16 v[24:25], v4 offset:512
    ds_read_b64_tr_b16 v[26:27], v4 offset:544
    ds_read_b64_tr_b16 v[28:29], v4 offset:768
    ds_read_b64_tr_b16 v[30:31], v4 offset:800
    ds_read_b64_tr_b16 v[32:33], v4 offset:1024
    ds_read_b64_tr_b16 v[34:35], v4 offset:1056
    ds_read_b64_tr_b16 v[36:37], v4 offset:1280
    ds_read_b64_tr_b16 v[38:39], v4 offset:1312
    ds_read_b64_tr_b16 v[40:41], v4 offset:1536
    ds_read_b64_tr_b16 v[42:43], v4 offset:1568
    ds_read_b64_tr_b16 v[44:45], v4 offset:1792
    ds_read_b64_tr_b16 v[46:47], v4 offset:1824
    ds_read_b64_tr_b16 v[48:49], v4 offset:2048
    ds_read_b64_tr_b16 v[50:51], v4 offset:2080
    ds_read_b64_tr_b16 v[52:53], v4 offset:2304
    ds_read_b64_tr_b16 v[54:55], v4 offset:2336
    ds_read_b64_tr_b16 v[56:57], v4 offset:2560
    ds_read_b64_tr_b16 v[58:59], v4 offset:2592
    ds_read_b64_tr_b16 v[60:61], v4 offset:2816
    ds_read_b64_tr_b16 v[62:63], v4 offset:2848
    ds_read_b64_tr_b16 v[192:193], v4 offset:3072
    ds_read_b64_tr_b16 v[194:195], v4 offset:3104
    ds_read_b64_tr_b16 v[196:197], v4 offset:3328
    ds_read_b64_tr_b16 v[198:199], v4 offset:3360
    ds_read_b64_tr_b16 v[200:201], v4 offset:3584
    ds_read_b64_tr_b16 v[202:203], v4 offset:3616
    ds_read_b64_tr_b16 v[204:205], v4 offset:3840
    ds_read_b64_tr_b16 v[206:207], v4 offset:3872
    s_waitcnt vmcnt(7)
    ds_write2_b64 v88, v[64:65], v[66:67] offset0:0 offset1:4
    s_waitcnt vmcnt(6)
    ds_write2_b64 v88, v[68:69], v[70:71] offset0:128 offset1:132
    s_waitcnt vmcnt(5)
    ds_write2_b64 v89, v[72:73], v[74:75] offset0:0 offset1:4
    s_waitcnt vmcnt(4)
    ds_write2_b64 v89, v[76:77], v[78:79] offset0:128 offset1:132
    s_waitcnt vmcnt(3)
    ds_write2_b64 v90, v[80:81], v[82:83] offset0:0 offset1:4
    s_waitcnt vmcnt(2)
    ds_write2_b64 v90, v[84:85], v[86:87] offset0:128 offset1:132
    s_mov_b32 s85, 0
    s_mov_b32 s89, 0
    s_mov_b64 vcc, 0
    s_waitcnt lgkmcnt(0)
    s_barrier
    ds_read2_b64 v[164:167], v2 offset0:4 offset1:0
    ds_read2_b64 v[168:171], v2 offset0:20 offset1:16
    global_load_dword v245, v[246:247], off
L_plain:
    s_lshl_b32 s13, s86, 7
    s_add_u32 s13, s13, 4194304
    s_waitcnt lgkmcnt(0)
    s_bitcmp1_b32 s5, 0
    s_cbranch_scc1 LconvB_37
    v_mfma_f32_16x16x32_bf16 v[64:67], v[164:167], v[16:19], 0
    ds_read2_b64 v[172:175], v2 offset0:36 offset1:32
    v_mfma_f32_16x16x32_bf16 v[72:75], v[164:167], v[20:23], 0
    v_mfma_f32_16x16x32_bf16 v[80:83], v[164:167], v[24:27], 0
    v_mfma_f32_16x16x32_bf16 v[88:91], v[164:167], v[28:31], 0
    s_cbranch_vccz Lw_39
    buffer_load_dwordx4 a[0:3], v252, s[60:63], s27 offen offset:0 sc1
    buffer_load_dwordx4 a[4:7], v252, s[60:63], s27 offen offset:1024 sc1
    buffer_load_dwordx4 a[8:11], v252, s[60:63], s27 offen offset:2048 sc1
    buffer_load_dwordx4 a[12:15], v252, s[60:63], s27 offen offset:3072 sc1
    s_add_u32 s27, s27, 4096
Lw_39:
    v_add_f32_dpp v132, v67, v66 wave_shr:1 row_mask:0xf bank_mask:0xf bound_ctrl:0
    v_mfma_f32_16x16x32_bf16 v[100:103], v[164:167], v[192:195], 0
    s_nop 0
    v_add_f32_dpp v134, v132, v65 wave_shr:1 row_mask:0xf bank_mask:0xf bound_ctrl:0
    v_mfma_f32_16x16x32_bf16 v[108:111], v[164:167], v[196:199], 0
    s_nop 0
    v_add_f32_dpp v136, v134, v64 wave_shr:1 row_mask:0xf bank_mask:0xf bound_ctrl:0
    v_mfma_f32_16x16x32_bf16 v[116:119], v[164:167], v[200:203], 0
    v_mfma_f32_16x16x32_bf16 v[124:127], v[164:167], v[204:207], 0
    v_mfma_f32_16x16x32_bf16 v[68:71], v[168:171], v[16:19], 0
    ds_read2_b64 v[176:179], v2 offset0:52 offset1:48
    v_mfma_f32_16x16x32_bf16 v[76:79], v[168:171], v[20:23], 0
    v_mfma_f32_16x16x32_bf16 v[84:87], v[168:171], v[24:27], 0
    v_mfma_f32_16x16x32_bf16 v[92:95], v[168:171], v[28:31], 0
    s_nop 3
    v_add_f32_dpp v133, v67, v70 wave_ror:1 row_mask:0xf bank_mask:0xf
    v_mfma_f32_16x16x32_bf16 v[96:99], v[168:171], v[60:63], 0
    v_add_f32_dpp v135, v132, v69 wave_ror:1 row_mask:0xf bank_mask:0xf
    v_mfma_f32_16x16x32_bf16 v[104:107], v[168:171], v[192:195], 0
    s_cbranch_vccz Lw_40
    buffer_load_dwordx4 a[16:19], v252, s[60:63], s27 offen offset:0 sc1
    buffer_load_dwordx4 a[20:23], v252, s[60:63], s27 offen offset:1024 sc1
    buffer_load_dwordx4 a[24:27], v252, s[60:63], s27 offen offset:2048 sc1
    buffer_load_dwordx4 a[28:31], v252, s[60:63], s27 offen offset:3072 sc1
    s_add_u32 s27, s27, 4096
Lw_40:
    v_add_f32_dpp v137, v134, v68 wave_ror:1 row_mask:0xf bank_mask:0xf
    v_mfma_f32_16x16x32_bf16 v[112:115], v[168:171], v[196:199], 0
    v_add_f32_dpp v133, v71, v70 wave_shr:1 row_mask:0xf bank_mask:0xf
    v_mfma_f32_16x16x32_bf16 v[120:123], v[168:171], v[200:203], 0
    s_nop 0
    v_add_f32_dpp v135, v133, v69 wave_shr:1 row_mask:0xf bank_mask:0xf
    v_mfma_f32_16x16x32_bf16 v[128:131], v[168:171], v[204:207], 0
    s_nop 0
    v_add_f32_dpp v137, v135, v68 wave_shr:1 row_mask:0xf bank_mask:0xf
    s_waitcnt lgkmcnt(1)
    v_mfma_f32_16x16x32_bf16 v[72:75], v[172:175], v[16:19], v[72:75]
    ds_read2_b64 v[164:167], v2 offset0:68 offset1:64
    v_cvt_pk_bf16_f32 v140, v136, v137
    v_mfma_f32_16x16x32_bf16 v[80:83], v[172:175], v[20:23], v[80:83]
    v_mfma_f32_16x16x32_bf16 v[88:91], v[172:175], v[24:27], v[88:91]
    v_mfma_f32_16x16x32_bf16 v[100:103], v[172:175], v[60:63], v[100:103]
    s_nop 2
    v_add_f32_dpp v132, v71, v74 wave_ror:1 row_mask:0xf bank_mask:0xf
    v_mfma_f32_16x16x32_bf16 v[108:111], v[172:175], v[192:195], v[108:111]
    v_add_f32_dpp v134, v133, v73 wave_ror:1 row_mask:0xf bank_mask:0xf
    v_mfma_f32_16x16x32_bf16 v[116:119], v[172:175], v[196:199], v[116:119]
    v_add_f32_dpp v136, v135, v72 wave_ror:1 row_mask:0xf bank_mask:0xf
    v_mfma_f32_16x16x32_bf16 v[124:127], v[172:175], v[200:203], v[124:127]
    s_cbranch_vccz Lw_41
    buffer_load_dwordx4 a[32:35], v252, s[60:63], s27 offen offset:0 sc1
    buffer_load_dwordx4 a[36:39], v252, s[60:63], s27 offen offset:1024 sc1
    buffer_load_dwordx4 a[40:43], v252, s[60:63], s27 offen offset:2048 sc1
    buffer_load_dwordx4 a[44:47], v252, s[60:63], s27 offen offset:3072 sc1
    s_add_u32 s27, s27, 4096
Lw_41:
    v_add_f32_dpp v132, v75, v74 wave_shr:1 row_mask:0xf bank_mask:0xf
    s_waitcnt lgkmcnt(1)
    v_mfma_f32_16x16x32_bf16 v[76:79], v[176:179], v[16:19], v[76:79]
    ds_read2_b64 v[168:171], v2 offset0:84 offset1:80
    v_add_f32_dpp v134, v132, v73 wave_shr:1 row_mask:0xf bank_mask:0xf
    v_mfma_f32_16x16x32_bf16 v[84:87], v[176:179], v[20:23], v[84:87]
    s_nop 0
    v_add_f32_dpp v136, v134, v72 wave_shr:1 row_mask:0xf bank_mask:0xf
    v_mfma_f32_16x16x32_bf16 v[92:95], v[176:179], v[24:27], v[92:95]
    v_mfma_f32_16x16x32_bf16 v[96:99], v[176:179], v[56:59], v[96:99]
    s_nop 0
    v_add_f32_dpp v133, v75, v78 wave_ror:1 row_mask:0xf bank_mask:0xf
    v_mfma_f32_16x16x32_bf16 v[104:107], v[176:179], v[60:63], v[104:107]
    v_add_f32_dpp v135, v132, v77 wave_ror:1 row_mask:0xf bank_mask:0xf
    v_mfma_f32_16x16x32_bf16 v[112:115], v[176:179], v[192:195], v[112:115]
    v_add_f32_dpp v137, v134, v76 wave_ror:1 row_mask:0xf bank_mask:0xf
    v_mfma_f32_16x16x32_bf16 v[120:123], v[176:179], v[196:199], v[120:123]
    v_add_f32_dpp v133, v79, v78 wave_shr:1 row_mask:0xf bank_mask:0xf
    v_mfma_f32_16x16x32_bf16 v[128:131], v[176:179], v[200:203], v[128:131]
    s_nop 0
    v_add_f32_dpp v135, v133, v77 wave_shr:1 row_mask:0xf bank_mask:0xf
    s_waitcnt lgkmcnt(1)
    v_mfma_f32_16x16x32_bf16 v[80:83], v[164:167], v[16:19], v[80:83]
    ds_read2_b64 v[172:175], v2 offset0:100 offset1:96
    v_add_f32_dpp v137, v135, v76 wave_shr:1 row_mask:0xf bank_mask:0xf
    v_mfma_f32_16x16x32_bf16 v[88:91], v[164:167], v[20:23], v[88:91]
    s_cbranch_vccz Lw_42
    buffer_load_dwordx4 a[48:51], v252, s[60:63], s27 offen offset:0 sc1
    buffer_load_dwordx4 a[52:55], v252, s[60:63], s27 offen offset:1024 sc1
    buffer_load_dwordx4 a[56:59], v252, s[60:63], s27 offen offset:2048 sc1
    buffer_load_dwordx4 a[60:63], v252, s[60:63], s27 offen offset:3072 sc1
    s_add_u32 s27, s27, 4096
Lw_42:
    v_cvt_pk_bf16_f32 v141, v136, v137
    v_mfma_f32_16x16x32_bf16 v[100:103], v[164:167], v[56:59], v[100:103]
    v_mfma_f32_16x16x32_bf16 v[108:111], v[164:167], v[60:63], v[108:111]
    v_add_f32_dpp v132, v79, v82 wave_ror:1 row_mask:0xf bank_mask:0xf
    v_mfma_f32_16x16x32_bf16 v[116:119], v[164:167], v[192:195], v[116:119]
    v_add_f32_dpp v134, v133, v81 wave_ror:1 row_mask:0xf bank_mask:0xf
    v_mfma_f32_16x16x32_bf16 v[124:127], v[164:167], v[196:199], v[124:127]
    v_add_f32_dpp v136, v135, v80 wave_ror:1 row_mask:0xf bank_mask:0xf
    s_waitcnt lgkmcnt(1)
    v_mfma_f32_16x16x32_bf16 v[84:87], v[168:171], v[16:19], v[84:87]
    ds_read2_b64 v[176:179], v2 offset0:116 offset1:112
    v_add_f32_dpp v132, v83, v82 wave_shr:1 row_mask:0xf bank_mask:0xf
    v_mfma_f32_16x16x32_bf16 v[92:95], v[168:171], v[20:23], v[92:95]
    s_nop 0
    v_add_f32_dpp v134, v132, v81 wave_shr:1 row_mask:0xf bank_mask:0xf
    v_mfma_f32_16x16x32_bf16 v[96:99], v[168:171], v[52:55], v[96:99]
    s_nop 0
    v_add_f32_dpp v136, v134, v80 wave_shr:1 row_mask:0xf bank_mask:0xf
    v_mfma_f32_16x16x32_bf16 v[104:107], v[168:171], v[56:59], v[104:107]
    v_add_f32_dpp v133, v83, v86 wave_ror:1 row_mask:0xf bank_mask:0xf
    v_mfma_f32_16x16x32_bf16 v[112:115], v[168:171], v[60:63], v[112:115]
    v_add_f32_dpp v135, v132, v85 wave_ror:1 row_mask:0xf bank_mask:0xf
    v_mfma_f32_16x16x32_bf16 v[120:123], v[168:171], v[192:195], v[120:123]
    s_cbranch_vccz Lw_43
    buffer_load_dwordx4 a[64:67], v252, s[60:63], s27 offen offset:0 sc1
    buffer_load_dwordx4 a[68:71], v252, s[60:63], s27 offen offset:1024 sc1
    buffer_load_dwordx4 a[72:75], v252, s[60:63], s27 offen offset:2048 sc1
    buffer_load_dwordx4 a[76:79], v252, s[60:63], s27 offen offset:3072 sc1
    s_add_u32 s27, s27, 4096
Lw_43:
    v_add_f32_dpp v137, v134, v84 wave_ror:1 row_mask:0xf bank_mask:0xf
    v_mfma_f32_16x16x32_bf16 v[128:131], v[168:171], v[196:199], v[128:131]
    v_add_f32_dpp v133, v87, v86 wave_shr:1 row_mask:0xf bank_mask:0xf
    s_waitcnt lgkmcnt(1)
    v_mfma_f32_16x16x32_bf16 v[88:91], v[172:175], v[16:19], v[88:91]
    ds_read2_b64 v[164:167], v2 offset0:132 offset1:128
    v_add_f32_dpp v135, v133, v85 wave_shr:1 row_mask:0xf bank_mask:0xf
    v_mfma_f32_16x16x32_bf16 v[100:103], v[172:175], v[52:55], v[100:103]
    s_nop 0
    v_add_f32_dpp v137, v135, v84 wave_shr:1 row_mask:0xf bank_mask:0xf
    v_mfma_f32_16x16x32_bf16 v[108:111], v[172:175], v[56:59], v[108:111]
    v_cvt_pk_bf16_f32 v142, v136, v137
    v_mfma_f32_16x16x32_bf16 v[116:119], v[172:175], v[60:63], v[116:119]
    v_add_f32_dpp v132, v87, v90 wave_ror:1 row_mask:0xf bank_mask:0xf
    v_mfma_f32_16x16x32_bf16 v[124:127], v[172:175], v[192:195], v[124:127]
    v_add_f32_dpp v134, v133, v89 wave_ror:1 row_mask:0xf bank_mask:0xf
    s_waitcnt lgkmcnt(1)
    v_mfma_f32_16x16x32_bf16 v[92:95], v[176:179], v[16:19], v[92:95]
    ds_read2_b64 v[168:171], v2 offset0:148 offset1:144
    v_add_f32_dpp v136, v135, v88 wave_ror:1 row_mask:0xf bank_mask:0xf
    v_mfma_f32_16x16x32_bf16 v[96:99], v[176:179], v[48:51], v[96:99]
    v_add_f32_dpp v132, v91, v90 wave_shr:1 row_mask:0xf bank_mask:0xf
    v_mfma_f32_16x16x32_bf16 v[104:107], v[176:179], v[52:55], v[104:107]
    s_nop 0
    v_add_f32_dpp v134, v132, v89 wave_shr:1 row_mask:0xf bank_mask:0xf
    v_mfma_f32_16x16x32_bf16 v[112:115], v[176:179], v[56:59], v[112:115]
    s_cbranch_vccz Lw_44
    s_cmp_eq_u32 s68, 4
    s_cselect_b32 s27, s74, s27
    buffer_load_dwordx4 a[80:83], v252, s[60:63], s27 offen offset:0 sc1
    buffer_load_dwordx4 a[84:87], v252, s[60:63], s27 offen offset:1024 sc1
    buffer_load_dwordx4 a[88:91], v252, s[60:63], s27 offen offset:2048 sc1
    buffer_load_dwordx4 a[92:95], v252, s[60:63], s27 offen offset:3072 sc1
    s_add_u32 s27, s27, 4096
Lw_44:
    v_add_f32_dpp v136, v134, v88 wave_shr:1 row_mask:0xf bank_mask:0xf
    v_mfma_f32_16x16x32_bf16 v[120:123], v[176:179], v[60:63], v[120:123]
    v_add_f32_dpp v133, v91, v94 wave_ror:1 row_mask:0xf bank_mask:0xf
    v_mfma_f32_16x16x32_bf16 v[128:131], v[176:179], v[192:195], v[128:131]
    v_add_f32_dpp v135, v132, v93 wave_ror:1 row_mask:0xf bank_mask:0xf
    s_waitcnt lgkmcnt(1)
    v_mfma_f32_16x16x32_bf16 v[100:103], v[164:167], v[48:51], v[100:103]
    ds_read2_b64 v[172:175], v2 offset0:164 offset1:160
    v_add_f32_dpp v137, v134, v92 wave_ror:1 row_mask:0xf bank_mask:0xf
    v_mfma_f32_16x16x32_bf16 v[108:111], v[164:167], v[52:55], v[108:111]
    v_add_f32_dpp v133, v95, v94 wave_shr:1 row_mask:0xf bank_mask:0xf
    v_mfma_f32_16x16x32_bf16 v[116:119], v[164:167], v[56:59], v[116:119]
    s_nop 0
    v_add_f32_dpp v135, v133, v93 wave_shr:1 row_mask:0xf bank_mask:0xf
    v_mfma_f32_16x16x32_bf16 v[124:127], v[164:167], v[60:63], v[124:127]
    s_nop 0
    v_add_f32_dpp v137, v135, v92 wave_shr:1 row_mask:0xf bank_mask:0xf
    s_waitcnt lgkmcnt(1)
    v_mfma_f32_16x16x32_bf16 v[96:99], v[168:171], v[44:47], v[96:99]
    ds_read2_b64 v[176:179], v2 offset0:180 offset1:176
    v_cvt_pk_bf16_f32 v143, v136, v137
    v_mfma_f32_16x16x32_bf16 v[104:107], v[168:171], v[48:51], v[104:107]
    s_add_u32 s6, s13, 0
    v_mfma_f32_16x16x32_bf16 v[112:115], v[168:171], v[52:55], v[112:115]
    buffer_store_dwordx4 v[140:143], v5, s[60:63], s6 offen sc1
    v_mfma_f32_16x16x32_bf16 v[120:123], v[168:171], v[56:59], v[120:123]
    s_cbranch_vccz Lw_45
    buffer_load_dwordx4 a[96:99], v252, s[60:63], s27 offen offset:0 sc1
    buffer_load_dwordx4 a[100:103], v252, s[60:63], s27 offen offset:1024 sc1
    buffer_load_dwordx4 a[104:107], v252, s[60:63], s27 offen offset:2048 sc1
    buffer_load_dwordx4 a[108:111], v252, s[60:63], s27 offen offset:3072 sc1
    s_add_u32 s27, s27, 4096
Lw_45:
    v_mfma_f32_16x16x32_bf16 v[128:131], v[168:171], v[60:63], v[128:131]
    s_waitcnt lgkmcnt(1)
    v_mfma_f32_16x16x32_bf16 v[100:103], v[172:175], v[44:47], v[100:103]
    ds_read2_b64 v[164:167], v2 offset0:196 offset1:192
    v_mfma_f32_16x16x32_bf16 v[108:111], v[172:175], v[48:51], v[108:111]
    v_mfma_f32_16x16x32_bf16 v[116:119], v[172:175], v[52:55], v[116:119]
    v_mfma_f32_16x16x32_bf16 v[124:127], v[172:175], v[56:59], v[124:127]
    s_waitcnt lgkmcnt(1)
    v_mfma_f32_16x16x32_bf16 v[96:99], v[176:179], v[40:43], v[96:99]
    ds_read2_b64 v[168:171], v2 offset0:212 offset1:208
    v_mfma_f32_16x16x32_bf16 v[104:107], v[176:179], v[44:47], v[104:107]
    v_mfma_f32_16x16x32_bf16 v[112:115], v[176:179], v[48:51], v[112:115]
    v_mfma_f32_16x16x32_bf16 v[120:123], v[176:179], v[52:55], v[120:123]
    v_mfma_f32_16x16x32_bf16 v[128:131], v[176:179], v[56:59], v[128:131]
    s_cbranch_vccz Lw_46
    buffer_load_dwordx4 a[112:115], v252, s[60:63], s27 offen offset:0 sc1
    buffer_load_dwordx4 a[116:119], v252, s[60:63], s27 offen offset:1024 sc1
    buffer_load_dwordx4 a[120:123], v252, s[60:63], s27 offen offset:2048 sc1
    buffer_load_dwordx4 a[124:127], v252, s[60:63], s27 offen offset:3072 sc1
    s_add_u32 s27, s27, 4096
Lw_46:
    s_waitcnt lgkmcnt(1)
    v_mfma_f32_16x16x32_bf16 v[100:103], v[164:167], v[40:43], v[100:103]
    ds_read2_b64 v[172:175], v2 offset0:228 offset1:224
    v_mfma_f32_16x16x32_bf16 v[108:111], v[164:167], v[44:47], v[108:111]
    v_mfma_f32_16x16x32_bf16 v[116:119], v[164:167], v[48:51], v[116:119]
    v_mfma_f32_16x16x32_bf16 v[124:127], v[164:167], v[52:55], v[124:127]
    s_waitcnt lgkmcnt(1)
    v_mfma_f32_16x16x32_bf16 v[96:99], v[168:171], v[36:39], v[96:99]
    ds_read2_b64 v[176:179], v2 offset0:244 offset1:240
    v_mfma_f32_16x16x32_bf16 v[104:107], v[168:171], v[40:43], v[104:107]
    v_mfma_f32_16x16x32_bf16 v[112:115], v[168:171], v[44:47], v[112:115]
    v_mfma_f32_16x16x32_bf16 v[120:123], v[168:171], v[48:51], v[120:123]
    v_mfma_f32_16x16x32_bf16 v[128:131], v[168:171], v[52:55], v[128:131]
    s_waitcnt lgkmcnt(1)
    v_mfma_f32_16x16x32_bf16 v[100:103], v[172:175], v[36:39], v[100:103]
    ds_read2_b64 v[164:167], v3 offset0:4 offset1:0
    s_cbranch_vccz Lw_47
    buffer_load_dwordx4 a[128:131], v252, s[60:63], s27 offen offset:0 sc1
    buffer_load_dwordx4 a[132:135], v252, s[60:63], s27 offen offset:1024 sc1
    buffer_load_dwordx4 a[136:139], v252, s[60:63], s27 offen offset:2048 sc1
    buffer_load_dwordx4 a[140:143], v252, s[60:63], s27 offen offset:3072 sc1
    s_add_u32 s27, s27, 4096
Lw_47:
    v_mfma_f32_16x16x32_bf16 v[108:111], v[172:175], v[40:43], v[108:111]
    v_mfma_f32_16x16x32_bf16 v[116:119], v[172:175], v[44:47], v[116:119]
    v_mfma_f32_16x16x32_bf16 v[124:127], v[172:175], v[48:51], v[124:127]
    s_waitcnt lgkmcnt(1)
    v_mfma_f32_16x16x32_bf16 v[96:99], v[176:179], v[32:35], v[96:99]
    ds_read2_b64 v[168:171], v3 offset0:20 offset1:16
    v_mfma_f32_16x16x32_bf16 v[104:107], v[176:179], v[36:39], v[104:107]
    v_mfma_f32_16x16x32_bf16 v[112:115], v[176:179], v[40:43], v[112:115]
    v_mfma_f32_16x16x32_bf16 v[120:123], v[176:179], v[44:47], v[120:123]
    v_mfma_f32_16x16x32_bf16 v[128:131], v[176:179], v[48:51], v[128:131]
    s_waitcnt lgkmcnt(1)
    v_mfma_f32_16x16x32_bf16 v[100:103], v[164:167], v[32:35], v[100:103]
    ds_read2_b64 v[172:175], v3 offset0:36 offset1:32
    v_mfma_f32_16x16x32_bf16 v[108:111], v[164:167], v[36:39], v[108:111]
    s_cbranch_vccz Lw_48
    buffer_load_dwordx4 a[144:147], v252, s[60:63], s27 offen offset:0 sc1
    buffer_load_dwordx4 a[148:151], v252, s[60:63], s27 offen offset:1024 sc1
    buffer_load_dwordx4 a[152:155], v252, s[60:63], s27 offen offset:2048 sc1
    buffer_load_dwordx4 a[156:159], v252, s[60:63], s27 offen offset:3072 sc1
    s_add_u32 s27, s27, 4096
Lw_48:
    v_mfma_f32_16x16x32_bf16 v[116:119], v[164:167], v[40:43], v[116:119]
    v_mfma_f32_16x16x32_bf16 v[124:127], v[164:167], v[44:47], v[124:127]
    s_waitcnt lgkmcnt(1)
    v_mfma_f32_16x16x32_bf16 v[96:99], v[168:171], v[28:31], v[96:99]
    ds_read2_b64 v[176:179], v3 offset0:52 offset1:48
    v_mfma_f32_16x16x32_bf16 v[104:107], v[168:171], v[32:35], v[104:107]
    v_mfma_f32_16x16x32_bf16 v[112:115], v[168:171], v[36:39], v[112:115]
    v_mfma_f32_16x16x32_bf16 v[120:123], v[168:171], v[40:43], v[120:123]
    v_mfma_f32_16x16x32_bf16 v[128:131], v[168:171], v[44:47], v[128:131]
    s_waitcnt lgkmcnt(1)
    v_mfma_f32_16x16x32_bf16 v[100:103], v[172:175], v[28:31], v[100:103]
    ds_read2_b64 v[164:167], v3 offset0:68 offset1:64
    v_mfma_f32_16x16x32_bf16 v[108:111], v[172:175], v[32:35], v[108:111]
    v_mfma_f32_16x16x32_bf16 v[116:119], v[172:175], v[36:39], v[116:119]
    v_mfma_f32_16x16x32_bf16 v[124:127], v[172:175], v[40:43], v[124:127]
    s_waitcnt lgkmcnt(1)
    v_mfma_f32_16x16x32_bf16 v[96:99], v[176:179], v[24:27], v[96:99]
    ds_read2_b64 v[168:171], v3 offset0:84 offset1:80
    ds_read_b64_tr_b16 v[204:205], v4 offset:21248
    v_mfma_f32_16x16x32_bf16 v[104:107], v[176:179], v[28:31], v[104:107]
    ds_read_b64_tr_b16 v[206:207], v4 offset:21280
    v_mfma_f32_16x16x32_bf16 v[112:115], v[176:179], v[32:35], v[112:115]
    ds_read_b64_tr_b16 v[200:201], v4 offset:20992
    v_mfma_f32_16x16x32_bf16 v[120:123], v[176:179], v[36:39], v[120:123]
    ds_read_b64_tr_b16 v[202:203], v4 offset:21024
    v_mfma_f32_16x16x32_bf16 v[128:131], v[176:179], v[40:43], v[128:131]
    s_waitcnt lgkmcnt(5)
    v_mfma_f32_16x16x32_bf16 v[100:103], v[164:167], v[24:27], v[100:103]
    ds_read2_b64 v[172:175], v3 offset0:100 offset1:96
    ds_read_b64_tr_b16 v[196:197], v4 offset:20736
    v_mfma_f32_16x16x32_bf16 v[108:111], v[164:167], v[28:31], v[108:111]
    ds_read_b64_tr_b16 v[198:199], v4 offset:20768
    v_mfma_f32_16x16x32_bf16 v[116:119], v[164:167], v[32:35], v[116:119]
    ds_read_b64_tr_b16 v[192:193], v4 offset:20480
    v_mfma_f32_16x16x32_bf16 v[124:127], v[164:167], v[36:39], v[124:127]
    ds_read_b64_tr_b16 v[194:195], v4 offset:20512
    s_waitcnt lgkmcnt(9)
    v_mfma_f32_16x16x32_bf16 v[96:99], v[168:171], v[20:23], v[96:99]
    ds_read2_b64 v[176:179], v3 offset0:116 offset1:112
    ds_read_b64_tr_b16 v[60:61], v4 offset:20224
    v_mfma_f32_16x16x32_bf16 v[104:107], v[168:171], v[24:27], v[104:107]
    v_mfma_f32_16x16x32_bf16 v[112:115], v[168:171], v[28:31], v[112:115]
    ds_read_b64_tr_b16 v[62:63], v4 offset:20256
    v_mfma_f32_16x16x32_bf16 v[120:123], v[168:171], v[32:35], v[120:123]
    ds_read_b64_tr_b16 v[56:57], v4 offset:19968
    s_cmp_lg_u32 s5, 0
    s_cbranch_scc1 Lz_49
    v_mov_b32 v253, 0
    s_mov_b64 exec, 1
    buffer_atomic_add v253, v255, s[60:63], s9 offen sc0 sc1
    s_mov_b64 exec, -1
Lz_49:
    s_nop 0
    v_mfma_f32_16x16x32_bf16 v[128:131], v[168:171], v[36:39], v[128:131]
    ds_read_b64_tr_b16 v[58:59], v4 offset:20000
    s_waitcnt lgkmcnt(9)
    v_mfma_f32_16x16x32_bf16 v[100:103], v[172:175], v[20:23], v[100:103]
    ds_read2_b64 v[164:167], v3 offset0:132 offset1:128
    ds_read_b64_tr_b16 v[52:53], v4 offset:19712
    v_mfma_f32_16x16x32_bf16 v[108:111], v[172:175], v[24:27], v[108:111]
    ds_read_b64_tr_b16 v[54:55], v4 offset:19744
    v_mfma_f32_16x16x32_bf16 v[116:119], v[172:175], v[28:31], v[116:119]
    v_mfma_f32_16x16x32_bf16 v[124:127], v[172:175], v[32:35], v[124:127]
    ds_read_b64_tr_b16 v[48:49], v4 offset:19456
    s_waitcnt lgkmcnt(8)
    v_mfma_f32_16x16x32_bf16 v[96:99], v[176:179], v[16:19], v[96:99]
    ds_read2_b64 v[168:171], v3 offset0:148 offset1:144
    ds_read_b64_tr_b16 v[50:51], v4 offset:19488
    v_mfma_f32_16x16x32_bf16 v[104:107], v[176:179], v[20:23], v[104:107]
    ds_read_b64_tr_b16 v[44:45], v4 offset:19200
    v_mfma_f32_16x16x32_bf16 v[112:115], v[176:179], v[24:27], v[112:115]
    ds_read_b64_tr_b16 v[46:47], v4 offset:19232
    v_mfma_f32_16x16x32_bf16 v[120:123], v[176:179], v[28:31], v[120:123]
    ds_read_b64_tr_b16 v[40:41], v4 offset:18944
    v_add_f32_dpp v133, v99, v98 wave_shr:1 row_mask:0xf bank_mask:0xf bound_ctrl:0
    v_mfma_f32_16x16x32_bf16 v[128:131], v[176:179], v[32:35], v[128:131]
    s_nop 0
    v_add_f32_dpp v135, v133, v97 wave_shr:1 row_mask:0xf bank_mask:0xf bound_ctrl:0
    s_waitcnt lgkmcnt(8)
    v_mfma_f32_16x16x32_bf16 v[100:103], v[164:167], v[16:19], v[100:103]
    ds_read2_b64 v[172:175], v3 offset0:164 offset1:160
    ds_read_b64_tr_b16 v[42:43], v4 offset:18976
    v_mfma_f32_16x16x32_bf16 v[108:111], v[164:167], v[20:23], v[108:111]
    ds_read_b64_tr_b16 v[36:37], v4 offset:18688
    v_mfma_f32_16x16x32_bf16 v[116:119], v[164:167], v[24:27], v[116:119]
    ds_read_b64_tr_b16 v[38:39], v4 offset:18720
    v_mfma_f32_16x16x32_bf16 v[124:127], v[164:167], v[28:31], v[124:127]
    ds_read_b64_tr_b16 v[32:33], v4 offset:18432
    v_add_f32_dpp v132, v99, v102 wave_ror:1 row_mask:0xf bank_mask:0xf
    s_waitcnt lgkmcnt(9)
    v_mfma_f32_16x16x32_bf16 v[104:107], v[168:171], v[16:19], v[104:107]
    ds_read2_b64 v[176:179], v3 offset0:180 offset1:176
    ds_read_b64_tr_b16 v[34:35], v4 offset:18464
    v_add_f32_dpp v134, v133, v101 wave_ror:1 row_mask:0xf bank_mask:0xf
    v_mfma_f32_16x16x32_bf16 v[112:115], v[168:171], v[20:23], v[112:115]
    v_add_f32_dpp v136, v135, v100 wave_ror:1 row_mask:0xf bank_mask:0xf
    v_mfma_f32_16x16x32_bf16 v[120:123], v[168:171], v[24:27], v[120:123]
    v_add_f32_dpp v132, v103, v102 wave_shr:1 row_mask:0xf bank_mask:0xf
    v_mfma_f32_16x16x32_bf16 v[128:131], v[168:171], v[28:31], v[128:131]
    ds_read_b64_tr_b16 v[28:29], v4 offset:18176
    v_add_f32_dpp v134, v132, v101 wave_shr:1 row_mask:0xf bank_mask:0xf
    s_waitcnt lgkmcnt(7)
    v_mfma_f32_16x16x32_bf16 v[108:111], v[172:175], v[16:19], v[108:111]
    ds_read2_b64 v[164:167], v3 offset0:196 offset1:192
    v_add_f32_dpp v136, v134, v100 wave_shr:1 row_mask:0xf bank_mask:0xf
    v_add_f32_dpp v133, v103, v106 wave_ror:1 row_mask:0xf bank_mask:0xf
    v_mfma_f32_16x16x32_bf16 v[116:119], v[172:175], v[20:23], v[116:119]
    ds_read_b64_tr_b16 v[30:31], v4 offset:18208
    v_add_f32_dpp v135, v132, v105 wave_ror:1 row_mask:0xf bank_mask:0xf
    v_add_f32_dpp v137, v134, v104 wave_ror:1 row_mask:0xf bank_mask:0xf
    v_mfma_f32_16x16x32_bf16 v[124:127], v[172:175], v[24:27], v[124:127]
    v_add_f32_dpp v133, v107, v106 wave_shr:1 row_mask:0xf bank_mask:0xf
    s_nop 1
    v_add_f32_dpp v135, v133, v105 wave_shr:1 row_mask:0xf bank_mask:0xf
    s_waitcnt lgkmcnt(4)
    v_mfma_f32_16x16x32_bf16 v[112:115], v[176:179], v[16:19], v[112:115]
    ds_read2_b64 v[168:171], v3 offset0:212 offset1:208
    v_add_f32_dpp v137, v135, v104 wave_shr:1 row_mask:0xf bank_mask:0xf
    v_cvt_pk_bf16_f32 v144, v136, v137
    v_mfma_f32_16x16x32_bf16 v[120:123], v[176:179], v[20:23], v[120:123]
    v_add_f32_dpp v132, v107, v110 wave_ror:1 row_mask:0xf bank_mask:0xf
    v_add_f32_dpp v134, v133, v109 wave_ror:1 row_mask:0xf bank_mask:0xf
    v_mfma_f32_16x16x32_bf16 v[128:131], v[176:179], v[24:27], v[128:131]
    ds_read_b64_tr_b16 v[24:25], v4 offset:17920
    v_add_f32_dpp v136, v135, v108 wave_ror:1 row_mask:0xf bank_mask:0xf
    v_add_f32_dpp v132, v111, v110 wave_shr:1 row_mask:0xf bank_mask:0xf
    s_waitcnt lgkmcnt(3)
    v_mfma_f32_16x16x32_bf16 v[116:119], v[164:167], v[16:19], v[116:119]
    ds_read2_b64 v[172:175], v3 offset0:228 offset1:224
    v_add_f32_dpp v134, v132, v109 wave_shr:1 row_mask:0xf bank_mask:0xf
    s_nop 1
    v_add_f32_dpp v136, v134, v108 wave_shr:1 row_mask:0xf bank_mask:0xf
    v_mfma_f32_16x16x32_bf16 v[124:127], v[164:167], v[20:23], v[124:127]
    ds_read_b64_tr_b16 v[26:27], v4 offset:17952
    v_add_u32 v6, 17408, v2
    ds_read2_b64 v[164:167], v6 offset0:4 offset1:0
    v_add_f32_dpp v133, v111, v114 wave_ror:1 row_mask:0xf bank_mask:0xf
    v_add_f32_dpp v135, v132, v113 wave_ror:1 row_mask:0xf bank_mask:0xf
    s_waitcnt lgkmcnt(4)
    v_mfma_f32_16x16x32_bf16 v[120:123], v[168:171], v[16:19], v[120:123]
    ds_read2_b64 v[176:179], v3 offset0:244 offset1:240
    v_add_f32_dpp v137, v134, v112 wave_ror:1 row_mask:0xf bank_mask:0xf
    v_add_f32_dpp v133, v115, v114 wave_shr:1 row_mask:0xf bank_mask:0xf
    v_mfma_f32_16x16x32_bf16 v[128:131], v[168:171], v[20:23], v[128:131]
    ds_read2_b64 v[168:171], v6 offset0:20 offset1:16
    ds_read_b64_tr_b16 v[20:21], v4 offset:17664
    v_add_f32_dpp v135, v133, v113 wave_shr:1 row_mask:0xf bank_mask:0xf
    s_nop 1
    v_add_f32_dpp v137, v135, v112 wave_shr:1 row_mask:0xf bank_mask:0xf
    s_waitcnt lgkmcnt(5)
    v_mfma_f32_16x16x32_bf16 v[124:127], v[172:175], v[16:19], v[124:127]
    v_cvt_pk_bf16_f32 v145, v136, v137
    v_add_f32_dpp v132, v115, v118 wave_ror:1 row_mask:0xf bank_mask:0xf
    s_waitcnt lgkmcnt(2)
    v_mfma_f32_16x16x32_bf16 v[128:131], v[176:179], v[16:19], v[128:131]
    ds_read_b64_tr_b16 v[22:23], v4 offset:17696
    ds_read_b64_tr_b16 v[16:17], v4 offset:17408
    ds_read_b64_tr_b16 v[18:19], v4 offset:17440
    v_add_f32_dpp v134, v133, v117 wave_ror:1 row_mask:0xf bank_mask:0xf
    v_add_f32_dpp v136, v135, v116 wave_ror:1 row_mask:0xf bank_mask:0xf
    v_add_f32_dpp v132, v119, v118 wave_shr:1 row_mask:0xf bank_mask:0xf
    s_nop 1
    v_add_f32_dpp v134, v132, v117 wave_shr:1 row_mask:0xf bank_mask:0xf
    s_nop 1
    v_add_f32_dpp v136, v134, v116 wave_shr:1 row_mask:0xf bank_mask:0xf
    v_add_f32_dpp v133, v119, v122 wave_ror:1 row_mask:0xf bank_mask:0xf
    v_add_f32_dpp v135, v132, v121 wave_ror:1 row_mask:0xf bank_mask:0xf
    v_add_f32_dpp v137, v134, v120 wave_ror:1 row_mask:0xf bank_mask:0xf
    v_add_f32_dpp v133, v123, v122 wave_shr:1 row_mask:0xf bank_mask:0xf
    s_nop 1
    v_add_f32_dpp v135, v133, v121 wave_shr:1 row_mask:0xf bank_mask:0xf
    s_nop 1
    v_add_f32_dpp v137, v135, v120 wave_shr:1 row_mask:0xf bank_mask:0xf
    v_cvt_pk_bf16_f32 v146, v136, v137
    v_add_f32_dpp v132, v123, v126 wave_ror:1 row_mask:0xf bank_mask:0xf
    v_add_f32_dpp v134, v133, v125 wave_ror:1 row_mask:0xf bank_mask:0xf
    v_add_f32_dpp v136, v135, v124 wave_ror:1 row_mask:0xf bank_mask:0xf
    v_add_f32_dpp v132, v127, v126 wave_shr:1 row_mask:0xf bank_mask:0xf
    s_nop 1
    v_add_f32_dpp v134, v132, v125 wave_shr:1 row_mask:0xf bank_mask:0xf
    s_nop 1
    v_add_f32_dpp v136, v134, v124 wave_shr:1 row_mask:0xf bank_mask:0xf
    v_add_f32_dpp v133, v127, v130 wave_ror:1 row_mask:0xf bank_mask:0xf
    v_add_f32_dpp v135, v132, v129 wave_ror:1 row_mask:0xf bank_mask:0xf
    v_add_f32_dpp v137, v134, v128 wave_ror:1 row_mask:0xf bank_mask:0xf
    v_add_f32_dpp v133, v131, v130 wave_shr:1 row_mask:0xf bank_mask:0xf
    s_nop 1
    v_add_f32_dpp v135, v133, v129 wave_shr:1 row_mask:0xf bank_mask:0xf
    s_nop 1
    v_add_f32_dpp v137, v135, v128 wave_shr:1 row_mask:0xf bank_mask:0xf
    v_cvt_pk_bf16_f32 v147, v136, v137
    s_add_u32 s6, s13, 1966080
    buffer_store_dwordx4 v[144:147], v5, s[60:63], s6 offen sc1
    s_branch LconvE_38
LconvB_37:
    v_mfma_f32_16x16x32_bf16 v[68:71], v[164:167], v[32:35], 0
    ds_read2_b64 v[172:175], v2 offset0:36 offset1:32
    v_mfma_f32_16x16x32_bf16 v[76:79], v[164:167], v[36:39], 0
    v_mfma_f32_16x16x32_bf16 v[84:87], v[164:167], v[40:43], 0
    v_mfma_f32_16x16x32_bf16 v[92:95], v[164:167], v[44:47], 0
    s_cbranch_vccz Lw_50
    buffer_load_dwordx4 a[0:3], v252, s[60:63], s27 offen offset:0 sc1
    buffer_load_dwordx4 a[4:7], v252, s[60:63], s27 offen offset:1024 sc1
    buffer_load_dwordx4 a[8:11], v252, s[60:63], s27 offen offset:2048 sc1
    buffer_load_dwordx4 a[12:15], v252, s[60:63], s27 offen offset:3072 sc1
    s_add_u32 s27, s27, 4096
Lw_50:
    v_mfma_f32_16x16x32_bf16 v[100:103], v[164:167], v[48:51], 0
    v_mfma_f32_16x16x32_bf16 v[108:111], v[164:167], v[52:55], 0
    v_mfma_f32_16x16x32_bf16 v[116:119], v[164:167], v[56:59], 0
    v_mfma_f32_16x16x32_bf16 v[124:127], v[164:167], v[60:63], 0
    v_mfma_f32_16x16x32_bf16 v[64:67], v[168:171], v[28:31], 0
    ds_read2_b64 v[176:179], v2 offset0:52 offset1:48
    v_mfma_f32_16x16x32_bf16 v[72:75], v[168:171], v[32:35], 0
    v_mfma_f32_16x16x32_bf16 v[80:83], v[168:171], v[36:39], 0
    v_mfma_f32_16x16x32_bf16 v[88:91], v[168:171], v[40:43], 0
    v_mfma_f32_16x16x32_bf16 v[96:99], v[168:171], v[44:47], 0
    v_mfma_f32_16x16x32_bf16 v[104:107], v[168:171], v[48:51], 0
    s_cbranch_vccz Lw_51
    buffer_load_dwordx4 a[16:19], v252, s[60:63], s27 offen offset:0 sc1
    buffer_load_dwordx4 a[20:23], v252, s[60:63], s27 offen offset:1024 sc1
    buffer_load_dwordx4 a[24:27], v252, s[60:63], s27 offen offset:2048 sc1
    buffer_load_dwordx4 a[28:31], v252, s[60:63], s27 offen offset:3072 sc1
    s_add_u32 s27, s27, 4096
Lw_51:
    v_mfma_f32_16x16x32_bf16 v[112:115], v[168:171], v[52:55], 0
    v_mfma_f32_16x16x32_bf16 v[120:123], v[168:171], v[56:59], 0
    v_mfma_f32_16x16x32_bf16 v[128:131], v[168:171], v[60:63], 0
    s_waitcnt lgkmcnt(1)
    v_mfma_f32_16x16x32_bf16 v[68:71], v[172:175], v[28:31], v[68:71]
    ds_read2_b64 v[164:167], v2 offset0:68 offset1:64
    v_mfma_f32_16x16x32_bf16 v[76:79], v[172:175], v[32:35], v[76:79]
    v_mfma_f32_16x16x32_bf16 v[84:87], v[172:175], v[36:39], v[84:87]
    v_mfma_f32_16x16x32_bf16 v[92:95], v[172:175], v[40:43], v[92:95]
    v_mfma_f32_16x16x32_bf16 v[100:103], v[172:175], v[44:47], v[100:103]
    v_mfma_f32_16x16x32_bf16 v[108:111], v[172:175], v[48:51], v[108:111]
    s_cbranch_vccz Lw_52
    buffer_load_dwordx4 a[32:35], v252, s[60:63], s27 offen offset:0 sc1
    buffer_load_dwordx4 a[36:39], v252, s[60:63], s27 offen offset:1024 sc1
    buffer_load_dwordx4 a[40:43], v252, s[60:63], s27 offen offset:2048 sc1
    buffer_load_dwordx4 a[44:47], v252, s[60:63], s27 offen offset:3072 sc1
    s_add_u32 s27, s27, 4096
Lw_52:
    v_mfma_f32_16x16x32_bf16 v[116:119], v[172:175], v[52:55], v[116:119]
    v_mfma_f32_16x16x32_bf16 v[124:127], v[172:175], v[56:59], v[124:127]
    s_waitcnt lgkmcnt(1)
    v_mfma_f32_16x16x32_bf16 v[64:67], v[176:179], v[24:27], v[64:67]
    ds_read2_b64 v[168:171], v2 offset0:84 offset1:80
    v_mfma_f32_16x16x32_bf16 v[72:75], v[176:179], v[28:31], v[72:75]
    v_mfma_f32_16x16x32_bf16 v[80:83], v[176:179], v[32:35], v[80:83]
    v_mfma_f32_16x16x32_bf16 v[88:91], v[176:179], v[36:39], v[88:91]
    v_mfma_f32_16x16x32_bf16 v[96:99], v[176:179], v[40:43], v[96:99]
    v_mfma_f32_16x16x32_bf16 v[104:107], v[176:179], v[44:47], v[104:107]
    v_mfma_f32_16x16x32_bf16 v[112:115], v[176:179], v[48:51], v[112:115]
    s_cbranch_vccz Lw_53
    buffer_load_dwordx4 a[48:51], v252, s[60:63], s27 offen offset:0 sc1
    buffer_load_dwordx4 a[52:55], v252, s[60:63], s27 offen offset:1024 sc1
    buffer_load_dwordx4 a[56:59], v252, s[60:63], s27 offen offset:2048 sc1
    buffer_load_dwordx4 a[60:63], v252, s[60:63], s27 offen offset:3072 sc1
    s_add_u32 s27, s27, 4096
Lw_53:
    v_mfma_f32_16x16x32_bf16 v[120:123], v[176:179], v[52:55], v[120:123]
    v_mfma_f32_16x16x32_bf16 v[128:131], v[176:179], v[56:59], v[128:131]
    s_waitcnt lgkmcnt(1)
    v_mfma_f32_16x16x32_bf16 v[68:71], v[164:167], v[24:27], v[68:71]
    ds_read2_b64 v[172:175], v2 offset0:100 offset1:96
    v_mfma_f32_16x16x32_bf16 v[76:79], v[164:167], v[28:31], v[76:79]
    v_mfma_f32_16x16x32_bf16 v[84:87], v[164:167], v[32:35], v[84:87]
    v_mfma_f32_16x16x32_bf16 v[92:95], v[164:167], v[36:39], v[92:95]
    v_mfma_f32_16x16x32_bf16 v[100:103], v[164:167], v[40:43], v[100:103]
    v_mfma_f32_16x16x32_bf16 v[108:111], v[164:167], v[44:47], v[108:111]
    v_mfma_f32_16x16x32_bf16 v[116:119], v[164:167], v[48:51], v[116:119]
    s_cbranch_vccz Lw_54
    buffer_load_dwordx4 a[64:67], v252, s[60:63], s27 offen offset:0 sc1
    buffer_load_dwordx4 a[68:71], v252, s[60:63], s27 offen offset:1024 sc1
    buffer_load_dwordx4 a[72:75], v252, s[60:63], s27 offen offset:2048 sc1
    buffer_load_dwordx4 a[76:79], v252, s[60:63], s27 offen offset:3072 sc1
    s_add_u32 s27, s27, 4096
Lw_54:
    v_mfma_f32_16x16x32_bf16 v[124:127], v[164:167], v[52:55], v[124:127]
    s_waitcnt lgkmcnt(1)
    v_mfma_f32_16x16x32_bf16 v[64:67], v[168:171], v[20:23], v[64:67]
    ds_read2_b64 v[176:179], v2 offset0:116 offset1:112
    v_mfma_f32_16x16x32_bf16 v[72:75], v[168:171], v[24:27], v[72:75]
    v_mfma_f32_16x16x32_bf16 v[80:83], v[168:171], v[28:31], v[80:83]
    v_mfma_f32_16x16x32_bf16 v[88:91], v[168:171], v[32:35], v[88:91]
    v_mfma_f32_16x16x32_bf16 v[96:99], v[168:171], v[36:39], v[96:99]
    v_mfma_f32_16x16x32_bf16 v[104:107], v[168:171], v[40:43], v[104:107]
    v_mfma_f32_16x16x32_bf16 v[112:115], v[168:171], v[44:47], v[112:115]
    v_mfma_f32_16x16x32_bf16 v[120:123], v[168:171], v[48:51], v[120:123]
    s_cbranch_vccz Lw_55
    s_cmp_eq_u32 s68, 4
    s_cselect_b32 s27, s74, s27
    buffer_load_dwordx4 a[80:83], v252, s[60:63], s27 offen offset:0 sc1
    buffer_load_dwordx4 a[84:87], v252, s[60:63], s27 offen offset:1024 sc1
    buffer_load_dwordx4 a[88:91], v252, s[60:63], s27 offen offset:2048 sc1
    buffer_load_dwordx4 a[92:95], v252, s[60:63], s27 offen offset:3072 sc1
    s_add_u32 s27, s27, 4096
Lw_55:
    v_mfma_f32_16x16x32_bf16 v[128:131], v[168:171], v[52:55], v[128:131]
    s_waitcnt lgkmcnt(1)
    v_mfma_f32_16x16x32_bf16 v[68:71], v[172:175], v[20:23], v[68:71]
    ds_read2_b64 v[164:167], v2 offset0:132 offset1:128
    v_mfma_f32_16x16x32_bf16 v[76:79], v[172:175], v[24:27], v[76:79]
    v_mfma_f32_16x16x32_bf16 v[84:87], v[172:175], v[28:31], v[84:87]
    v_mfma_f32_16x16x32_bf16 v[92:95], v[172:175], v[32:35], v[92:95]
    v_mfma_f32_16x16x32_bf16 v[100:103], v[172:175], v[36:39], v[100:103]
    v_mfma_f32_16x16x32_bf16 v[108:111], v[172:175], v[40:43], v[108:111]
    v_mfma_f32_16x16x32_bf16 v[116:119], v[172:175], v[44:47], v[116:119]
    v_mfma_f32_16x16x32_bf16 v[124:127], v[172:175], v[48:51], v[124:127]
    s_waitcnt lgkmcnt(1)
    v_mfma_f32_16x16x32_bf16 v[64:67], v[176:179], v[16:19], v[64:67]
    ds_read2_b64 v[168:171], v2 offset0:148 offset1:144
    s_cbranch_vccz Lw_56
    buffer_load_dwordx4 a[96:99], v252, s[60:63], s27 offen offset:0 sc1
    buffer_load_dwordx4 a[100:103], v252, s[60:63], s27 offen offset:1024 sc1
    buffer_load_dwordx4 a[104:107], v252, s[60:63], s27 offen offset:2048 sc1
    buffer_load_dwordx4 a[108:111], v252, s[60:63], s27 offen offset:3072 sc1
    s_add_u32 s27, s27, 4096
Lw_56:
    v_mfma_f32_16x16x32_bf16 v[72:75], v[176:179], v[20:23], v[72:75]
    v_mfma_f32_16x16x32_bf16 v[80:83], v[176:179], v[24:27], v[80:83]
    v_mfma_f32_16x16x32_bf16 v[88:91], v[176:179], v[28:31], v[88:91]
    v_add_f32_dpp v133, v67, v66 wave_shr:1 row_mask:0xf bank_mask:0xf bound_ctrl:0
    v_mfma_f32_16x16x32_bf16 v[96:99], v[176:179], v[32:35], v[96:99]
    s_nop 0
    v_add_f32_dpp v135, v133, v65 wave_shr:1 row_mask:0xf bank_mask:0xf bound_ctrl:0
    v_mfma_f32_16x16x32_bf16 v[104:107], v[176:179], v[36:39], v[104:107]
    v_mfma_f32_16x16x32_bf16 v[112:115], v[176:179], v[40:43], v[112:115]
    v_mfma_f32_16x16x32_bf16 v[120:123], v[176:179], v[44:47], v[120:123]
    v_mfma_f32_16x16x32_bf16 v[128:131], v[176:179], v[48:51], v[128:131]
    s_waitcnt lgkmcnt(1)
    v_mfma_f32_16x16x32_bf16 v[68:71], v[164:167], v[16:19], v[68:71]
    ds_read2_b64 v[172:175], v2 offset0:164 offset1:160
    s_cbranch_vccz Lw_57
    buffer_load_dwordx4 a[112:115], v252, s[60:63], s27 offen offset:0 sc1
    buffer_load_dwordx4 a[116:119], v252, s[60:63], s27 offen offset:1024 sc1
    buffer_load_dwordx4 a[120:123], v252, s[60:63], s27 offen offset:2048 sc1
    buffer_load_dwordx4 a[124:127], v252, s[60:63], s27 offen offset:3072 sc1
    s_add_u32 s27, s27, 4096
Lw_57:
    v_mfma_f32_16x16x32_bf16 v[76:79], v[164:167], v[20:23], v[76:79]
    v_mfma_f32_16x16x32_bf16 v[84:87], v[164:167], v[24:27], v[84:87]
    v_mfma_f32_16x16x32_bf16 v[92:95], v[164:167], v[28:31], v[92:95]
    v_add_f32_dpp v132, v67, v70 wave_ror:1 row_mask:0xf bank_mask:0xf
    v_mfma_f32_16x16x32_bf16 v[100:103], v[164:167], v[32:35], v[100:103]
    v_add_f32_dpp v134, v133, v69 wave_ror:1 row_mask:0xf bank_mask:0xf
    v_mfma_f32_16x16x32_bf16 v[108:111], v[164:167], v[36:39], v[108:111]
    v_add_f32_dpp v136, v135, v68 wave_ror:1 row_mask:0xf bank_mask:0xf
    v_mfma_f32_16x16x32_bf16 v[116:119], v[164:167], v[40:43], v[116:119]
    v_add_f32_dpp v132, v71, v70 wave_shr:1 row_mask:0xf bank_mask:0xf
    v_mfma_f32_16x16x32_bf16 v[124:127], v[164:167], v[44:47], v[124:127]
    s_nop 0
    v_add_f32_dpp v134, v132, v69 wave_shr:1 row_mask:0xf bank_mask:0xf
    s_waitcnt lgkmcnt(1)
    v_mfma_f32_16x16x32_bf16 v[72:75], v[168:171], v[16:19], v[72:75]
    ds_read2_b64 v[176:179], v2 offset0:180 offset1:176
    v_add_f32_dpp v136, v134, v68 wave_shr:1 row_mask:0xf bank_mask:0xf
    v_mfma_f32_16x16x32_bf16 v[80:83], v[168:171], v[20:23], v[80:83]
    s_cbranch_vccz Lw_58
    buffer_load_dwordx4 a[128:131], v252, s[60:63], s27 offen offset:0 sc1
    buffer_load_dwordx4 a[132:135], v252, s[60:63], s27 offen offset:1024 sc1
    buffer_load_dwordx4 a[136:139], v252, s[60:63], s27 offen offset:2048 sc1
    buffer_load_dwordx4 a[140:143], v252, s[60:63], s27 offen offset:3072 sc1
    s_add_u32 s27, s27, 4096
Lw_58:
    v_mfma_f32_16x16x32_bf16 v[88:91], v[168:171], v[24:27], v[88:91]
    v_mfma_f32_16x16x32_bf16 v[96:99], v[168:171], v[28:31], v[96:99]
    v_add_f32_dpp v133, v71, v74 wave_ror:1 row_mask:0xf bank_mask:0xf
    v_mfma_f32_16x16x32_bf16 v[104:107], v[168:171], v[32:35], v[104:107]
    v_add_f32_dpp v135, v132, v73 wave_ror:1 row_mask:0xf bank_mask:0xf
    v_mfma_f32_16x16x32_bf16 v[112:115], v[168:171], v[36:39], v[112:115]
    v_add_f32_dpp v137, v134, v72 wave_ror:1 row_mask:0xf bank_mask:0xf
    v_mfma_f32_16x16x32_bf16 v[120:123], v[168:171], v[40:43], v[120:123]
    v_add_f32_dpp v133, v75, v74 wave_shr:1 row_mask:0xf bank_mask:0xf
    v_mfma_f32_16x16x32_bf16 v[128:131], v[168:171], v[44:47], v[128:131]
    s_nop 0
    v_add_f32_dpp v135, v133, v73 wave_shr:1 row_mask:0xf bank_mask:0xf
    s_waitcnt lgkmcnt(1)
    v_mfma_f32_16x16x32_bf16 v[76:79], v[172:175], v[16:19], v[76:79]
    ds_read2_b64 v[164:167], v2 offset0:196 offset1:192
    v_add_f32_dpp v137, v135, v72 wave_shr:1 row_mask:0xf bank_mask:0xf
    v_mfma_f32_16x16x32_bf16 v[84:87], v[172:175], v[20:23], v[84:87]
    v_cvt_pk_bf16_f32 v144, v136, v137
    v_mfma_f32_16x16x32_bf16 v[92:95], v[172:175], v[24:27], v[92:95]
    s_cbranch_vccz Lw_59
    buffer_load_dwordx4 a[144:147], v252, s[60:63], s27 offen offset:0 sc1
    buffer_load_dwordx4 a[148:151], v252, s[60:63], s27 offen offset:1024 sc1
    buffer_load_dwordx4 a[152:155], v252, s[60:63], s27 offen offset:2048 sc1
    buffer_load_dwordx4 a[156:159], v252, s[60:63], s27 offen offset:3072 sc1
    s_add_u32 s27, s27, 4096
Lw_59:
    v_mfma_f32_16x16x32_bf16 v[100:103], v[172:175], v[28:31], v[100:103]
    v_add_f32_dpp v132, v75, v78 wave_ror:1 row_mask:0xf bank_mask:0xf
    v_mfma_f32_16x16x32_bf16 v[108:111], v[172:175], v[32:35], v[108:111]
    v_add_f32_dpp v134, v133, v77 wave_ror:1 row_mask:0xf bank_mask:0xf
    v_mfma_f32_16x16x32_bf16 v[116:119], v[172:175], v[36:39], v[116:119]
    v_add_f32_dpp v136, v135, v76 wave_ror:1 row_mask:0xf bank_mask:0xf
    v_mfma_f32_16x16x32_bf16 v[124:127], v[172:175], v[40:43], v[124:127]
    v_add_f32_dpp v132, v79, v78 wave_shr:1 row_mask:0xf bank_mask:0xf
    s_waitcnt lgkmcnt(1)
    v_mfma_f32_16x16x32_bf16 v[80:83], v[176:179], v[16:19], v[80:83]
    ds_read2_b64 v[168:171], v2 offset0:212 offset1:208
    v_add_f32_dpp v134, v132, v77 wave_shr:1 row_mask:0xf bank_mask:0xf
    v_mfma_f32_16x16x32_bf16 v[88:91], v[176:179], v[20:23], v[88:91]
    s_nop 0
    v_add_f32_dpp v136, v134, v76 wave_shr:1 row_mask:0xf bank_mask:0xf
    v_mfma_f32_16x16x32_bf16 v[96:99], v[176:179], v[24:27], v[96:99]
    v_mfma_f32_16x16x32_bf16 v[104:107], v[176:179], v[28:31], v[104:107]
    s_nop 0
    v_add_f32_dpp v133, v79, v82 wave_ror:1 row_mask:0xf bank_mask:0xf
    v_mfma_f32_16x16x32_bf16 v[112:115], v[176:179], v[32:35], v[112:115]
    v_add_f32_dpp v135, v132, v81 wave_ror:1 row_mask:0xf bank_mask:0xf
    v_mfma_f32_16x16x32_bf16 v[120:123], v[176:179], v[36:39], v[120:123]
    v_add_f32_dpp v137, v134, v80 wave_ror:1 row_mask:0xf bank_mask:0xf
    v_mfma_f32_16x16x32_bf16 v[128:131], v[176:179], v[40:43], v[128:131]
    ds_read_b64_tr_b16 v[204:205], v4 offset:21248
    v_add_f32_dpp v133, v83, v82 wave_shr:1 row_mask:0xf bank_mask:0xf
    s_waitcnt lgkmcnt(2)
    v_mfma_f32_16x16x32_bf16 v[84:87], v[164:167], v[16:19], v[84:87]
    ds_read2_b64 v[172:175], v2 offset0:228 offset1:224
    ds_read_b64_tr_b16 v[206:207], v4 offset:21280
    v_add_f32_dpp v135, v133, v81 wave_shr:1 row_mask:0xf bank_mask:0xf
    v_mfma_f32_16x16x32_bf16 v[92:95], v[164:167], v[20:23], v[92:95]
    ds_read_b64_tr_b16 v[200:201], v4 offset:20992
    v_add_f32_dpp v137, v135, v80 wave_shr:1 row_mask:0xf bank_mask:0xf
    v_mfma_f32_16x16x32_bf16 v[100:103], v[164:167], v[24:27], v[100:103]
    ds_read_b64_tr_b16 v[202:203], v4 offset:21024
    v_cvt_pk_bf16_f32 v145, v136, v137
    v_mfma_f32_16x16x32_bf16 v[108:111], v[164:167], v[28:31], v[108:111]
    v_add_f32_dpp v132, v83, v86 wave_ror:1 row_mask:0xf bank_mask:0xf
    v_mfma_f32_16x16x32_bf16 v[116:119], v[164:167], v[32:35], v[116:119]
    ds_read_b64_tr_b16 v[196:197], v4 offset:20736
    v_add_f32_dpp v134, v133, v85 wave_ror:1 row_mask:0xf bank_mask:0xf
    v_mfma_f32_16x16x32_bf16 v[124:127], v[164:167], v[36:39], v[124:127]
    ds_read_b64_tr_b16 v[198:199], v4 offset:20768
    v_add_f32_dpp v136, v135, v84 wave_ror:1 row_mask:0xf bank_mask:0xf
    s_waitcnt lgkmcnt(7)
    v_mfma_f32_16x16x32_bf16 v[88:91], v[168:171], v[16:19], v[88:91]
    ds_read2_b64 v[176:179], v2 offset0:244 offset1:240
    ds_read_b64_tr_b16 v[192:193], v4 offset:20480
    v_add_f32_dpp v132, v87, v86 wave_shr:1 row_mask:0xf bank_mask:0xf
    v_mfma_f32_16x16x32_bf16 v[96:99], v[168:171], v[20:23], v[96:99]
    ds_read_b64_tr_b16 v[194:195], v4 offset:20512
    v_add_f32_dpp v134, v132, v85 wave_shr:1 row_mask:0xf bank_mask:0xf
    v_mfma_f32_16x16x32_bf16 v[104:107], v[168:171], v[24:27], v[104:107]
    ds_read_b64_tr_b16 v[60:61], v4 offset:20224
    v_add_f32_dpp v136, v134, v84 wave_shr:1 row_mask:0xf bank_mask:0xf
    v_mfma_f32_16x16x32_bf16 v[112:115], v[168:171], v[28:31], v[112:115]
    v_add_f32_dpp v133, v87, v90 wave_ror:1 row_mask:0xf bank_mask:0xf
    v_mfma_f32_16x16x32_bf16 v[120:123], v[168:171], v[32:35], v[120:123]
    ds_read_b64_tr_b16 v[62:63], v4 offset:20256
    v_add_f32_dpp v135, v132, v89 wave_ror:1 row_mask:0xf bank_mask:0xf
    v_mfma_f32_16x16x32_bf16 v[128:131], v[168:171], v[36:39], v[128:131]
    ds_read_b64_tr_b16 v[56:57], v4 offset:19968
    v_add_f32_dpp v137, v134, v88 wave_ror:1 row_mask:0xf bank_mask:0xf
    s_waitcnt lgkmcnt(11)
    v_mfma_f32_16x16x32_bf16 v[92:95], v[172:175], v[16:19], v[92:95]
    ds_read2_b64 v[164:167], v3 offset0:4 offset1:0
    ds_read_b64_tr_b16 v[58:59], v4 offset:20000
    v_add_f32_dpp v133, v91, v90 wave_shr:1 row_mask:0xf bank_mask:0xf
    v_mfma_f32_16x16x32_bf16 v[100:103], v[172:175], v[20:23], v[100:103]
    ds_read_b64_tr_b16 v[52:53], v4 offset:19712
    v_add_f32_dpp v135, v133, v89 wave_shr:1 row_mask:0xf bank_mask:0xf
    v_mfma_f32_16x16x32_bf16 v[108:111], v[172:175], v[24:27], v[108:111]
    ds_read_b64_tr_b16 v[54:55], v4 offset:19744
    v_add_f32_dpp v137, v135, v88 wave_shr:1 row_mask:0xf bank_mask:0xf
    v_mfma_f32_16x16x32_bf16 v[116:119], v[172:175], v[28:31], v[116:119]
    v_cvt_pk_bf16_f32 v146, v136, v137
    v_mfma_f32_16x16x32_bf16 v[124:127], v[172:175], v[32:35], v[124:127]
    ds_read_b64_tr_b16 v[48:49], v4 offset:19456
    v_add_f32_dpp v132, v91, v94 wave_ror:1 row_mask:0xf bank_mask:0xf
    s_waitcnt lgkmcnt(10)
    v_mfma_f32_16x16x32_bf16 v[96:99], v[176:179], v[16:19], v[96:99]
    ds_read2_b64 v[168:171], v3 offset0:20 offset1:16
    ds_read_b64_tr_b16 v[50:51], v4 offset:19488
    v_add_f32_dpp v134, v133, v93 wave_ror:1 row_mask:0xf bank_mask:0xf
    v_mfma_f32_16x16x32_bf16 v[104:107], v[176:179], v[20:23], v[104:107]
    ds_read_b64_tr_b16 v[44:45], v4 offset:19200
    v_add_f32_dpp v136, v135, v92 wave_ror:1 row_mask:0xf bank_mask:0xf
    v_mfma_f32_16x16x32_bf16 v[112:115], v[176:179], v[24:27], v[112:115]
    ds_read_b64_tr_b16 v[46:47], v4 offset:19232
    v_add_f32_dpp v132, v95, v94 wave_shr:1 row_mask:0xf bank_mask:0xf
    v_mfma_f32_16x16x32_bf16 v[120:123], v[176:179], v[28:31], v[120:123]
    ds_read_b64_tr_b16 v[40:41], v4 offset:18944
    v_add_f32_dpp v134, v132, v93 wave_shr:1 row_mask:0xf bank_mask:0xf
    v_mfma_f32_16x16x32_bf16 v[128:131], v[176:179], v[32:35], v[128:131]
    s_nop 0
    v_add_f32_dpp v136, v134, v92 wave_shr:1 row_mask:0xf bank_mask:0xf
    s_waitcnt lgkmcnt(9)
    v_mfma_f32_16x16x32_bf16 v[100:103], v[164:167], v[16:19], v[100:103]
    ds_read2_b64 v[172:175], v3 offset0:36 offset1:32
    ds_read_b64_tr_b16 v[42:43], v4 offset:18976
    v_add_f32_dpp v133, v95, v98 wave_ror:1 row_mask:0xf bank_mask:0xf
    v_mfma_f32_16x16x32_bf16 v[108:111], v[164:167], v[20:23], v[108:111]
    ds_read_b64_tr_b16 v[36:37], v4 offset:18688
    v_add_f32_dpp v135, v132, v97 wave_ror:1 row_mask:0xf bank_mask:0xf
    v_mfma_f32_16x16x32_bf16 v[116:119], v[164:167], v[24:27], v[116:119]
    ds_read_b64_tr_b16 v[38:39], v4 offset:18720
    v_add_f32_dpp v137, v134, v96 wave_ror:1 row_mask:0xf bank_mask:0xf
    v_mfma_f32_16x16x32_bf16 v[124:127], v[164:167], v[28:31], v[124:127]
    ds_read_b64_tr_b16 v[32:33], v4 offset:18432
    v_add_f32_dpp v133, v99, v98 wave_shr:1 row_mask:0xf bank_mask:0xf
    s_waitcnt lgkmcnt(9)
    v_mfma_f32_16x16x32_bf16 v[104:107], v[168:171], v[16:19], v[104:107]
    ds_read2_b64 v[176:179], v3 offset0:52 offset1:48
    ds_read_b64_tr_b16 v[34:35], v4 offset:18464
    v_add_f32_dpp v135, v133, v97 wave_shr:1 row_mask:0xf bank_mask:0xf
    s_nop 1
    v_add_f32_dpp v137, v135, v96 wave_shr:1 row_mask:0xf bank_mask:0xf
    v_mfma_f32_16x16x32_bf16 v[112:115], v[168:171], v[20:23], v[112:115]
    v_cvt_pk_bf16_f32 v147, v136, v137
    s_add_u32 s6, s13, 655360
    v_mfma_f32_16x16x32_bf16 v[120:123], v[168:171], v[24:27], v[120:123]
    buffer_store_dwordx4 v[144:147], v5, s[60:63], s6 offen sc1
    v_add_f32_dpp v132, v99, v102 wave_ror:1 row_mask:0xf bank_mask:0xf
    v_mfma_f32_16x16x32_bf16 v[128:131], v[168:171], v[28:31], v[128:131]
    ds_read_b64_tr_b16 v[28:29], v4 offset:18176
    v_add_f32_dpp v134, v133, v101 wave_ror:1 row_mask:0xf bank_mask:0xf
    s_waitcnt lgkmcnt(7)
    v_mfma_f32_16x16x32_bf16 v[108:111], v[172:175], v[16:19], v[108:111]
    ds_read2_b64 v[164:167], v3 offset0:68 offset1:64
    v_add_f32_dpp v136, v135, v100 wave_ror:1 row_mask:0xf bank_mask:0xf
    v_add_f32_dpp v132, v103, v102 wave_shr:1 row_mask:0xf bank_mask:0xf
    v_mfma_f32_16x16x32_bf16 v[116:119], v[172:175], v[20:23], v[116:119]
    ds_read_b64_tr_b16 v[30:31], v4 offset:18208
    v_add_f32_dpp v134, v132, v101 wave_shr:1 row_mask:0xf bank_mask:0xf
    s_nop 1
    v_add_f32_dpp v136, v134, v100 wave_shr:1 row_mask:0xf bank_mask:0xf
    v_mfma_f32_16x16x32_bf16 v[124:127], v[172:175], v[24:27], v[124:127]
    v_add_f32_dpp v133, v103, v106 wave_ror:1 row_mask:0xf bank_mask:0xf
    v_add_f32_dpp v135, v132, v105 wave_ror:1 row_mask:0xf bank_mask:0xf
    s_waitcnt lgkmcnt(4)
    v_mfma_f32_16x16x32_bf16 v[112:115], v[176:179], v[16:19], v[112:115]
    ds_read2_b64 v[168:171], v3 offset0:84 offset1:80
    v_add_f32_dpp v137, v134, v104 wave_ror:1 row_mask:0xf bank_mask:0xf
    v_add_f32_dpp v133, v107, v106 wave_shr:1 row_mask:0xf bank_mask:0xf
    v_mfma_f32_16x16x32_bf16 v[120:123], v[176:179], v[20:23], v[120:123]
    s_nop 0
    v_add_f32_dpp v135, v133, v105 wave_shr:1 row_mask:0xf bank_mask:0xf
    s_nop 1
    v_add_f32_dpp v137, v135, v104 wave_shr:1 row_mask:0xf bank_mask:0xf
    v_mfma_f32_16x16x32_bf16 v[128:131], v[176:179], v[24:27], v[128:131]
    ds_read_b64_tr_b16 v[24:25], v4 offset:17920
    v_cvt_pk_bf16_f32 v140, v136, v137
    v_add_f32_dpp v132, v107, v110 wave_ror:1 row_mask:0xf bank_mask:0xf
    s_waitcnt lgkmcnt(3)
    v_mfma_f32_16x16x32_bf16 v[116:119], v[164:167], v[16:19], v[116:119]
    ds_read2_b64 v[172:175], v3 offset0:100 offset1:96
    v_add_f32_dpp v134, v133, v109 wave_ror:1 row_mask:0xf bank_mask:0xf
    v_add_f32_dpp v136, v135, v108 wave_ror:1 row_mask:0xf bank_mask:0xf
    v_mfma_f32_16x16x32_bf16 v[124:127], v[164:167], v[20:23], v[124:127]
    ds_read_b64_tr_b16 v[26:27], v4 offset:17952
    v_add_u32 v6, 17408, v2
    ds_read2_b64 v[164:167], v6 offset0:4 offset1:0
    v_add_f32_dpp v132, v111, v110 wave_shr:1 row_mask:0xf bank_mask:0xf
    s_nop 1
    v_add_f32_dpp v134, v132, v109 wave_shr:1 row_mask:0xf bank_mask:0xf
    s_waitcnt lgkmcnt(4)
    v_mfma_f32_16x16x32_bf16 v[120:123], v[168:171], v[16:19], v[120:123]
    ds_read2_b64 v[176:179], v3 offset0:116 offset1:112
    v_add_f32_dpp v136, v134, v108 wave_shr:1 row_mask:0xf bank_mask:0xf
    v_add_f32_dpp v133, v111, v114 wave_ror:1 row_mask:0xf bank_mask:0xf
    v_mfma_f32_16x16x32_bf16 v[128:131], v[168:171], v[20:23], v[128:131]
    ds_read2_b64 v[168:171], v6 offset0:20 offset1:16
    ds_read_b64_tr_b16 v[20:21], v4 offset:17664
    v_add_f32_dpp v135, v132, v113 wave_ror:1 row_mask:0xf bank_mask:0xf
    v_add_f32_dpp v137, v134, v112 wave_ror:1 row_mask:0xf bank_mask:0xf
    s_waitcnt lgkmcnt(5)
    v_mfma_f32_16x16x32_bf16 v[124:127], v[172:175], v[16:19], v[124:127]
    v_add_f32_dpp v133, v115, v114 wave_shr:1 row_mask:0xf bank_mask:0xf
    s_nop 1
    v_add_f32_dpp v135, v133, v113 wave_shr:1 row_mask:0xf bank_mask:0xf
    s_waitcnt lgkmcnt(2)
    v_mfma_f32_16x16x32_bf16 v[128:131], v[176:179], v[16:19], v[128:131]
    ds_read_b64_tr_b16 v[22:23], v4 offset:17696
    ds_read_b64_tr_b16 v[16:17], v4 offset:17408
    ds_read_b64_tr_b16 v[18:19], v4 offset:17440
    v_add_f32_dpp v137, v135, v112 wave_shr:1 row_mask:0xf bank_mask:0xf
    v_cvt_pk_bf16_f32 v141, v136, v137
    v_add_f32_dpp v132, v115, v118 wave_ror:1 row_mask:0xf bank_mask:0xf
    v_add_f32_dpp v134, v133, v117 wave_ror:1 row_mask:0xf bank_mask:0xf
    v_add_f32_dpp v136, v135, v116 wave_ror:1 row_mask:0xf bank_mask:0xf
    v_add_f32_dpp v132, v119, v118 wave_shr:1 row_mask:0xf bank_mask:0xf
    s_nop 1
    v_add_f32_dpp v134, v132, v117 wave_shr:1 row_mask:0xf bank_mask:0xf
    s_nop 1
    v_add_f32_dpp v136, v134, v116 wave_shr:1 row_mask:0xf bank_mask:0xf
    v_add_f32_dpp v133, v119, v122 wave_ror:1 row_mask:0xf bank_mask:0xf
    v_add_f32_dpp v135, v132, v121 wave_ror:1 row_mask:0xf bank_mask:0xf
    v_add_f32_dpp v137, v134, v120 wave_ror:1 row_mask:0xf bank_mask:0xf
    v_add_f32_dpp v133, v123, v122 wave_shr:1 row_mask:0xf bank_mask:0xf
    s_nop 1
    v_add_f32_dpp v135, v133, v121 wave_shr:1 row_mask:0xf bank_mask:0xf
    s_nop 1
    v_add_f32_dpp v137, v135, v120 wave_shr:1 row_mask:0xf bank_mask:0xf
    v_cvt_pk_bf16_f32 v142, v136, v137
    v_add_f32_dpp v132, v123, v126 wave_ror:1 row_mask:0xf bank_mask:0xf
    v_add_f32_dpp v134, v133, v125 wave_ror:1 row_mask:0xf bank_mask:0xf
    v_add_f32_dpp v136, v135, v124 wave_ror:1 row_mask:0xf bank_mask:0xf
    v_add_f32_dpp v132, v127, v126 wave_shr:1 row_mask:0xf bank_mask:0xf
    s_nop 1
    v_add_f32_dpp v134, v132, v125 wave_shr:1 row_mask:0xf bank_mask:0xf
    s_nop 1
    v_add_f32_dpp v136, v134, v124 wave_shr:1 row_mask:0xf bank_mask:0xf
    v_add_f32_dpp v133, v127, v130 wave_ror:1 row_mask:0xf bank_mask:0xf
    v_add_f32_dpp v135, v132, v129 wave_ror:1 row_mask:0xf bank_mask:0xf
    v_add_f32_dpp v137, v134, v128 wave_ror:1 row_mask:0xf bank_mask:0xf
    v_add_f32_dpp v133, v131, v130 wave_shr:1 row_mask:0xf bank_mask:0xf
    s_nop 1
    v_add_f32_dpp v135, v133, v129 wave_shr:1 row_mask:0xf bank_mask:0xf
    s_nop 1
    v_add_f32_dpp v137, v135, v128 wave_shr:1 row_mask:0xf bank_mask:0xf
    v_cvt_pk_bf16_f32 v143, v136, v137
    s_add_u32 s6, s13, 1310720
    buffer_store_dwordx4 v[140:143], v5, s[60:63], s6 offen sc1
LconvE_38:
    s_add_u32 s89, s89, 1
    s_add_u32 s86, s86, 2
    v_add_u32 v2, 17408, v2
    v_add_u32 v3, 17408, v3
    v_add_u32 v4, 17408, v4
    s_waitcnt vmcnt(1)
    s_cmp_ge_u32 s89, 2
    s_cbranch_scc1 L_conv
    s_cmp_lg_u32 s5, 0
    s_cbranch_scc1 Lok_60
    s_mov_b32 s82, 0
    s_waitcnt vmcnt(1)
Lspin_61:
    v_cmp_gt_u32 vcc, 56, v253
    s_add_u32 s82, s82, 1
    s_cmp_ge_u32 s82, 200000
    s_cbranch_scc1 Lok_60
    s_and_b32 s83, vcc_lo, 1
    s_cbranch_scc0 Lok_60
    s_sleep 8
    v_mov_b32 v253, 0
    s_mov_b64 exec, 1
    buffer_atomic_add v253, v255, s[60:63], s9 offen sc0 sc1
    s_mov_b64 exec, -1
    s_waitcnt vmcnt(0)
    s_branch Lspin_61
Lok_60:
    s_barrier
    s_mov_b64 vcc, -1
    s_branch L_plain
L_last:
    s_endpgm
.section .rodata,"a"
.p2align 6
.amdhsa_kernel parallel_sum__ssm_conv_h3__dense_activation_gelu__prompt_kernel
  .amdhsa_next_free_vgpr 512
  .amdhsa_next_free_sgpr 102
  .amdhsa_accum_offset 256
  .amdhsa_group_segment_fixed_size 0
  .amdhsa_kernarg_size 112
  .amdhsa_user_sgpr_count 2
  .amdhsa_user_sgpr_kernarg_segment_ptr 1
  .amdhsa_system_sgpr_workgroup_id_x 1
.end_amdhsa_kernel
```
